```python
import torch

def _softmax(x, axis=-1):
    return torch.softmax(x, dim=axis)
def _gelu(x):
    return torch.nn.functional.gelu(x, approximate="tanh")
def _silu(x):
    return torch.nn.functional.silu(x)
def _sigmoid(x):
    return torch.sigmoid(x)
def _layernorm(x, axis=-1, eps=1e-5):
    m = x.mean(dim=axis, keepdim=True)
    v = x.var(dim=axis, keepdim=True, unbiased=False)
    return (x - m) / torch.sqrt(v + eps)
def _scatter_add(tgt, idx, src, axis=0):
    return tgt.clone().index_add_(axis, idx, src)
def _segment_sum(src, seg, n):
    out = torch.zeros((n,) + src.shape[1:], dtype=src.dtype)
    return out.index_add_(0, seg, src)
def _pad(x, pw):
    flat = tuple(v for pair in reversed(pw) for v in pair)
    return torch.nn.functional.pad(x, flat)

kernel_name = 'concat_heads__mha_block_cached__mha_block_cached__near_ridge'

def setup_inputs():

    _w = (lambda a: (lambda t: t.to(torch.bfloat16) if t.is_floating_point() else t)(torch.as_tensor(a)))
    def _A_setup():
        B, Sq, D = 8, 160, 448
        H, Sk, Dh = 16, 1024, 256
        return {
            "x": _w((lambda *s: torch.randn(*s, dtype=torch.bfloat16) * 0.8)(B, Sq, D)),
            "k_cache": _w((lambda *s: torch.randn(*s, dtype=torch.bfloat16) * 0.8)(B, H, Sk, Dh)),
            "v_cache": _w((lambda *s: torch.randn(*s, dtype=torch.bfloat16) * 0.05)(B, H, Sk, Dh)),
            "wq": _w((lambda *s: torch.randn(*s, dtype=torch.bfloat16) * 0.8)(D, H * Dh) * (D ** -0.5)),
            "wo": _w((lambda *s: torch.randn(*s, dtype=torch.bfloat16) * 0.05)(H * Dh, D) * ((H * Dh) ** -0.5)),
        }
    _A_in = _A_setup()

    def _B_setup():
        B, Sq, D = 8, 160, 448
        H, Sk, Dh = 16, 1024, 256
        return {
            "x": _w((lambda *s: torch.randn(*s, dtype=torch.bfloat16) * 0.8)(B, Sq, D)),
            "k_cache": _w((lambda *s: torch.randn(*s, dtype=torch.bfloat16) * 0.8)(B, H, Sk, Dh)),
            "v_cache": _w((lambda *s: torch.randn(*s, dtype=torch.bfloat16) * 0.05)(B, H, Sk, Dh)),
            "wq": _w((lambda *s: torch.randn(*s, dtype=torch.bfloat16) * 0.8)(D, H * Dh) * (D ** -0.5)),
            "wo": _w((lambda *s: torch.randn(*s, dtype=torch.bfloat16) * 0.05)(H * Dh, D) * ((H * Dh) ** -0.5)),
        }
    _B_in = _B_setup()

    return {
        "A_x": _A_in["x"],
        "A_k_cache": _A_in["k_cache"],
        "A_v_cache": _A_in["v_cache"],
        "A_wq": _A_in["wq"],
        "A_wo": _A_in["wo"],
        "B_x": _B_in["x"],
        "B_k_cache": _B_in["k_cache"],
        "B_v_cache": _B_in["v_cache"],
        "B_wq": _B_in["wq"],
        "B_wo": _B_in["wo"],
    }

def reference(A_x, A_k_cache, A_v_cache, A_wq, A_wo, B_x, B_k_cache, B_v_cache, B_wq, B_wo):
    def _A_ref(x, k_cache, v_cache, wq, wo):
        B, Sq, D = x.shape
        H, Dh = 16, 256
        q = (lambda x, *d: x.permute(*d))((x @ wq).reshape(B, Sq, H, Dh), 0, 2, 1, 3)
        scores = torch.einsum("bhqd,bhkd->bhqk", q, k_cache) * (Dh ** -0.5)
        p = _softmax(scores, axis=-1)
        o = torch.einsum("bhqk,bhkd->bhqd", p, v_cache)
        return (lambda x, *d: x.permute(*d))(o, 0, 2, 1, 3).reshape(B, Sq, H * Dh) @ wo

    def _B_ref(x, k_cache, v_cache, wq, wo):
        B, Sq, D = x.shape
        H, Dh = 16, 256
        q = (lambda x, *d: x.permute(*d))((x @ wq).reshape(B, Sq, H, Dh), 0, 2, 1, 3)
        scores = torch.einsum("bhqd,bhkd->bhqk", q, k_cache) * (Dh ** -0.5)
        p = _softmax(scores, axis=-1)
        o = torch.einsum("bhqk,bhkd->bhqd", p, v_cache)
        return (lambda x, *d: x.permute(*d))(o, 0, 2, 1, 3).reshape(B, Sq, H * Dh) @ wo

    a = _A_ref(A_x, A_k_cache, A_v_cache, A_wq, A_wo)
    b = _B_ref(B_x, B_k_cache, B_v_cache, B_wq, B_wo)
    return torch.concatenate([a, b], axis=-1)
```

```asm
; @launch grid=(256,1,1) block=(256,1,1) lds=163840
.amdgcn_target "amdgcn-amd-amdhsa--gfx950"
.text
.globl concat_heads__mha_block_cached__mha_block_cached__near_ridge_kernel
.p2align 8
.type concat_heads__mha_block_cached__mha_block_cached__near_ridge_kernel,@function
concat_heads__mha_block_cached__mha_block_cached__near_ridge_kernel:
s_cmp_ge_u32 s2, 256
s_cbranch_scc1 L_exit
s_load_dwordx16 s[52:67], s[0:1], 0
s_load_dwordx4 s[68:71], s[0:1], 64
s_load_dwordx2 s[72:73], s[0:1], 96
s_load_dwordx4 s[96:99], s[0:1], 80
v_lshrrev_b32 v1, 6, v0
s_and_b32 s3, s2, 7
v_readfirstlane_b32 s32, v1
s_lshr_b32 s4, s2, 3
s_and_b32 s5, s3, 3
s_lshl_b32 s5, s5, 2
s_and_b32 s6, s4, 3
s_add_u32 s5, s5, s6
s_lshr_b32 s6, s4, 2
s_lshr_b32 s7, s3, 2
s_and_b32 s47, s32, 1
s_lshl_b32 s33, s32, 12
s_mov_b32 s37, 1035512379
s_mov_b32 s43, 0x40004000
s_mov_b32 s40, 0
s_lshr_b32 s3, s32, 1
s_lshl_b32 s4, s3, 4
s_lshl_b32 s41, s32, 5
s_sub_u32 s4, s4, s41
s_add_u32 s4, s4, 128
s_mul_i32 s41, s4, 896
s_and_b32 s38, s2, 1
s_lshl_b32 s38, s38, 2
s_and_b32 s39, s2, 18
s_or_b32 s38, s38, s39
s_bfe_u32 s39, s2, 65539
s_or_b32 s44, s38, s39
s_mov_b32 s48, 0
s_mov_b32 s49, -1
s_sub_u32 s50, 0, s47
s_mov_b32 s51, s50
s_and_b32 s3, s5, 3
s_mul_i32 s3, s3, 4
s_lshl_b32 s4, s6, 2
s_add_u32 s3, s3, s4
s_mov_b32 s94, 542246176
s_mov_b32 s95, 86004229
s_lshr_b64 s[94:95], s[94:95], s3
s_and_b32 s75, s94, 7
v_bfe_u32 v63, v0, 5, 1
v_and_b32 v64, 31, v0
v_lshlrev_b32 v65, 1, v63
v_xor_b32 v65, v64, v65
v_lshlrev_b32 v65, 4, v65
s_lshl_b32 s38, s47, 7
s_lshl_b32 s39, s32, 16
v_xor_b32 v56, s38, v65
v_lshl_add_u32 v56, v63, 13, v56
v_add_u32 v56, s39, v56
v_xor_b32 v57, 64, v56
v_add_u32 v57, 15360, v57
v_bfe_u32 v66, v0, 3, 3
v_bfe_u32 v67, v0, 4, 2
v_xor_b32 v67, v67, v0
v_and_b32 v67, 7, v67
s_lshl_b32 s39, s32, 5
v_add_u32 v66, s39, v66
v_mul_u32_u24 v66, 896, v66
v_lshl_add_u32 v66, v67, 4, v66
v_xor_b32 v67, 64, v66
v_add_u32 v67, 6144, v67
s_waitcnt lgkmcnt(0)
s_cmp_eq_u32 s7, 1
s_cselect_b64 s[58:59], s[68:69], s[58:59]
s_cselect_b64 s[52:53], s[62:63], s[52:53]
s_cselect_b64 s[54:55], s[64:65], s[54:55]
s_cselect_b64 s[56:57], s[66:67], s[56:57]
s_cselect_b64 s[60:61], s[70:71], s[60:61]
s_lshl_b32 s64, s75, 19
s_lshl_b32 s65, s75, 7
s_lshl_b32 s3, s5, 9
s_add_u32 s12, s58, s3
s_addc_u32 s13, s59, 0
s_sub_u32 s14, 3670016, s3
s_mov_b32 s15, 0x20000
s_mul_i32 s3, s6, 143360
s_add_u32 s8, s52, s3
s_addc_u32 s9, s53, 0
s_mov_b32 s10, 143360
s_mov_b32 s11, 0x20000
s_add_u32 m0, s33, 49152
s_add_u32 s38, s64, 30720
buffer_load_dwordx4 v56, s[12:15], s64 offen offset:0  lds
buffer_load_dwordx4 v57, s[12:15], s64 offen offset:1024  lds
s_add_u32 s64, s64, 262144
s_cmp_eq_u32 s64, 3670016
s_cselect_b32 s64, 0, s64
buffer_load_dwordx4 v56, s[12:15], s38 offen offset:2048  lds
buffer_load_dwordx4 v57, s[12:15], s38 offen offset:3072  lds
s_add_u32 m0, s33, 149504
s_add_u32 s38, s65, 14336
buffer_load_dwordx4 v66, s[8:11], s38 offen offset:0  lds
buffer_load_dwordx4 v67, s[8:11], s38 offen offset:1024  lds
s_add_u32 m0, s33, 131072
s_add_u32 s38, s65, s41
buffer_load_dwordx4 v66, s[8:11], s38 offen offset:0  lds
buffer_load_dwordx4 v67, s[8:11], s38 offen offset:1024  lds
s_add_u32 m0, s33, 147456
s_nop 0
buffer_load_dwordx4 v66, s[8:11], s65 offen offset:0  lds
buffer_load_dwordx4 v67, s[8:11], s65 offen offset:1024  lds
s_add_u32 s65, s65, 128
s_cmp_eq_u32 s65, 896
s_cselect_b32 s65, 0, s65
s_lshl_b32 s3, s6, 4
s_add_u32 s3, s3, s5
s_lshl_b32 s3, s3, 19
s_add_u32 s16, s54, s3
s_addc_u32 s17, s55, 0
s_mov_b32 s18, 524288
s_mov_b32 s19, 0x20000
s_add_u32 s20, s56, s3
s_addc_u32 s21, s57, 0
s_mov_b32 s22, 524288
s_mov_b32 s23, 0x20000
s_mul_i32 s3, s5, 229376
s_add_u32 s24, s60, s3
s_addc_u32 s25, s61, 0
s_mov_b32 s26, 229376
s_mov_b32 s27, 0x20000
s_lshl_b32 s3, s6, 2
s_add_u32 s3, s3, s32
s_mul_i32 s69, s3, 7168
s_lshl_b32 s4, s7, 5
s_add_u32 s3, s3, s4
s_lshl_b32 s3, s3, 21
s_add_u32 s52, s3, 85983231
s_and_b32 s4, s5, 8
s_add_u32 s53, s5, s4
s_lshl_b32 s53, s53, 10
s_add_u32 s72, s72, s52
s_addc_u32 s73, s73, 0
s_and_b32 s72, s72, 4292870144
s_add_u32 s28, s72, s53
s_addc_u32 s29, s73, 0
s_sub_u32 s30, 1146880, s53
s_mov_b32 s31, 0x20000
s_getpc_b64 s[70:71]
L_pc:
s_lshr_b32 s74, s2, 3
s_lshl_b32 s74, s74, 2
s_add_u32 s74, s74, s32
s_mul_i32 s74, s74, 384
s_mov_b32 s68, s74
v_and_b32 v90, 63, v0
v_lshlrev_b32 v90, 7, v90
v_and_b32 v72, 4095, v90
s_cmp_eq_u32 s44, s32
s_cbranch_scc0 L_np0
s_add_u32 s52, s72, 1572864
s_addc_u32 s53, s73, 0
s_mov_b32 s54, 16384
s_mov_b32 s55, 0x20000
v_lshlrev_b32 v93, 6, v90
v_mov_b32 v94, 0
buffer_atomic_or v94, v93, s[52:55], 0 offen sc1
L_np0:
v_add_u32 v92, s74, v90
v_min_u32 v92, L_exit - L_pc, v92
s_mov_b64 exec, 7
global_load_dword v91, v92, s[70:71]
s_mov_b64 exec, -1
v_lshl_add_u32 v20, v63, 9, v65
v_add_u32 v20, s33, v20
v_xor_b32 v21, 64, v20
v_xor_b32 v22, 128, v20
v_xor_b32 v23, 192, v20
v_xor_b32 v16, v64, v63
v_lshlrev_b32 v16, 4, v16
s_lshl_b32 s39, s47, 7
v_xor_b32 v16, s39, v16
v_lshl_add_u32 v16, v63, 9, v16
v_add_u32 v16, s33, v16
v_xor_b32 v17, 32, v16
v_xor_b32 v18, 64, v16
v_xor_b32 v19, 96, v16
v_and_b32 v63, 15, v0
v_bfe_u32 v64, v0, 4, 2
v_lshrrev_b32 v65, 1, v63
v_xor_b32 v65, v65, v64
v_lshlrev_b32 v65, 4, v65
v_lshl_add_u32 v65, v63, 7, v65
v_add_u32 v68, s33, v65
v_xor_b32 v69, 64, v68
v_add_u32 v70, 131072, v68
v_add_u32 v71, 131072, v69
v_lshrrev_b32 v65, 2, v63
v_and_b32 v1, 3, v63
v_lshlrev_b32 v1, 3, v1
v_and_b32 v3, 1, v64
v_lshl_add_u32 v3, v3, 2, v65
v_lshl_add_u32 v15, v3, 5, v1
v_lshl_add_u32 v2, v64, 3, v65
v_lshl_add_u32 v1, v2, 9, v15
s_lshl_b32 s39, s47, 7
v_xor_b32 v1, s39, v1
v_xor_b32 v2, 32, v1
v_xor_b32 v3, 64, v1
v_xor_b32 v4, 96, v1
v_xor_b32 v5, 128, v1
v_xor_b32 v6, 160, v1
v_xor_b32 v7, 192, v1
v_xor_b32 v8, 224, v1
v_add_u32 v48, 65536, v1
v_add_u32 v49, 65536, v2
v_add_u32 v50, 65536, v3
v_add_u32 v51, 65536, v4
v_add_u32 v52, 65536, v5
v_add_u32 v53, 65536, v6
v_add_u32 v54, 65536, v7
v_add_u32 v55, 65536, v8
v_lshl_add_u32 v65, v64, 2, v65
v_lshl_add_u32 v15, v65, 9, v15
s_lshl_b32 s39, s47, 8
s_add_u32 s39, s39, 98304
v_add_u32 v15, s39, v15
v_xor_b32 v9, v63, v64
v_lshlrev_b32 v9, 4, v9
v_lshl_add_u32 v9, v63, 9, v9
s_lshl_b32 s39, s47, 13
v_add_u32 v9, s39, v9
v_xor_b32 v10, 64, v9
v_xor_b32 v11, 128, v9
v_xor_b32 v12, 192, v9
v_lshrrev_b32 v65, 1, v64
v_lshlrev_b32 v65, 8, v65
v_lshl_add_u32 v65, v63, 4, v65
v_and_b32 v64, 1, v64
v_lshl_add_u32 v65, v64, 3, v65
s_lshl_b32 s38, s47, 11
s_lshl_b32 s39, s32, 14
s_add_u32 s39, s39, 49152
v_add_u32 v65, s38, v65
v_add_u32 v59, s39, v65
v_xor_b32 v60, 2048, v59
s_lshr_b32 s38, s32, 1
s_lshl_b32 s39, s38, 13
s_add_u32 s39, s39, 114688
v_add_u32 v61, s39, v65
v_and_b32 v89, 63, v0
v_lshlrev_b32 v89, 4, v89
s_mul_i32 s39, s38, 40960
s_add_u32 s39, s39, 49152
v_add_u32 v62, s39, v89
s_mul_i32 s39, s38, 5120
s_add_u32 s39, s39, 65536
v_add_u32 v13, s39, v89
s_lshl_b32 s39, s47, 3
v_add_u32 v14, s39, v13
v_bfe_u32 v64, v0, 3, 3
v_lshrrev_b32 v65, 2, v64
v_xor_b32 v65, v65, v64
v_and_b32 v65, 3, v65
v_lshlrev_b32 v65, 1, v65
v_and_b32 v63, 7, v0
v_xor_b32 v63, v63, v65
s_lshl_b32 s39, s32, 5
v_add_u32 v64, s39, v64
v_mul_u32_u24 v64, 896, v64
v_lshl_add_u32 v88, v63, 4, v64
v_mov_b32 v38, 0
v_mov_b32 v39, 0
s_add_u32 m0, s33, 65536
s_add_u32 s38, s64, 30720
buffer_load_dwordx4 v56, s[12:15], s64 offen offset:0  lds
buffer_load_dwordx4 v57, s[12:15], s64 offen offset:1024  lds
s_add_u32 s64, s64, 262144
s_cmp_eq_u32 s64, 3670016
s_cselect_b32 s64, 0, s64
buffer_load_dwordx4 v56, s[12:15], s38 offen offset:2048  lds
buffer_load_dwordx4 v57, s[12:15], s38 offen offset:3072  lds
s_add_u32 m0, s33, 16384
s_add_u32 s38, s65, 14336
buffer_load_dwordx4 v66, s[8:11], s38 offen offset:0  lds
buffer_load_dwordx4 v67, s[8:11], s38 offen offset:1024  lds
s_add_u32 m0, s33, 18432
s_add_u32 s38, s65, s41
buffer_load_dwordx4 v66, s[8:11], s38 offen offset:0  lds
buffer_load_dwordx4 v67, s[8:11], s38 offen offset:1024  lds
s_add_u32 m0, s33, 133120
s_nop 0
buffer_load_dwordx4 v66, s[8:11], s65 offen offset:0  lds
buffer_load_dwordx4 v67, s[8:11], s65 offen offset:1024  lds
s_add_u32 s65, s65, 128
s_cmp_eq_u32 s65, 896
s_cselect_b32 s65, 0, s65
s_cmp_eq_u32 s44, s32
s_cbranch_scc0 L_np1
s_add_u32 s52, s72, 1572864
s_addc_u32 s53, s73, 0
s_mov_b32 s54, 16384
s_mov_b32 s55, 0x20000
v_lshlrev_b32 v93, 6, v90
v_mov_b32 v94, 0
s_mov_b64 exec, 1
s_mov_b32 s38, 8192
s_waitcnt vmcnt(0)
s_memtime s[56:57]
buffer_atomic_or v94, v93, s[52:55], 0 offen sc0 sc1
s_waitcnt vmcnt(0)
v_mov_b32 v94, 0
s_memtime s[58:59]
buffer_atomic_or v94, v93, s[52:55], s38 offen sc0 sc1
s_waitcnt vmcnt(0)
v_mov_b32 v94, 0
s_memtime s[60:61]
s_lshr_b32 s39, s2, 5
s_and_b32 s38, s2, 4
s_lshl_b32 s38, s38, 1
s_add_u32 s38, s38, s39
s_lshl_b32 s38, s38, 4
s_add_u32 s52, s98, s38
s_addc_u32 s53, s99, 0
s_mov_b32 s54, 16
s_waitcnt lgkmcnt(0)
s_sub_u32 s56, s58, s56
s_sub_u32 s58, s60, s58
s_cmp_lt_u32 s58, s56
s_cselect_b32 s38, 8, 0
s_lshl_b32 s38, s38, s32
v_mov_b32 v92, s38
buffer_atomic_or v92, v93, s[52:55], 0 offen offset:8 sc1
s_mov_b64 exec, -1
L_np1:
s_waitcnt vmcnt(11)
ds_read_b128 a[156:159], v70 offset:16384
ds_read_b128 a[160:163], v70 offset:18432
ds_read_b128 a[164:167], v70 offset:0
ds_read_b128 a[144:147], v71 offset:16384
ds_read_b128 a[148:151], v71 offset:18432
ds_read_b128 a[152:155], v71 offset:0
s_barrier
s_waitcnt lgkmcnt(0)
ds_read_b64_tr_b16 a[224:225], v1 offset:49152
ds_read_b64_tr_b16 a[226:227], v1 offset:51200
ds_read_b64_tr_b16 a[228:229], v2 offset:49152
ds_read_b64_tr_b16 a[230:231], v2 offset:51200
ds_read_b64_tr_b16 a[232:233], v3 offset:49152
ds_read_b64_tr_b16 a[234:235], v3 offset:51200
ds_read_b64_tr_b16 a[236:237], v4 offset:49152
ds_read_b64_tr_b16 a[238:239], v4 offset:51200
ds_read_b64_tr_b16 a[240:241], v5 offset:49152
ds_read_b64_tr_b16 a[242:243], v5 offset:51200
s_waitcnt lgkmcnt(8)
v_mfma_f32_16x16x32_bf16 v[96:99], a[224:227], a[156:159], 0
s_add_u32 m0, s33, 81920
ds_read_b64_tr_b16 a[244:245], v6 offset:49152
s_add_u32 s38, s64, 30720
v_mfma_f32_16x16x32_bf16 v[100:103], a[224:227], a[160:163], 0
ds_read_b64_tr_b16 a[246:247], v6 offset:51200
v_mfma_f32_16x16x32_bf16 v[224:227], a[224:227], a[164:167], 0
s_waitcnt lgkmcnt(8)
ds_read_b64_tr_b16 a[248:249], v7 offset:49152
v_mfma_f32_16x16x32_bf16 v[104:107], a[228:231], a[156:159], 0
ds_read_b64_tr_b16 a[250:251], v7 offset:51200
v_mfma_f32_16x16x32_bf16 v[108:111], a[228:231], a[160:163], 0
buffer_load_dwordx4 v56, s[12:15], s64 offen offset:0  lds
v_mfma_f32_16x16x32_bf16 v[228:231], a[228:231], a[164:167], 0
s_waitcnt lgkmcnt(8)
ds_read_b64_tr_b16 a[252:253], v8 offset:49152
ds_read_b64_tr_b16 a[254:255], v8 offset:51200
v_mfma_f32_16x16x32_bf16 v[112:115], a[232:235], a[156:159], 0
ds_read_b64_tr_b16 a[192:193], v1 offset:49408
v_mfma_f32_16x16x32_bf16 v[116:119], a[232:235], a[160:163], 0
ds_read_b64_tr_b16 a[194:195], v1 offset:51456
v_mfma_f32_16x16x32_bf16 v[232:235], a[232:235], a[164:167], 0
s_waitcnt lgkmcnt(10)
buffer_load_dwordx4 v57, s[12:15], s64 offen offset:1024  lds
v_mfma_f32_16x16x32_bf16 v[120:123], a[236:239], a[156:159], 0
s_add_u32 s64, s64, 262144
ds_read_b64_tr_b16 a[196:197], v2 offset:49408
v_mfma_f32_16x16x32_bf16 v[124:127], a[236:239], a[160:163], 0
s_cmp_eq_u32 s64, 3670016
s_cselect_b32 s64, 0, s64
ds_read_b64_tr_b16 a[198:199], v2 offset:51456
v_mfma_f32_16x16x32_bf16 v[236:239], a[236:239], a[164:167], 0
s_waitcnt lgkmcnt(10)
buffer_load_dwordx4 v56, s[12:15], s38 offen offset:2048  lds
v_mfma_f32_16x16x32_bf16 v[128:131], a[240:243], a[156:159], 0
ds_read_b64_tr_b16 a[200:201], v3 offset:49408
v_mfma_f32_16x16x32_bf16 v[132:135], a[240:243], a[160:163], 0
s_waitcnt lgkmcnt(9)
ds_read_b64_tr_b16 a[202:203], v3 offset:51456
v_mfma_f32_16x16x32_bf16 v[136:139], a[244:247], a[156:159], 0
buffer_load_dwordx4 v57, s[12:15], s38 offen offset:3072  lds
v_mfma_f32_16x16x32_bf16 v[140:143], a[244:247], a[160:163], 0
s_waitcnt lgkmcnt(8)
ds_read_b64_tr_b16 a[204:205], v4 offset:49408
v_mfma_f32_16x16x32_bf16 v[144:147], a[248:251], a[156:159], 0
ds_read_b64_tr_b16 a[206:207], v4 offset:51456
v_mfma_f32_16x16x32_bf16 v[148:151], a[248:251], a[160:163], 0
s_waitcnt lgkmcnt(8)
ds_read_b64_tr_b16 a[208:209], v5 offset:49408
v_mfma_f32_16x16x32_bf16 v[152:155], a[252:255], a[156:159], 0
ds_read_b64_tr_b16 a[210:211], v5 offset:51456
v_mfma_f32_16x16x32_bf16 v[156:159], a[252:255], a[160:163], 0
s_waitcnt lgkmcnt(8)
ds_read_b64_tr_b16 a[212:213], v6 offset:49408
v_mfma_f32_16x16x32_bf16 v[160:163], a[192:195], a[156:159], 0
ds_read_b64_tr_b16 a[214:215], v6 offset:51456
v_mfma_f32_16x16x32_bf16 v[164:167], a[192:195], a[160:163], 0
ds_read_b64_tr_b16 a[216:217], v7 offset:49408
v_mfma_f32_16x16x32_bf16 v[240:243], a[192:195], a[164:167], 0
s_waitcnt lgkmcnt(9)
ds_read_b64_tr_b16 a[218:219], v7 offset:51456
v_mfma_f32_16x16x32_bf16 v[168:171], a[196:199], a[156:159], 0
ds_read_b64_tr_b16 a[220:221], v8 offset:49408
v_mfma_f32_16x16x32_bf16 v[172:175], a[196:199], a[160:163], 0
ds_read_b64_tr_b16 a[222:223], v8 offset:51456
v_mfma_f32_16x16x32_bf16 v[244:247], a[196:199], a[164:167], 0
s_waitcnt vmcnt(10)
s_barrier
s_waitcnt lgkmcnt(10)
v_mfma_f32_16x16x32_bf16 v[176:179], a[200:203], a[156:159], 0
s_add_u32 m0, s33, 98304
ds_read_b64_tr_b16 a[224:225], v48 offset:0
s_add_u32 s38, s64, 30720
v_mfma_f32_16x16x32_bf16 v[180:183], a[200:203], a[160:163], 0
ds_read_b64_tr_b16 a[226:227], v48 offset:2048
v_mfma_f32_16x16x32_bf16 v[248:251], a[200:203], a[164:167], 0
s_waitcnt lgkmcnt(10)
buffer_load_dwordx4 v56, s[12:15], s64 offen offset:0  lds
v_mfma_f32_16x16x32_bf16 v[184:187], a[204:207], a[156:159], 0
ds_read_b64_tr_b16 a[228:229], v49 offset:0
v_mfma_f32_16x16x32_bf16 v[188:191], a[204:207], a[160:163], 0
ds_read_b64_tr_b16 a[230:231], v49 offset:2048
v_mfma_f32_16x16x32_bf16 v[252:255], a[204:207], a[164:167], 0
s_waitcnt lgkmcnt(10)
buffer_load_dwordx4 v57, s[12:15], s64 offen offset:1024  lds
v_mfma_f32_16x16x32_bf16 v[192:195], a[208:211], a[156:159], 0
s_add_u32 s64, s64, 262144
ds_read_b64_tr_b16 a[232:233], v50 offset:0
v_mfma_f32_16x16x32_bf16 v[196:199], a[208:211], a[160:163], 0
s_waitcnt lgkmcnt(9)
ds_read_b64_tr_b16 a[234:235], v50 offset:2048
v_mfma_f32_16x16x32_bf16 v[200:203], a[212:215], a[156:159], 0
s_cmp_eq_u32 s64, 3670016
s_cselect_b32 s64, 0, s64
ds_read_b64_tr_b16 a[236:237], v51 offset:0
v_mfma_f32_16x16x32_bf16 v[204:207], a[212:215], a[160:163], 0
s_waitcnt lgkmcnt(9)
buffer_load_dwordx4 v56, s[12:15], s38 offen offset:2048  lds
v_mfma_f32_16x16x32_bf16 v[208:211], a[216:219], a[156:159], 0
ds_read_b64_tr_b16 a[238:239], v51 offset:2048
v_mfma_f32_16x16x32_bf16 v[212:215], a[216:219], a[160:163], 0
s_waitcnt lgkmcnt(8)
buffer_load_dwordx4 v57, s[12:15], s38 offen offset:3072  lds
v_mfma_f32_16x16x32_bf16 v[216:219], a[220:223], a[156:159], 0
s_add_u32 m0, s33, 149504
ds_read_b64_tr_b16 a[240:241], v52 offset:0
s_add_u32 s38, s65, 14336
v_mfma_f32_16x16x32_bf16 v[220:223], a[220:223], a[160:163], 0
s_waitcnt lgkmcnt(5)
ds_read_b64_tr_b16 a[242:243], v52 offset:2048
v_mfma_f32_16x16x32_bf16 v[96:99], a[224:227], a[144:147], v[96:99]
ds_read_b64_tr_b16 a[244:245], v53 offset:0
v_mfma_f32_16x16x32_bf16 v[100:103], a[224:227], a[148:151], v[100:103]
ds_read_b64_tr_b16 a[246:247], v53 offset:2048
buffer_load_dwordx4 v66, s[8:11], s38 offen offset:0  lds
v_mfma_f32_16x16x32_bf16 v[224:227], a[224:227], a[152:155], v[224:227]
ds_read_b64_tr_b16 a[248:249], v54 offset:0
v_mfma_f32_16x16x32_bf16 v[104:107], a[228:231], a[144:147], v[104:107]
ds_read_b64_tr_b16 a[250:251], v54 offset:2048
v_mfma_f32_16x16x32_bf16 v[108:111], a[228:231], a[148:151], v[108:111]
buffer_load_dwordx4 v67, s[8:11], s38 offen offset:1024  lds
v_mfma_f32_16x16x32_bf16 v[228:231], a[228:231], a[152:155], v[228:231]
s_waitcnt lgkmcnt(6)
ds_read_b64_tr_b16 a[252:253], v55 offset:0
s_add_u32 m0, s33, 131072
ds_read_b64_tr_b16 a[254:255], v55 offset:2048
v_mfma_f32_16x16x32_bf16 v[112:115], a[232:235], a[144:147], v[112:115]
s_add_u32 s38, s65, s41
ds_read_b64_tr_b16 a[192:193], v48 offset:256
v_mfma_f32_16x16x32_bf16 v[116:119], a[232:235], a[148:151], v[116:119]
ds_read_b64_tr_b16 a[194:195], v48 offset:2304
buffer_load_dwordx4 v66, s[8:11], s38 offen offset:0  lds
v_mfma_f32_16x16x32_bf16 v[232:235], a[232:235], a[152:155], v[232:235]
ds_read_b64_tr_b16 a[196:197], v49 offset:256
v_mfma_f32_16x16x32_bf16 v[120:123], a[236:239], a[144:147], v[120:123]
ds_read_b64_tr_b16 a[198:199], v49 offset:2304
v_mfma_f32_16x16x32_bf16 v[124:127], a[236:239], a[148:151], v[124:127]
buffer_load_dwordx4 v67, s[8:11], s38 offen offset:1024  lds
v_mfma_f32_16x16x32_bf16 v[236:239], a[236:239], a[152:155], v[236:239]
s_waitcnt lgkmcnt(8)
s_add_u32 m0, s33, 147456
ds_read_b64_tr_b16 a[200:201], v50 offset:256
v_mfma_f32_16x16x32_bf16 v[128:131], a[240:243], a[144:147], v[128:131]
buffer_load_dwordx4 v66, s[8:11], s65 offen offset:0  lds
v_mfma_f32_16x16x32_bf16 v[132:135], a[240:243], a[148:151], v[132:135]
ds_read_b64_tr_b16 a[202:203], v50 offset:2304
v_mfma_f32_16x16x32_bf16 v[136:139], a[244:247], a[144:147], v[136:139]
buffer_load_dwordx4 v67, s[8:11], s65 offen offset:1024  lds
v_mfma_f32_16x16x32_bf16 v[140:143], a[244:247], a[148:151], v[140:143]
s_waitcnt lgkmcnt(6)
ds_read_b64_tr_b16 a[204:205], v51 offset:256
s_add_u32 s65, s65, 128
v_mfma_f32_16x16x32_bf16 v[144:147], a[248:251], a[144:147], v[144:147]
s_cmp_eq_u32 s65, 896
s_cselect_b32 s65, 0, s65
ds_read_b64_tr_b16 a[206:207], v51 offset:2304
v_mfma_f32_16x16x32_bf16 v[148:151], a[248:251], a[148:151], v[148:151]
ds_read_b64_tr_b16 a[208:209], v52 offset:256
v_mfma_f32_16x16x32_bf16 v[152:155], a[252:255], a[144:147], v[152:155]
ds_read_b64_tr_b16 a[210:211], v52 offset:2304
v_mfma_f32_16x16x32_bf16 v[156:159], a[252:255], a[148:151], v[156:159]
s_waitcnt lgkmcnt(6)
s_waitcnt vmcnt(14)
ds_read_b128 a[132:135], v70 offset:2048
v_mfma_f32_16x16x32_bf16 v[160:163], a[192:195], a[144:147], v[160:163]
ds_read_b128 a[136:139], v68 offset:16384
v_mfma_f32_16x16x32_bf16 v[164:167], a[192:195], a[148:151], v[164:167]
ds_read_b128 a[140:143], v68 offset:18432
ds_read_b128 a[120:123], v71 offset:2048
ds_read_b128 a[124:127], v69 offset:16384
ds_read_b128 a[128:131], v69 offset:18432
v_mfma_f32_16x16x32_bf16 v[240:243], a[192:195], a[152:155], v[240:243]
ds_read_b64_tr_b16 a[212:213], v53 offset:256
ds_read_b64_tr_b16 a[214:215], v53 offset:2304
v_mfma_f32_16x16x32_bf16 v[168:171], a[196:199], a[144:147], v[168:171]
ds_read_b64_tr_b16 a[216:217], v54 offset:256
v_mfma_f32_16x16x32_bf16 v[172:175], a[196:199], a[148:151], v[172:175]
ds_read_b64_tr_b16 a[218:219], v54 offset:2304
v_mfma_f32_16x16x32_bf16 v[244:247], a[196:199], a[152:155], v[244:247]
s_waitcnt vmcnt(10)
s_barrier
s_waitcnt lgkmcnt(12)
ds_read_b64_tr_b16 a[220:221], v55 offset:256
s_add_u32 m0, s33, 114688
ds_read_b64_tr_b16 a[222:223], v55 offset:2304
v_mfma_f32_16x16x32_bf16 v[176:179], a[200:203], a[144:147], v[176:179]
s_add_u32 s38, s64, 30720
ds_read_b64_tr_b16 a[224:225], v48 offset:16384
v_mfma_f32_16x16x32_bf16 v[180:183], a[200:203], a[148:151], v[180:183]
ds_read_b64_tr_b16 a[226:227], v48 offset:18432
v_mfma_f32_16x16x32_bf16 v[248:251], a[200:203], a[152:155], v[248:251]
ds_read_b64_tr_b16 a[228:229], v49 offset:16384
v_mfma_f32_16x16x32_bf16 v[184:187], a[204:207], a[144:147], v[184:187]
ds_read_b64_tr_b16 a[230:231], v49 offset:18432
v_mfma_f32_16x16x32_bf16 v[188:191], a[204:207], a[148:151], v[188:191]
buffer_load_dwordx4 v56, s[12:15], s64 offen offset:0  lds
v_mfma_f32_16x16x32_bf16 v[252:255], a[204:207], a[152:155], v[252:255]
s_waitcnt lgkmcnt(8)
ds_read_b64_tr_b16 a[232:233], v50 offset:16384
v_mfma_f32_16x16x32_bf16 v[192:195], a[208:211], a[144:147], v[192:195]
ds_read_b64_tr_b16 a[234:235], v50 offset:18432
v_mfma_f32_16x16x32_bf16 v[196:199], a[208:211], a[148:151], v[196:199]
buffer_load_dwordx4 v57, s[12:15], s64 offen offset:1024  lds
v_mfma_f32_16x16x32_bf16 v[200:203], a[212:215], a[144:147], v[200:203]
s_add_u32 s64, s64, 262144
ds_read_b64_tr_b16 a[236:237], v51 offset:16384
v_mfma_f32_16x16x32_bf16 v[204:207], a[212:215], a[148:151], v[204:207]
s_waitcnt lgkmcnt(7)
ds_read_b64_tr_b16 a[238:239], v51 offset:18432
v_mfma_f32_16x16x32_bf16 v[208:211], a[216:219], a[144:147], v[208:211]
s_cmp_eq_u32 s64, 3670016
s_cselect_b32 s64, 0, s64
ds_read_b64_tr_b16 a[240:241], v52 offset:16384
v_mfma_f32_16x16x32_bf16 v[212:215], a[216:219], a[148:151], v[212:215]
buffer_load_dwordx4 v56, s[12:15], s38 offen offset:2048  lds
v_mfma_f32_16x16x32_bf16 v[216:219], a[220:223], a[144:147], v[216:219]
ds_read_b64_tr_b16 a[242:243], v52 offset:18432
v_mfma_f32_16x16x32_bf16 v[220:223], a[220:223], a[148:151], v[220:223]
s_waitcnt lgkmcnt(6)
ds_read_b64_tr_b16 a[244:245], v53 offset:16384
v_mfma_f32_16x16x32_bf16 v[96:99], a[224:227], a[132:135], v[96:99]
ds_read_b64_tr_b16 a[246:247], v53 offset:18432
v_mfma_f32_16x16x32_bf16 v[100:103], a[224:227], a[136:139], v[100:103]
buffer_load_dwordx4 v57, s[12:15], s38 offen offset:3072  lds
v_mfma_f32_16x16x32_bf16 v[224:227], a[224:227], a[140:143], v[224:227]
s_add_u32 m0, s33, 0
ds_read_b64_tr_b16 a[248:249], v54 offset:16384
s_add_u32 s38, s64, 30720
v_mfma_f32_16x16x32_bf16 v[104:107], a[228:231], a[132:135], v[104:107]
ds_read_b64_tr_b16 a[250:251], v54 offset:18432
v_mfma_f32_16x16x32_bf16 v[108:111], a[228:231], a[136:139], v[108:111]
ds_read_b64_tr_b16 a[252:253], v55 offset:16384
v_mfma_f32_16x16x32_bf16 v[228:231], a[228:231], a[140:143], v[228:231]
s_waitcnt lgkmcnt(7)
ds_read_b64_tr_b16 a[254:255], v55 offset:18432
v_mfma_f32_16x16x32_bf16 v[112:115], a[232:235], a[132:135], v[112:115]
buffer_load_dwordx4 v56, s[12:15], s64 offen offset:0  lds
v_mfma_f32_16x16x32_bf16 v[116:119], a[232:235], a[136:139], v[116:119]
ds_read_b64_tr_b16 a[192:193], v48 offset:16640
ds_read_b64_tr_b16 a[194:195], v48 offset:18688
v_mfma_f32_16x16x32_bf16 v[232:235], a[232:235], a[140:143], v[232:235]
ds_read_b64_tr_b16 a[196:197], v49 offset:16640
v_mfma_f32_16x16x32_bf16 v[120:123], a[236:239], a[132:135], v[120:123]
ds_read_b64_tr_b16 a[198:199], v49 offset:18688
v_mfma_f32_16x16x32_bf16 v[124:127], a[236:239], a[136:139], v[124:127]
buffer_load_dwordx4 v57, s[12:15], s64 offen offset:1024  lds
v_mfma_f32_16x16x32_bf16 v[236:239], a[236:239], a[140:143], v[236:239]
s_waitcnt lgkmcnt(8)
ds_read_b64_tr_b16 a[200:201], v50 offset:16640
s_add_u32 s64, s64, 262144
v_mfma_f32_16x16x32_bf16 v[128:131], a[240:243], a[132:135], v[128:131]
s_cmp_eq_u32 s64, 3670016
s_cselect_b32 s64, 0, s64
ds_read_b64_tr_b16 a[202:203], v50 offset:18688
v_mfma_f32_16x16x32_bf16 v[132:135], a[240:243], a[136:139], v[132:135]
buffer_load_dwordx4 v56, s[12:15], s38 offen offset:2048  lds
v_mfma_f32_16x16x32_bf16 v[136:139], a[244:247], a[132:135], v[136:139]
ds_read_b64_tr_b16 a[204:205], v51 offset:16640
v_mfma_f32_16x16x32_bf16 v[140:143], a[244:247], a[136:139], v[140:143]
s_waitcnt lgkmcnt(7)
ds_read_b64_tr_b16 a[206:207], v51 offset:18688
v_mfma_f32_16x16x32_bf16 v[144:147], a[248:251], a[132:135], v[144:147]
buffer_load_dwordx4 v57, s[12:15], s38 offen offset:3072  lds
v_mfma_f32_16x16x32_bf16 v[148:151], a[248:251], a[136:139], v[148:151]
ds_read_b64_tr_b16 a[208:209], v52 offset:16640
v_mfma_f32_16x16x32_bf16 v[152:155], a[252:255], a[132:135], v[152:155]
ds_read_b64_tr_b16 a[210:211], v52 offset:18688
v_mfma_f32_16x16x32_bf16 v[156:159], a[252:255], a[136:139], v[156:159]
s_waitcnt lgkmcnt(6)
ds_read_b64_tr_b16 a[212:213], v53 offset:16640
v_mfma_f32_16x16x32_bf16 v[160:163], a[192:195], a[132:135], v[160:163]
ds_read_b64_tr_b16 a[214:215], v53 offset:18688
v_mfma_f32_16x16x32_bf16 v[164:167], a[192:195], a[136:139], v[164:167]
ds_read_b64_tr_b16 a[216:217], v54 offset:16640
v_mfma_f32_16x16x32_bf16 v[240:243], a[192:195], a[140:143], v[240:243]
ds_read_b64_tr_b16 a[218:219], v54 offset:18688
v_mfma_f32_16x16x32_bf16 v[168:171], a[196:199], a[132:135], v[168:171]
ds_read_b64_tr_b16 a[220:221], v55 offset:16640
v_mfma_f32_16x16x32_bf16 v[172:175], a[196:199], a[136:139], v[172:175]
ds_read_b64_tr_b16 a[222:223], v55 offset:18688
v_mfma_f32_16x16x32_bf16 v[244:247], a[196:199], a[140:143], v[244:247]
s_waitcnt vmcnt(14)
s_barrier
s_waitcnt lgkmcnt(8)
v_mfma_f32_16x16x32_bf16 v[176:179], a[200:203], a[132:135], v[176:179]
s_add_u32 m0, s33, 49152
ds_read_b64_tr_b16 a[224:225], v48 offset:32768
s_add_u32 s38, s64, 30720
v_mfma_f32_16x16x32_bf16 v[180:183], a[200:203], a[136:139], v[180:183]
ds_read_b64_tr_b16 a[226:227], v48 offset:34816
v_mfma_f32_16x16x32_bf16 v[248:251], a[200:203], a[140:143], v[248:251]
buffer_load_dwordx4 v56, s[12:15], s64 offen offset:0  lds
v_mfma_f32_16x16x32_bf16 v[184:187], a[204:207], a[132:135], v[184:187]
ds_read_b64_tr_b16 a[228:229], v49 offset:32768
v_mfma_f32_16x16x32_bf16 v[188:191], a[204:207], a[136:139], v[188:191]
ds_read_b64_tr_b16 a[230:231], v49 offset:34816
v_mfma_f32_16x16x32_bf16 v[252:255], a[204:207], a[140:143], v[252:255]
s_waitcnt lgkmcnt(8)
buffer_load_dwordx4 v57, s[12:15], s64 offen offset:1024  lds
v_mfma_f32_16x16x32_bf16 v[192:195], a[208:211], a[132:135], v[192:195]
s_add_u32 s64, s64, 262144
ds_read_b64_tr_b16 a[232:233], v50 offset:32768
v_mfma_f32_16x16x32_bf16 v[196:199], a[208:211], a[136:139], v[196:199]
s_cmp_eq_u32 s64, 3670016
s_cselect_b32 s64, 0, s64
ds_read_b64_tr_b16 a[234:235], v50 offset:34816
v_mfma_f32_16x16x32_bf16 v[200:203], a[212:215], a[132:135], v[200:203]
buffer_load_dwordx4 v56, s[12:15], s38 offen offset:2048  lds
v_mfma_f32_16x16x32_bf16 v[204:207], a[212:215], a[136:139], v[204:207]
s_waitcnt lgkmcnt(6)
ds_read_b64_tr_b16 a[236:237], v51 offset:32768
v_mfma_f32_16x16x32_bf16 v[208:211], a[216:219], a[132:135], v[208:211]
ds_read_b64_tr_b16 a[238:239], v51 offset:34816
v_mfma_f32_16x16x32_bf16 v[212:215], a[216:219], a[136:139], v[212:215]
buffer_load_dwordx4 v57, s[12:15], s38 offen offset:3072  lds
v_mfma_f32_16x16x32_bf16 v[216:219], a[220:223], a[132:135], v[216:219]
s_add_u32 m0, s33, 16384
ds_read_b64_tr_b16 a[240:241], v52 offset:32768
s_add_u32 s38, s65, 14336
v_mfma_f32_16x16x32_bf16 v[220:223], a[220:223], a[136:139], v[220:223]
s_waitcnt lgkmcnt(5)
ds_read_b64_tr_b16 a[242:243], v52 offset:34816
v_mfma_f32_16x16x32_bf16 v[96:99], a[224:227], a[120:123], v[96:99]
ds_read_b64_tr_b16 a[244:245], v53 offset:32768
v_mfma_f32_16x16x32_bf16 v[100:103], a[224:227], a[124:127], v[100:103]
ds_read_b64_tr_b16 a[246:247], v53 offset:34816
buffer_load_dwordx4 v66, s[8:11], s38 offen offset:0  lds
v_mfma_f32_16x16x32_bf16 v[224:227], a[224:227], a[128:131], v[224:227]
ds_read_b64_tr_b16 a[248:249], v54 offset:32768
v_mfma_f32_16x16x32_bf16 v[104:107], a[228:231], a[120:123], v[104:107]
ds_read_b64_tr_b16 a[250:251], v54 offset:34816
v_mfma_f32_16x16x32_bf16 v[108:111], a[228:231], a[124:127], v[108:111]
buffer_load_dwordx4 v67, s[8:11], s38 offen offset:1024  lds
v_mfma_f32_16x16x32_bf16 v[228:231], a[228:231], a[128:131], v[228:231]
s_waitcnt lgkmcnt(6)
ds_read_b64_tr_b16 a[252:253], v55 offset:32768
s_add_u32 m0, s33, 18432
ds_read_b64_tr_b16 a[254:255], v55 offset:34816
v_mfma_f32_16x16x32_bf16 v[112:115], a[232:235], a[120:123], v[112:115]
s_add_u32 s38, s65, s41
ds_read_b64_tr_b16 a[192:193], v48 offset:33024
v_mfma_f32_16x16x32_bf16 v[116:119], a[232:235], a[124:127], v[116:119]
ds_read_b64_tr_b16 a[194:195], v48 offset:35072
buffer_load_dwordx4 v66, s[8:11], s38 offen offset:0  lds
v_mfma_f32_16x16x32_bf16 v[232:235], a[232:235], a[128:131], v[232:235]
ds_read_b64_tr_b16 a[196:197], v49 offset:33024
v_mfma_f32_16x16x32_bf16 v[120:123], a[236:239], a[120:123], v[120:123]
ds_read_b64_tr_b16 a[198:199], v49 offset:35072
v_mfma_f32_16x16x32_bf16 v[124:127], a[236:239], a[124:127], v[124:127]
buffer_load_dwordx4 v67, s[8:11], s38 offen offset:1024  lds
v_mfma_f32_16x16x32_bf16 v[236:239], a[236:239], a[128:131], v[236:239]
s_waitcnt lgkmcnt(8)
s_add_u32 m0, s33, 133120
ds_read_b64_tr_b16 a[200:201], v50 offset:33024
v_mfma_f32_16x16x32_bf16 v[128:131], a[240:243], a[120:123], v[128:131]
buffer_load_dwordx4 v66, s[8:11], s65 offen offset:0  lds
v_mfma_f32_16x16x32_bf16 v[132:135], a[240:243], a[124:127], v[132:135]
ds_read_b64_tr_b16 a[202:203], v50 offset:35072
v_mfma_f32_16x16x32_bf16 v[136:139], a[244:247], a[120:123], v[136:139]
s_waitcnt vmcnt(17)
ds_read_b128 a[108:111], v70 offset:16384
v_mfma_f32_16x16x32_bf16 v[140:143], a[244:247], a[124:127], v[140:143]
s_waitcnt lgkmcnt(7)
ds_read_b128 a[112:115], v70 offset:18432
ds_read_b128 a[116:119], v70 offset:0
ds_read_b128 a[96:99], v71 offset:16384
ds_read_b128 a[100:103], v71 offset:18432
ds_read_b128 a[104:107], v71 offset:0
v_mfma_f32_16x16x32_bf16 v[144:147], a[248:251], a[120:123], v[144:147]
buffer_load_dwordx4 v67, s[8:11], s65 offen offset:1024  lds
v_mfma_f32_16x16x32_bf16 v[148:151], a[248:251], a[124:127], v[148:151]
ds_read_b64_tr_b16 a[204:205], v51 offset:33024
s_add_u32 s65, s65, 128
ds_read_b64_tr_b16 a[206:207], v51 offset:35072
v_mfma_f32_16x16x32_bf16 v[152:155], a[252:255], a[120:123], v[152:155]
s_cmp_eq_u32 s65, 896
s_cselect_b32 s65, 0, s65
ds_read_b64_tr_b16 a[208:209], v52 offset:33024
v_mfma_f32_16x16x32_bf16 v[156:159], a[252:255], a[124:127], v[156:159]
s_waitcnt lgkmcnt(11)
ds_read_b64_tr_b16 a[210:211], v52 offset:35072
v_mfma_f32_16x16x32_bf16 v[160:163], a[192:195], a[120:123], v[160:163]
ds_read_b64_tr_b16 a[212:213], v53 offset:33024
v_mfma_f32_16x16x32_bf16 v[164:167], a[192:195], a[124:127], v[164:167]
ds_read_b64_tr_b16 a[214:215], v53 offset:35072
v_mfma_f32_16x16x32_bf16 v[240:243], a[192:195], a[128:131], v[240:243]
ds_read_b64_tr_b16 a[216:217], v54 offset:33024
v_mfma_f32_16x16x32_bf16 v[168:171], a[196:199], a[120:123], v[168:171]
ds_read_b64_tr_b16 a[218:219], v54 offset:35072
v_mfma_f32_16x16x32_bf16 v[172:175], a[196:199], a[124:127], v[172:175]
ds_read_b64_tr_b16 a[220:221], v55 offset:33024
v_mfma_f32_16x16x32_bf16 v[244:247], a[196:199], a[128:131], v[244:247]
s_waitcnt vmcnt(14)
s_barrier
s_waitcnt lgkmcnt(7)
ds_read_b64_tr_b16 a[222:223], v55 offset:35072
v_mfma_f32_16x16x32_bf16 v[176:179], a[200:203], a[120:123], v[176:179]
s_add_u32 m0, s33, 65536
ds_read_b64_tr_b16 a[224:225], v48 offset:49152
s_add_u32 s38, s64, 30720
v_mfma_f32_16x16x32_bf16 v[180:183], a[200:203], a[124:127], v[180:183]
ds_read_b64_tr_b16 a[226:227], v48 offset:51200
v_mfma_f32_16x16x32_bf16 v[248:251], a[200:203], a[128:131], v[248:251]
ds_read_b64_tr_b16 a[228:229], v49 offset:49152
v_mfma_f32_16x16x32_bf16 v[184:187], a[204:207], a[120:123], v[184:187]
ds_read_b64_tr_b16 a[230:231], v49 offset:51200
v_mfma_f32_16x16x32_bf16 v[188:191], a[204:207], a[124:127], v[188:191]
buffer_load_dwordx4 v56, s[12:15], s64 offen offset:0  lds
v_mfma_f32_16x16x32_bf16 v[252:255], a[204:207], a[128:131], v[252:255]
s_waitcnt lgkmcnt(8)
ds_read_b64_tr_b16 a[232:233], v50 offset:49152
v_mfma_f32_16x16x32_bf16 v[192:195], a[208:211], a[120:123], v[192:195]
ds_read_b64_tr_b16 a[234:235], v50 offset:51200
v_mfma_f32_16x16x32_bf16 v[196:199], a[208:211], a[124:127], v[196:199]
buffer_load_dwordx4 v57, s[12:15], s64 offen offset:1024  lds
v_mfma_f32_16x16x32_bf16 v[200:203], a[212:215], a[120:123], v[200:203]
s_add_u32 s64, s64, 262144
ds_read_b64_tr_b16 a[236:237], v51 offset:49152
v_mfma_f32_16x16x32_bf16 v[204:207], a[212:215], a[124:127], v[204:207]
s_waitcnt lgkmcnt(7)
ds_read_b64_tr_b16 a[238:239], v51 offset:51200
v_mfma_f32_16x16x32_bf16 v[208:211], a[216:219], a[120:123], v[208:211]
s_cmp_eq_u32 s64, 3670016
s_cselect_b32 s64, 0, s64
ds_read_b64_tr_b16 a[240:241], v52 offset:49152
v_mfma_f32_16x16x32_bf16 v[212:215], a[216:219], a[124:127], v[212:215]
buffer_load_dwordx4 v56, s[12:15], s38 offen offset:2048  lds
v_mfma_f32_16x16x32_bf16 v[216:219], a[220:223], a[120:123], v[216:219]
ds_read_b64_tr_b16 a[242:243], v52 offset:51200
v_mfma_f32_16x16x32_bf16 v[220:223], a[220:223], a[124:127], v[220:223]
s_waitcnt lgkmcnt(6)
ds_read_b64_tr_b16 a[244:245], v53 offset:49152
v_mfma_f32_16x16x32_bf16 v[96:99], a[224:227], a[108:111], v[96:99]
ds_read_b64_tr_b16 a[246:247], v53 offset:51200
v_mfma_f32_16x16x32_bf16 v[100:103], a[224:227], a[112:115], v[100:103]
buffer_load_dwordx4 v57, s[12:15], s38 offen offset:3072  lds
v_mfma_f32_16x16x32_bf16 v[224:227], a[224:227], a[116:119], v[224:227]
s_add_u32 m0, s33, 32768
ds_read_b64_tr_b16 a[248:249], v54 offset:49152
s_add_u32 s38, s64, 30720
v_mfma_f32_16x16x32_bf16 v[104:107], a[228:231], a[108:111], v[104:107]
ds_read_b64_tr_b16 a[250:251], v54 offset:51200
v_mfma_f32_16x16x32_bf16 v[108:111], a[228:231], a[112:115], v[108:111]
ds_read_b64_tr_b16 a[252:253], v55 offset:49152
v_mfma_f32_16x16x32_bf16 v[228:231], a[228:231], a[116:119], v[228:231]
s_waitcnt lgkmcnt(7)
ds_read_b64_tr_b16 a[254:255], v55 offset:51200
v_mfma_f32_16x16x32_bf16 v[112:115], a[232:235], a[108:111], v[112:115]
buffer_load_dwordx4 v56, s[12:15], s64 offen offset:0  lds
v_mfma_f32_16x16x32_bf16 v[116:119], a[232:235], a[112:115], v[116:119]
ds_read_b64_tr_b16 a[192:193], v48 offset:49408
ds_read_b64_tr_b16 a[194:195], v48 offset:51456
v_mfma_f32_16x16x32_bf16 v[232:235], a[232:235], a[116:119], v[232:235]
ds_read_b64_tr_b16 a[196:197], v49 offset:49408
v_mfma_f32_16x16x32_bf16 v[120:123], a[236:239], a[108:111], v[120:123]
ds_read_b64_tr_b16 a[198:199], v49 offset:51456
v_mfma_f32_16x16x32_bf16 v[124:127], a[236:239], a[112:115], v[124:127]
buffer_load_dwordx4 v57, s[12:15], s64 offen offset:1024  lds
v_mfma_f32_16x16x32_bf16 v[236:239], a[236:239], a[116:119], v[236:239]
s_waitcnt lgkmcnt(8)
ds_read_b64_tr_b16 a[200:201], v50 offset:49408
s_add_u32 s64, s64, 262144
v_mfma_f32_16x16x32_bf16 v[128:131], a[240:243], a[108:111], v[128:131]
s_cmp_eq_u32 s64, 3670016
s_cselect_b32 s64, 0, s64
ds_read_b64_tr_b16 a[202:203], v50 offset:51456
v_mfma_f32_16x16x32_bf16 v[132:135], a[240:243], a[112:115], v[132:135]
buffer_load_dwordx4 v56, s[12:15], s38 offen offset:2048  lds
v_mfma_f32_16x16x32_bf16 v[136:139], a[244:247], a[108:111], v[136:139]
ds_read_b64_tr_b16 a[204:205], v51 offset:49408
v_mfma_f32_16x16x32_bf16 v[140:143], a[244:247], a[112:115], v[140:143]
s_waitcnt lgkmcnt(7)
ds_read_b64_tr_b16 a[206:207], v51 offset:51456
v_mfma_f32_16x16x32_bf16 v[144:147], a[248:251], a[108:111], v[144:147]
buffer_load_dwordx4 v57, s[12:15], s38 offen offset:3072  lds
v_mfma_f32_16x16x32_bf16 v[148:151], a[248:251], a[112:115], v[148:151]
ds_read_b64_tr_b16 a[208:209], v52 offset:49408
v_mfma_f32_16x16x32_bf16 v[152:155], a[252:255], a[108:111], v[152:155]
ds_read_b64_tr_b16 a[210:211], v52 offset:51456
v_mfma_f32_16x16x32_bf16 v[156:159], a[252:255], a[112:115], v[156:159]
s_waitcnt lgkmcnt(6)
ds_read_b64_tr_b16 a[212:213], v53 offset:49408
v_mfma_f32_16x16x32_bf16 v[160:163], a[192:195], a[108:111], v[160:163]
ds_read_b64_tr_b16 a[214:215], v53 offset:51456
v_mfma_f32_16x16x32_bf16 v[164:167], a[192:195], a[112:115], v[164:167]
ds_read_b64_tr_b16 a[216:217], v54 offset:49408
v_mfma_f32_16x16x32_bf16 v[240:243], a[192:195], a[116:119], v[240:243]
ds_read_b64_tr_b16 a[218:219], v54 offset:51456
v_mfma_f32_16x16x32_bf16 v[168:171], a[196:199], a[108:111], v[168:171]
ds_read_b64_tr_b16 a[220:221], v55 offset:49408
v_mfma_f32_16x16x32_bf16 v[172:175], a[196:199], a[112:115], v[172:175]
ds_read_b64_tr_b16 a[222:223], v55 offset:51456
v_mfma_f32_16x16x32_bf16 v[244:247], a[196:199], a[116:119], v[244:247]
s_waitcnt vmcnt(18)
s_barrier
s_waitcnt lgkmcnt(8)
v_mfma_f32_16x16x32_bf16 v[176:179], a[200:203], a[108:111], v[176:179]
s_add_u32 m0, s33, 81920
ds_read_b64_tr_b16 a[224:225], v1 offset:0
s_add_u32 s38, s64, 30720
v_mfma_f32_16x16x32_bf16 v[180:183], a[200:203], a[112:115], v[180:183]
ds_read_b64_tr_b16 a[226:227], v1 offset:2048
v_mfma_f32_16x16x32_bf16 v[248:251], a[200:203], a[116:119], v[248:251]
buffer_load_dwordx4 v56, s[12:15], s64 offen offset:0  lds
v_mfma_f32_16x16x32_bf16 v[184:187], a[204:207], a[108:111], v[184:187]
ds_read_b64_tr_b16 a[228:229], v2 offset:0
v_mfma_f32_16x16x32_bf16 v[188:191], a[204:207], a[112:115], v[188:191]
ds_read_b64_tr_b16 a[230:231], v2 offset:2048
v_mfma_f32_16x16x32_bf16 v[252:255], a[204:207], a[116:119], v[252:255]
s_waitcnt lgkmcnt(8)
buffer_load_dwordx4 v57, s[12:15], s64 offen offset:1024  lds
v_mfma_f32_16x16x32_bf16 v[192:195], a[208:211], a[108:111], v[192:195]
s_add_u32 s64, s64, 262144
ds_read_b64_tr_b16 a[232:233], v3 offset:0
v_mfma_f32_16x16x32_bf16 v[196:199], a[208:211], a[112:115], v[196:199]
s_cmp_eq_u32 s64, 3670016
s_cselect_b32 s64, 0, s64
ds_read_b64_tr_b16 a[234:235], v3 offset:2048
v_mfma_f32_16x16x32_bf16 v[200:203], a[212:215], a[108:111], v[200:203]
buffer_load_dwordx4 v56, s[12:15], s38 offen offset:2048  lds
v_mfma_f32_16x16x32_bf16 v[204:207], a[212:215], a[112:115], v[204:207]
s_waitcnt lgkmcnt(6)
ds_read_b64_tr_b16 a[236:237], v4 offset:0
v_mfma_f32_16x16x32_bf16 v[208:211], a[216:219], a[108:111], v[208:211]
ds_read_b64_tr_b16 a[238:239], v4 offset:2048
v_mfma_f32_16x16x32_bf16 v[212:215], a[216:219], a[112:115], v[212:215]
buffer_load_dwordx4 v57, s[12:15], s38 offen offset:3072  lds
v_mfma_f32_16x16x32_bf16 v[216:219], a[220:223], a[108:111], v[216:219]
s_add_u32 m0, s33, 149504
ds_read_b64_tr_b16 a[240:241], v5 offset:0
s_add_u32 s38, s65, 14336
v_mfma_f32_16x16x32_bf16 v[220:223], a[220:223], a[112:115], v[220:223]
s_waitcnt lgkmcnt(5)
ds_read_b64_tr_b16 a[242:243], v5 offset:2048
s_waitcnt vmcnt(12)
ds_read_b128 a[84:87], v70 offset:2048
ds_read_b128 a[88:91], v68 offset:16384
ds_read_b128 a[92:95], v68 offset:18432
ds_read_b128 a[72:75], v71 offset:2048
ds_read_b128 a[76:79], v69 offset:16384
ds_read_b128 a[80:83], v69 offset:18432
v_mfma_f32_16x16x32_bf16 v[96:99], a[224:227], a[96:99], v[96:99]
ds_read_b64_tr_b16 a[244:245], v6 offset:0
v_mfma_f32_16x16x32_bf16 v[100:103], a[224:227], a[100:103], v[100:103]
ds_read_b64_tr_b16 a[246:247], v6 offset:2048
buffer_load_dwordx4 v66, s[8:11], s38 offen offset:0  lds
v_mfma_f32_16x16x32_bf16 v[224:227], a[224:227], a[104:107], v[224:227]
ds_read_b64_tr_b16 a[248:249], v7 offset:0
v_mfma_f32_16x16x32_bf16 v[104:107], a[228:231], a[96:99], v[104:107]
ds_read_b64_tr_b16 a[250:251], v7 offset:2048
v_mfma_f32_16x16x32_bf16 v[108:111], a[228:231], a[100:103], v[108:111]
buffer_load_dwordx4 v67, s[8:11], s38 offen offset:1024  lds
v_mfma_f32_16x16x32_bf16 v[228:231], a[228:231], a[104:107], v[228:231]
s_waitcnt lgkmcnt(12)
ds_read_b64_tr_b16 a[252:253], v8 offset:0
s_add_u32 m0, s33, 131072
ds_read_b64_tr_b16 a[254:255], v8 offset:2048
v_mfma_f32_16x16x32_bf16 v[112:115], a[232:235], a[96:99], v[112:115]
s_add_u32 s38, s65, s41
ds_read_b64_tr_b16 a[192:193], v1 offset:256
v_mfma_f32_16x16x32_bf16 v[116:119], a[232:235], a[100:103], v[116:119]
ds_read_b64_tr_b16 a[194:195], v1 offset:2304
buffer_load_dwordx4 v66, s[8:11], s38 offen offset:0  lds
v_mfma_f32_16x16x32_bf16 v[232:235], a[232:235], a[104:107], v[232:235]
ds_read_b64_tr_b16 a[196:197], v2 offset:256
v_mfma_f32_16x16x32_bf16 v[120:123], a[236:239], a[96:99], v[120:123]
ds_read_b64_tr_b16 a[198:199], v2 offset:2304
v_mfma_f32_16x16x32_bf16 v[124:127], a[236:239], a[100:103], v[124:127]
buffer_load_dwordx4 v67, s[8:11], s38 offen offset:1024  lds
v_mfma_f32_16x16x32_bf16 v[236:239], a[236:239], a[104:107], v[236:239]
s_waitcnt lgkmcnt(8)
s_add_u32 m0, s33, 147456
ds_read_b64_tr_b16 a[200:201], v3 offset:256
v_mfma_f32_16x16x32_bf16 v[128:131], a[240:243], a[96:99], v[128:131]
buffer_load_dwordx4 v66, s[8:11], s65 offen offset:0  lds
v_mfma_f32_16x16x32_bf16 v[132:135], a[240:243], a[100:103], v[132:135]
ds_read_b64_tr_b16 a[202:203], v3 offset:2304
v_mfma_f32_16x16x32_bf16 v[136:139], a[244:247], a[96:99], v[136:139]
buffer_load_dwordx4 v67, s[8:11], s65 offen offset:1024  lds
v_mfma_f32_16x16x32_bf16 v[140:143], a[244:247], a[100:103], v[140:143]
s_waitcnt lgkmcnt(6)
ds_read_b64_tr_b16 a[204:205], v4 offset:256
s_add_u32 s65, s65, 128
v_mfma_f32_16x16x32_bf16 v[144:147], a[248:251], a[96:99], v[144:147]
s_cmp_eq_u32 s65, 896
s_cselect_b32 s65, 0, s65
ds_read_b64_tr_b16 a[206:207], v4 offset:2304
v_mfma_f32_16x16x32_bf16 v[148:151], a[248:251], a[100:103], v[148:151]
ds_read_b64_tr_b16 a[208:209], v5 offset:256
v_mfma_f32_16x16x32_bf16 v[152:155], a[252:255], a[96:99], v[152:155]
ds_read_b64_tr_b16 a[210:211], v5 offset:2304
v_mfma_f32_16x16x32_bf16 v[156:159], a[252:255], a[100:103], v[156:159]
s_waitcnt lgkmcnt(6)
ds_read_b64_tr_b16 a[212:213], v6 offset:256
v_mfma_f32_16x16x32_bf16 v[160:163], a[192:195], a[96:99], v[160:163]
ds_read_b64_tr_b16 a[214:215], v6 offset:2304
v_mfma_f32_16x16x32_bf16 v[164:167], a[192:195], a[100:103], v[164:167]
ds_read_b64_tr_b16 a[216:217], v7 offset:256
v_mfma_f32_16x16x32_bf16 v[240:243], a[192:195], a[104:107], v[240:243]
ds_read_b64_tr_b16 a[218:219], v7 offset:2304
v_mfma_f32_16x16x32_bf16 v[168:171], a[196:199], a[96:99], v[168:171]
ds_read_b64_tr_b16 a[220:221], v8 offset:256
v_mfma_f32_16x16x32_bf16 v[172:175], a[196:199], a[100:103], v[172:175]
ds_read_b64_tr_b16 a[222:223], v8 offset:2304
v_mfma_f32_16x16x32_bf16 v[244:247], a[196:199], a[104:107], v[244:247]
s_barrier
s_waitcnt lgkmcnt(8)
ds_read_b64_tr_b16 a[224:225], v1 offset:49152
v_mfma_f32_16x16x32_bf16 v[176:179], a[200:203], a[96:99], v[176:179]
s_add_u32 m0, s33, 16384
ds_read_b64_tr_b16 a[226:227], v1 offset:51200
s_add_u32 s38, s65, 14336
v_mfma_f32_16x16x32_bf16 v[180:183], a[200:203], a[100:103], v[180:183]
buffer_load_dwordx4 v66, s[8:11], s38 offen offset:0  lds
v_mfma_f32_16x16x32_bf16 v[248:251], a[200:203], a[104:107], v[248:251]
ds_read_b64_tr_b16 a[228:229], v2 offset:49152
v_mfma_f32_16x16x32_bf16 v[184:187], a[204:207], a[96:99], v[184:187]
ds_read_b64_tr_b16 a[230:231], v2 offset:51200
v_mfma_f32_16x16x32_bf16 v[188:191], a[204:207], a[100:103], v[188:191]
buffer_load_dwordx4 v67, s[8:11], s38 offen offset:1024  lds
v_mfma_f32_16x16x32_bf16 v[252:255], a[204:207], a[104:107], v[252:255]
s_waitcnt lgkmcnt(8)
ds_read_b64_tr_b16 a[232:233], v3 offset:49152
s_add_u32 m0, s33, 18432
v_mfma_f32_16x16x32_bf16 v[192:195], a[208:211], a[96:99], v[192:195]
s_add_u32 s38, s65, s41
ds_read_b64_tr_b16 a[234:235], v3 offset:51200
v_mfma_f32_16x16x32_bf16 v[196:199], a[208:211], a[100:103], v[196:199]
buffer_load_dwordx4 v66, s[8:11], s38 offen offset:0  lds
v_mfma_f32_16x16x32_bf16 v[200:203], a[212:215], a[96:99], v[200:203]
ds_read_b64_tr_b16 a[236:237], v4 offset:49152
v_mfma_f32_16x16x32_bf16 v[204:207], a[212:215], a[100:103], v[204:207]
s_waitcnt lgkmcnt(7)
ds_read_b64_tr_b16 a[238:239], v4 offset:51200
v_mfma_f32_16x16x32_bf16 v[208:211], a[216:219], a[96:99], v[208:211]
buffer_load_dwordx4 v67, s[8:11], s38 offen offset:1024  lds
v_mfma_f32_16x16x32_bf16 v[212:215], a[216:219], a[100:103], v[212:215]
s_add_u32 m0, s33, 133120
ds_read_b64_tr_b16 a[240:241], v5 offset:49152
v_mfma_f32_16x16x32_bf16 v[216:219], a[220:223], a[96:99], v[216:219]
ds_read_b64_tr_b16 a[242:243], v5 offset:51200
v_mfma_f32_16x16x32_bf16 v[220:223], a[220:223], a[100:103], v[220:223]
s_waitcnt lgkmcnt(6)
ds_read_b64_tr_b16 a[244:245], v6 offset:49152
v_mfma_f32_16x16x32_bf16 v[96:99], a[224:227], a[84:87], v[96:99]
ds_read_b64_tr_b16 a[246:247], v6 offset:51200
v_mfma_f32_16x16x32_bf16 v[100:103], a[224:227], a[88:91], v[100:103]
buffer_load_dwordx4 v66, s[8:11], s65 offen offset:0  lds
v_mfma_f32_16x16x32_bf16 v[224:227], a[224:227], a[92:95], v[224:227]
ds_read_b64_tr_b16 a[248:249], v7 offset:49152
v_mfma_f32_16x16x32_bf16 v[104:107], a[228:231], a[84:87], v[104:107]
ds_read_b64_tr_b16 a[250:251], v7 offset:51200
v_mfma_f32_16x16x32_bf16 v[108:111], a[228:231], a[88:91], v[108:111]
buffer_load_dwordx4 v67, s[8:11], s65 offen offset:1024  lds
v_mfma_f32_16x16x32_bf16 v[228:231], a[228:231], a[92:95], v[228:231]
s_waitcnt lgkmcnt(6)
ds_read_b64_tr_b16 a[252:253], v8 offset:49152
s_add_u32 s65, s65, 128
ds_read_b64_tr_b16 a[254:255], v8 offset:51200
v_mfma_f32_16x16x32_bf16 v[112:115], a[232:235], a[84:87], v[112:115]
s_cmp_eq_u32 s65, 896
s_cselect_b32 s65, 0, s65
ds_read_b64_tr_b16 a[192:193], v1 offset:49408
v_mfma_f32_16x16x32_bf16 v[116:119], a[232:235], a[88:91], v[116:119]
s_add_u32 m0, s33, 98304
s_add_u32 s38, s64, 30720
ds_read_b64_tr_b16 a[194:195], v1 offset:51456
buffer_load_dwordx4 v56, s[12:15], s64 offen offset:0  lds
v_mfma_f32_16x16x32_bf16 v[232:235], a[232:235], a[92:95], v[232:235]
ds_read_b64_tr_b16 a[196:197], v2 offset:49408
v_mfma_f32_16x16x32_bf16 v[120:123], a[236:239], a[84:87], v[120:123]
ds_read_b64_tr_b16 a[198:199], v2 offset:51456
v_mfma_f32_16x16x32_bf16 v[124:127], a[236:239], a[88:91], v[124:127]
buffer_load_dwordx4 v57, s[12:15], s64 offen offset:1024  lds
v_mfma_f32_16x16x32_bf16 v[236:239], a[236:239], a[92:95], v[236:239]
s_waitcnt lgkmcnt(8)
s_add_u32 s64, s64, 262144
ds_read_b64_tr_b16 a[200:201], v3 offset:49408
v_mfma_f32_16x16x32_bf16 v[128:131], a[240:243], a[84:87], v[128:131]
s_cmp_eq_u32 s64, 3670016
s_cselect_b32 s64, 0, s64
ds_read_b64_tr_b16 a[202:203], v3 offset:51456
v_mfma_f32_16x16x32_bf16 v[132:135], a[240:243], a[88:91], v[132:135]
buffer_load_dwordx4 v56, s[12:15], s38 offen offset:2048  lds
v_mfma_f32_16x16x32_bf16 v[136:139], a[244:247], a[84:87], v[136:139]
s_waitcnt vmcnt(9)
ds_read_b128 a[60:63], v70 offset:16384
v_mfma_f32_16x16x32_bf16 v[140:143], a[244:247], a[88:91], v[140:143]
s_waitcnt lgkmcnt(7)
ds_read_b128 a[64:67], v70 offset:18432
ds_read_b128 a[68:71], v70 offset:0
ds_read_b128 a[48:51], v71 offset:16384
ds_read_b128 a[52:55], v71 offset:18432
ds_read_b128 a[56:59], v71 offset:0
v_mfma_f32_16x16x32_bf16 v[144:147], a[248:251], a[84:87], v[144:147]
buffer_load_dwordx4 v57, s[12:15], s38 offen offset:3072  lds
v_mfma_f32_16x16x32_bf16 v[148:151], a[248:251], a[88:91], v[148:151]
ds_read_b64_tr_b16 a[204:205], v4 offset:49408
ds_read_b64_tr_b16 a[206:207], v4 offset:51456
v_mfma_f32_16x16x32_bf16 v[152:155], a[252:255], a[84:87], v[152:155]
ds_read_b64_tr_b16 a[208:209], v5 offset:49408
v_mfma_f32_16x16x32_bf16 v[156:159], a[252:255], a[88:91], v[156:159]
s_waitcnt lgkmcnt(11)
ds_read_b64_tr_b16 a[210:211], v5 offset:51456
v_mfma_f32_16x16x32_bf16 v[160:163], a[192:195], a[84:87], v[160:163]
ds_read_b64_tr_b16 a[212:213], v6 offset:49408
v_mfma_f32_16x16x32_bf16 v[164:167], a[192:195], a[88:91], v[164:167]
ds_read_b64_tr_b16 a[214:215], v6 offset:51456
v_mfma_f32_16x16x32_bf16 v[240:243], a[192:195], a[92:95], v[240:243]
ds_read_b64_tr_b16 a[216:217], v7 offset:49408
v_mfma_f32_16x16x32_bf16 v[168:171], a[196:199], a[84:87], v[168:171]
ds_read_b64_tr_b16 a[218:219], v7 offset:51456
v_mfma_f32_16x16x32_bf16 v[172:175], a[196:199], a[88:91], v[172:175]
ds_read_b64_tr_b16 a[220:221], v8 offset:49408
v_mfma_f32_16x16x32_bf16 v[244:247], a[196:199], a[92:95], v[244:247]
ds_read_b64_tr_b16 a[222:223], v8 offset:51456
s_barrier
s_waitcnt lgkmcnt(8)
v_mfma_f32_16x16x32_bf16 v[176:179], a[200:203], a[84:87], v[176:179]
s_add_u32 m0, s33, 149504
ds_read_b64_tr_b16 a[224:225], v48 offset:0
s_add_u32 s38, s65, 14336
v_mfma_f32_16x16x32_bf16 v[180:183], a[200:203], a[88:91], v[180:183]
ds_read_b64_tr_b16 a[226:227], v48 offset:2048
v_mfma_f32_16x16x32_bf16 v[248:251], a[200:203], a[92:95], v[248:251]
buffer_load_dwordx4 v66, s[8:11], s38 offen offset:0  lds
v_mfma_f32_16x16x32_bf16 v[184:187], a[204:207], a[84:87], v[184:187]
ds_read_b64_tr_b16 a[228:229], v49 offset:0
v_mfma_f32_16x16x32_bf16 v[188:191], a[204:207], a[88:91], v[188:191]
ds_read_b64_tr_b16 a[230:231], v49 offset:2048
v_mfma_f32_16x16x32_bf16 v[252:255], a[204:207], a[92:95], v[252:255]
s_waitcnt lgkmcnt(8)
buffer_load_dwordx4 v67, s[8:11], s38 offen offset:1024  lds
v_mfma_f32_16x16x32_bf16 v[192:195], a[208:211], a[84:87], v[192:195]
s_add_u32 m0, s33, 131072
ds_read_b64_tr_b16 a[232:233], v50 offset:0
s_add_u32 s38, s65, s41
v_mfma_f32_16x16x32_bf16 v[196:199], a[208:211], a[88:91], v[196:199]
ds_read_b64_tr_b16 a[234:235], v50 offset:2048
v_mfma_f32_16x16x32_bf16 v[200:203], a[212:215], a[84:87], v[200:203]
buffer_load_dwordx4 v66, s[8:11], s38 offen offset:0  lds
v_mfma_f32_16x16x32_bf16 v[204:207], a[212:215], a[88:91], v[204:207]
s_waitcnt lgkmcnt(6)
ds_read_b64_tr_b16 a[236:237], v51 offset:0
v_mfma_f32_16x16x32_bf16 v[208:211], a[216:219], a[84:87], v[208:211]
ds_read_b64_tr_b16 a[238:239], v51 offset:2048
v_mfma_f32_16x16x32_bf16 v[212:215], a[216:219], a[88:91], v[212:215]
buffer_load_dwordx4 v67, s[8:11], s38 offen offset:1024  lds
v_mfma_f32_16x16x32_bf16 v[216:219], a[220:223], a[84:87], v[216:219]
s_add_u32 m0, s33, 147456
ds_read_b64_tr_b16 a[240:241], v52 offset:0
v_mfma_f32_16x16x32_bf16 v[220:223], a[220:223], a[88:91], v[220:223]
s_waitcnt lgkmcnt(5)
ds_read_b64_tr_b16 a[242:243], v52 offset:2048
v_mfma_f32_16x16x32_bf16 v[96:99], a[224:227], a[72:75], v[96:99]
ds_read_b64_tr_b16 a[244:245], v53 offset:0
v_mfma_f32_16x16x32_bf16 v[100:103], a[224:227], a[76:79], v[100:103]
ds_read_b64_tr_b16 a[246:247], v53 offset:2048
buffer_load_dwordx4 v66, s[8:11], s65 offen offset:0  lds
v_mfma_f32_16x16x32_bf16 v[224:227], a[224:227], a[80:83], v[224:227]
ds_read_b64_tr_b16 a[248:249], v54 offset:0
v_mfma_f32_16x16x32_bf16 v[104:107], a[228:231], a[72:75], v[104:107]
ds_read_b64_tr_b16 a[250:251], v54 offset:2048
v_mfma_f32_16x16x32_bf16 v[108:111], a[228:231], a[76:79], v[108:111]
buffer_load_dwordx4 v67, s[8:11], s65 offen offset:1024  lds
v_mfma_f32_16x16x32_bf16 v[228:231], a[228:231], a[80:83], v[228:231]
s_waitcnt lgkmcnt(6)
ds_read_b64_tr_b16 a[252:253], v55 offset:0
s_add_u32 s65, s65, 128
ds_read_b64_tr_b16 a[254:255], v55 offset:2048
v_mfma_f32_16x16x32_bf16 v[112:115], a[232:235], a[72:75], v[112:115]
s_cmp_eq_u32 s65, 896
s_cselect_b32 s65, 0, s65
ds_read_b64_tr_b16 a[192:193], v48 offset:256
v_mfma_f32_16x16x32_bf16 v[116:119], a[232:235], a[76:79], v[116:119]
s_add_u32 m0, s33, 114688
s_add_u32 s38, s64, 30720
ds_read_b64_tr_b16 a[194:195], v48 offset:2304
buffer_load_dwordx4 v56, s[12:15], s64 offen offset:0  lds
v_mfma_f32_16x16x32_bf16 v[232:235], a[232:235], a[80:83], v[232:235]
ds_read_b64_tr_b16 a[196:197], v49 offset:256
v_mfma_f32_16x16x32_bf16 v[120:123], a[236:239], a[72:75], v[120:123]
ds_read_b64_tr_b16 a[198:199], v49 offset:2304
v_mfma_f32_16x16x32_bf16 v[124:127], a[236:239], a[76:79], v[124:127]
buffer_load_dwordx4 v57, s[12:15], s64 offen offset:1024  lds
v_mfma_f32_16x16x32_bf16 v[236:239], a[236:239], a[80:83], v[236:239]
s_waitcnt lgkmcnt(8)
s_add_u32 s64, s64, 262144
ds_read_b64_tr_b16 a[200:201], v50 offset:256
v_mfma_f32_16x16x32_bf16 v[128:131], a[240:243], a[72:75], v[128:131]
s_cmp_eq_u32 s64, 3670016
s_cselect_b32 s64, 0, s64
ds_read_b64_tr_b16 a[202:203], v50 offset:2304
v_mfma_f32_16x16x32_bf16 v[132:135], a[240:243], a[76:79], v[132:135]
buffer_load_dwordx4 v56, s[12:15], s38 offen offset:2048  lds
v_mfma_f32_16x16x32_bf16 v[136:139], a[244:247], a[72:75], v[136:139]
buffer_load_dwordx4 v57, s[12:15], s38 offen offset:3072  lds
v_mfma_f32_16x16x32_bf16 v[140:143], a[244:247], a[76:79], v[140:143]
s_waitcnt lgkmcnt(6)
ds_read_b64_tr_b16 a[204:205], v51 offset:256
s_add_u32 m0, s33, 0
v_mfma_f32_16x16x32_bf16 v[144:147], a[248:251], a[72:75], v[144:147]
s_add_u32 s34, s40, 0
ds_read_b64_tr_b16 a[206:207], v51 offset:2304
s_and_b32 s34, s34, 524287
v_mfma_f32_16x16x32_bf16 v[148:151], a[248:251], a[76:79], v[148:151]
s_waitcnt vmcnt(14)
ds_read_b128 a[36:39], v70 offset:2048
v_mfma_f32_16x16x32_bf16 v[152:155], a[252:255], a[72:75], v[152:155]
ds_read_b128 a[40:43], v68 offset:16384
v_mfma_f32_16x16x32_bf16 v[156:159], a[252:255], a[76:79], v[156:159]
s_waitcnt lgkmcnt(6)
ds_read_b128 a[44:47], v68 offset:18432
ds_read_b128 a[24:27], v71 offset:2048
ds_read_b128 a[28:31], v69 offset:16384
buffer_load_dwordx4 v16, s[16:19], s34 offen offset:0 nt lds
ds_read_b128 a[32:35], v69 offset:18432
v_mfma_f32_16x16x32_bf16 v[160:163], a[192:195], a[72:75], v[160:163]
ds_read_b64_tr_b16 a[208:209], v52 offset:256
ds_read_b64_tr_b16 a[210:211], v52 offset:2304
v_mfma_f32_16x16x32_bf16 v[164:167], a[192:195], a[76:79], v[164:167]
ds_read_b64_tr_b16 a[212:213], v53 offset:256
v_mfma_f32_16x16x32_bf16 v[240:243], a[192:195], a[80:83], v[240:243]
ds_read_b64_tr_b16 a[214:215], v53 offset:2304
buffer_load_dwordx4 v17, s[16:19], s34 offen offset:1024 nt lds
v_mfma_f32_16x16x32_bf16 v[168:171], a[196:199], a[72:75], v[168:171]
ds_read_b64_tr_b16 a[216:217], v54 offset:256
v_mfma_f32_16x16x32_bf16 v[172:175], a[196:199], a[76:79], v[172:175]
ds_read_b64_tr_b16 a[218:219], v54 offset:2304
v_mfma_f32_16x16x32_bf16 v[244:247], a[196:199], a[80:83], v[244:247]
ds_read_b64_tr_b16 a[220:221], v55 offset:256
s_barrier
s_waitcnt lgkmcnt(13)
ds_read_b64_tr_b16 a[222:223], v55 offset:2304
v_mfma_f32_16x16x32_bf16 v[176:179], a[200:203], a[72:75], v[176:179]
s_add_u32 m0, s33, 49152
ds_read_b64_tr_b16 a[224:225], v1 offset:32768
s_add_u32 s38, s64, 30720
v_mfma_f32_16x16x32_bf16 v[180:183], a[200:203], a[76:79], v[180:183]
ds_read_b64_tr_b16 a[226:227], v1 offset:34816
v_mfma_f32_16x16x32_bf16 v[248:251], a[200:203], a[80:83], v[248:251]
ds_read_b64_tr_b16 a[228:229], v2 offset:32768
v_mfma_f32_16x16x32_bf16 v[184:187], a[204:207], a[72:75], v[184:187]
ds_read_b64_tr_b16 a[230:231], v2 offset:34816
v_mfma_f32_16x16x32_bf16 v[188:191], a[204:207], a[76:79], v[188:191]
buffer_load_dwordx4 v56, s[12:15], s64 offen offset:0  lds
v_mfma_f32_16x16x32_bf16 v[252:255], a[204:207], a[80:83], v[252:255]
s_waitcnt lgkmcnt(8)
ds_read_b64_tr_b16 a[232:233], v3 offset:32768
v_mfma_f32_16x16x32_bf16 v[192:195], a[208:211], a[72:75], v[192:195]
ds_read_b64_tr_b16 a[234:235], v3 offset:34816
v_mfma_f32_16x16x32_bf16 v[196:199], a[208:211], a[76:79], v[196:199]
ds_read_b64_tr_b16 a[236:237], v4 offset:32768
v_mfma_f32_16x16x32_bf16 v[200:203], a[212:215], a[72:75], v[200:203]
ds_read_b64_tr_b16 a[238:239], v4 offset:34816
v_mfma_f32_16x16x32_bf16 v[204:207], a[212:215], a[76:79], v[204:207]
s_waitcnt lgkmcnt(8)
buffer_load_dwordx4 v57, s[12:15], s64 offen offset:1024  lds
v_mfma_f32_16x16x32_bf16 v[208:211], a[216:219], a[72:75], v[208:211]
ds_read_b64_tr_b16 a[240:241], v5 offset:32768
v_mfma_f32_16x16x32_bf16 v[212:215], a[216:219], a[76:79], v[212:215]
s_add_u32 s64, s64, 262144
ds_read_b64_tr_b16 a[242:243], v5 offset:34816
v_mfma_f32_16x16x32_bf16 v[216:219], a[220:223], a[72:75], v[216:219]
s_cmp_eq_u32 s64, 3670016
s_cselect_b32 s64, 0, s64
ds_read_b64_tr_b16 a[244:245], v6 offset:32768
v_mfma_f32_16x16x32_bf16 v[220:223], a[220:223], a[76:79], v[220:223]
s_waitcnt lgkmcnt(7)
ds_read_b64_tr_b16 a[246:247], v6 offset:34816
v_mfma_f32_16x16x32_bf16 v[96:99], a[224:227], a[60:63], v[96:99]
ds_read_b64_tr_b16 a[248:249], v7 offset:32768
v_mfma_f32_16x16x32_bf16 v[100:103], a[224:227], a[64:67], v[100:103]
ds_read_b64_tr_b16 a[250:251], v7 offset:34816
v_mfma_f32_16x16x32_bf16 v[224:227], a[224:227], a[68:71], v[224:227]
buffer_load_dwordx4 v56, s[12:15], s38 offen offset:2048  lds
v_mfma_f32_16x16x32_bf16 v[104:107], a[228:231], a[60:63], v[104:107]
ds_read_b64_tr_b16 a[252:253], v8 offset:32768
v_mfma_f32_16x16x32_bf16 v[108:111], a[228:231], a[64:67], v[108:111]
ds_read_b64_tr_b16 a[254:255], v8 offset:34816
v_mfma_f32_16x16x32_bf16 v[228:231], a[228:231], a[68:71], v[228:231]
s_waitcnt lgkmcnt(8)
ds_read_b64_tr_b16 a[192:193], v1 offset:33024
v_mfma_f32_16x16x32_bf16 v[112:115], a[232:235], a[60:63], v[112:115]
ds_read_b64_tr_b16 a[194:195], v1 offset:35072
v_mfma_f32_16x16x32_bf16 v[116:119], a[232:235], a[64:67], v[116:119]
ds_read_b64_tr_b16 a[196:197], v2 offset:33024
v_mfma_f32_16x16x32_bf16 v[232:235], a[232:235], a[68:71], v[232:235]
ds_read_b64_tr_b16 a[198:199], v2 offset:35072
v_mfma_f32_16x16x32_bf16 v[120:123], a[236:239], a[60:63], v[120:123]
buffer_load_dwordx4 v57, s[12:15], s38 offen offset:3072  lds
v_mfma_f32_16x16x32_bf16 v[124:127], a[236:239], a[64:67], v[124:127]
s_add_u32 m0, s33, 0
ds_read_b64_tr_b16 a[200:201], v3 offset:33024
s_add_u32 s34, s40, 0
v_mfma_f32_16x16x32_bf16 v[236:239], a[236:239], a[68:71], v[236:239]
s_waitcnt lgkmcnt(9)
ds_read_b64_tr_b16 a[202:203], v3 offset:35072
s_and_b32 s34, s34, 524287
v_mfma_f32_16x16x32_bf16 v[128:131], a[240:243], a[60:63], v[128:131]
buffer_load_dwordx4 v18, s[16:19], s34 offen offset:2048 nt lds
v_mfma_f32_16x16x32_bf16 v[132:135], a[240:243], a[64:67], v[132:135]
ds_read_b64_tr_b16 a[204:205], v4 offset:33024
v_mfma_f32_16x16x32_bf16 v[136:139], a[244:247], a[60:63], v[136:139]
ds_read_b64_tr_b16 a[206:207], v4 offset:35072
v_mfma_f32_16x16x32_bf16 v[140:143], a[244:247], a[64:67], v[140:143]
s_waitcnt lgkmcnt(8)
s_waitcnt vmcnt(11)
ds_read_b128 a[12:15], v70 offset:16384
v_mfma_f32_16x16x32_bf16 v[144:147], a[248:251], a[60:63], v[144:147]
ds_read_b128 a[16:19], v70 offset:18432
v_mfma_f32_16x16x32_bf16 v[148:151], a[248:251], a[64:67], v[148:151]
ds_read_b128 a[20:23], v70 offset:0
v_mfma_f32_16x16x32_bf16 v[152:155], a[252:255], a[60:63], v[152:155]
ds_read_b128 a[0:3], v71 offset:16384
v_mfma_f32_16x16x32_bf16 v[156:159], a[252:255], a[64:67], v[156:159]
s_waitcnt lgkmcnt(8)
ds_read_b128 a[4:7], v71 offset:18432
ds_read_b128 a[8:11], v71 offset:0
v_mfma_f32_16x16x32_bf16 v[160:163], a[192:195], a[60:63], v[160:163]
ds_read_b64_tr_b16 a[208:209], v5 offset:33024
ds_read_b64_tr_b16 a[210:211], v5 offset:35072
v_mfma_f32_16x16x32_bf16 v[164:167], a[192:195], a[64:67], v[164:167]
ds_read_b64_tr_b16 a[212:213], v6 offset:33024
v_mfma_f32_16x16x32_bf16 v[240:243], a[192:195], a[68:71], v[240:243]
ds_read_b64_tr_b16 a[214:215], v6 offset:35072
buffer_load_dwordx4 v19, s[16:19], s34 offen offset:3072 nt lds
v_mfma_f32_16x16x32_bf16 v[168:171], a[196:199], a[60:63], v[168:171]
ds_read_b64_tr_b16 a[216:217], v7 offset:33024
v_mfma_f32_16x16x32_bf16 v[172:175], a[196:199], a[64:67], v[172:175]
ds_read_b64_tr_b16 a[218:219], v7 offset:35072
v_mfma_f32_16x16x32_bf16 v[244:247], a[196:199], a[68:71], v[244:247]
ds_read_b64_tr_b16 a[220:221], v8 offset:33024
s_barrier
s_waitcnt lgkmcnt(13)
ds_read_b64_tr_b16 a[222:223], v8 offset:35072
v_mfma_f32_16x16x32_bf16 v[176:179], a[200:203], a[60:63], v[176:179]
s_add_u32 m0, s33, 65536
ds_read_b64_tr_b16 a[224:225], v48 offset:16384
s_add_u32 s38, s64, 30720
v_mfma_f32_16x16x32_bf16 v[180:183], a[200:203], a[64:67], v[180:183]
ds_read_b64_tr_b16 a[226:227], v48 offset:18432
v_mfma_f32_16x16x32_bf16 v[248:251], a[200:203], a[68:71], v[248:251]
ds_read_b64_tr_b16 a[228:229], v49 offset:16384
v_mfma_f32_16x16x32_bf16 v[184:187], a[204:207], a[60:63], v[184:187]
ds_read_b64_tr_b16 a[230:231], v49 offset:18432
v_mfma_f32_16x16x32_bf16 v[188:191], a[204:207], a[64:67], v[188:191]
buffer_load_dwordx4 v56, s[12:15], s64 offen offset:0  lds
v_mfma_f32_16x16x32_bf16 v[252:255], a[204:207], a[68:71], v[252:255]
s_waitcnt lgkmcnt(8)
ds_read_b64_tr_b16 a[232:233], v50 offset:16384
v_mfma_f32_16x16x32_bf16 v[192:195], a[208:211], a[60:63], v[192:195]
ds_read_b64_tr_b16 a[234:235], v50 offset:18432
v_mfma_f32_16x16x32_bf16 v[196:199], a[208:211], a[64:67], v[196:199]
ds_read_b64_tr_b16 a[236:237], v51 offset:16384
v_mfma_f32_16x16x32_bf16 v[200:203], a[212:215], a[60:63], v[200:203]
ds_read_b64_tr_b16 a[238:239], v51 offset:18432
v_mfma_f32_16x16x32_bf16 v[204:207], a[212:215], a[64:67], v[204:207]
s_waitcnt lgkmcnt(8)
buffer_load_dwordx4 v57, s[12:15], s64 offen offset:1024  lds
v_mfma_f32_16x16x32_bf16 v[208:211], a[216:219], a[60:63], v[208:211]
ds_read_b64_tr_b16 a[240:241], v52 offset:16384
v_mfma_f32_16x16x32_bf16 v[212:215], a[216:219], a[64:67], v[212:215]
s_add_u32 s64, s64, 262144
ds_read_b64_tr_b16 a[242:243], v52 offset:18432
v_mfma_f32_16x16x32_bf16 v[216:219], a[220:223], a[60:63], v[216:219]
s_cmp_eq_u32 s64, 3670016
s_cselect_b32 s64, 0, s64
ds_read_b64_tr_b16 a[244:245], v53 offset:16384
v_mfma_f32_16x16x32_bf16 v[220:223], a[220:223], a[64:67], v[220:223]
s_waitcnt lgkmcnt(7)
ds_read_b64_tr_b16 a[246:247], v53 offset:18432
v_mfma_f32_16x16x32_bf16 v[96:99], a[224:227], a[48:51], v[96:99]
ds_read_b64_tr_b16 a[248:249], v54 offset:16384
v_mfma_f32_16x16x32_bf16 v[100:103], a[224:227], a[52:55], v[100:103]
ds_read_b64_tr_b16 a[250:251], v54 offset:18432
v_mfma_f32_16x16x32_bf16 v[224:227], a[224:227], a[56:59], v[224:227]
buffer_load_dwordx4 v56, s[12:15], s38 offen offset:2048  lds
v_mfma_f32_16x16x32_bf16 v[104:107], a[228:231], a[48:51], v[104:107]
ds_read_b64_tr_b16 a[252:253], v55 offset:16384
v_mfma_f32_16x16x32_bf16 v[108:111], a[228:231], a[52:55], v[108:111]
ds_read_b64_tr_b16 a[254:255], v55 offset:18432
v_mfma_f32_16x16x32_bf16 v[228:231], a[228:231], a[56:59], v[228:231]
s_waitcnt lgkmcnt(8)
ds_read_b64_tr_b16 a[192:193], v48 offset:16640
v_mfma_f32_16x16x32_bf16 v[112:115], a[232:235], a[48:51], v[112:115]
ds_read_b64_tr_b16 a[194:195], v48 offset:18688
v_mfma_f32_16x16x32_bf16 v[116:119], a[232:235], a[52:55], v[116:119]
ds_read_b64_tr_b16 a[196:197], v49 offset:16640
v_mfma_f32_16x16x32_bf16 v[232:235], a[232:235], a[56:59], v[232:235]
ds_read_b64_tr_b16 a[198:199], v49 offset:18688
v_mfma_f32_16x16x32_bf16 v[120:123], a[236:239], a[48:51], v[120:123]
buffer_load_dwordx4 v57, s[12:15], s38 offen offset:3072  lds
v_mfma_f32_16x16x32_bf16 v[124:127], a[236:239], a[52:55], v[124:127]
s_add_u32 m0, s33, 16384
ds_read_b64_tr_b16 a[200:201], v50 offset:16640
s_add_u32 s34, s40, 16384
v_mfma_f32_16x16x32_bf16 v[236:239], a[236:239], a[56:59], v[236:239]
s_waitcnt lgkmcnt(9)
ds_read_b64_tr_b16 a[202:203], v50 offset:18688
s_and_b32 s34, s34, 524287
v_mfma_f32_16x16x32_bf16 v[128:131], a[240:243], a[48:51], v[128:131]
buffer_load_dwordx4 v16, s[16:19], s34 offen offset:0 nt lds
v_mfma_f32_16x16x32_bf16 v[132:135], a[240:243], a[52:55], v[132:135]
ds_read_b64_tr_b16 a[204:205], v51 offset:16640
v_mfma_f32_16x16x32_bf16 v[136:139], a[244:247], a[48:51], v[136:139]
ds_read_b64_tr_b16 a[206:207], v51 offset:18688
v_mfma_f32_16x16x32_bf16 v[140:143], a[244:247], a[52:55], v[140:143]
s_waitcnt lgkmcnt(8)
ds_read_b64_tr_b16 a[208:209], v52 offset:16640
v_mfma_f32_16x16x32_bf16 v[144:147], a[248:251], a[48:51], v[144:147]
ds_read_b64_tr_b16 a[210:211], v52 offset:18688
v_mfma_f32_16x16x32_bf16 v[148:151], a[248:251], a[52:55], v[148:151]
ds_read_b64_tr_b16 a[212:213], v53 offset:16640
v_mfma_f32_16x16x32_bf16 v[152:155], a[252:255], a[48:51], v[152:155]
ds_read_b64_tr_b16 a[214:215], v53 offset:18688
v_mfma_f32_16x16x32_bf16 v[156:159], a[252:255], a[52:55], v[156:159]
s_waitcnt lgkmcnt(8)
buffer_load_dwordx4 v17, s[16:19], s34 offen offset:1024 nt lds
v_mfma_f32_16x16x32_bf16 v[160:163], a[192:195], a[48:51], v[160:163]
ds_read_b64_tr_b16 a[216:217], v54 offset:16640
v_mfma_f32_16x16x32_bf16 v[164:167], a[192:195], a[52:55], v[164:167]
ds_read_b64_tr_b16 a[218:219], v54 offset:18688
v_mfma_f32_16x16x32_bf16 v[240:243], a[192:195], a[56:59], v[240:243]
ds_read_b64_tr_b16 a[220:221], v55 offset:16640
v_mfma_f32_16x16x32_bf16 v[168:171], a[196:199], a[48:51], v[168:171]
ds_read_b64_tr_b16 a[222:223], v55 offset:18688
v_mfma_f32_16x16x32_bf16 v[172:175], a[196:199], a[52:55], v[172:175]
v_mfma_f32_16x16x32_bf16 v[244:247], a[196:199], a[56:59], v[244:247]
s_barrier
s_waitcnt lgkmcnt(8)
ds_read_b64_tr_b16 a[224:225], v48 offset:32768
v_mfma_f32_16x16x32_bf16 v[176:179], a[200:203], a[48:51], v[176:179]
s_add_u32 m0, s33, 16384
ds_read_b64_tr_b16 a[226:227], v48 offset:34816
s_add_u32 s34, s40, 16384
v_mfma_f32_16x16x32_bf16 v[180:183], a[200:203], a[52:55], v[180:183]
s_and_b32 s34, s34, 524287
ds_read_b64_tr_b16 a[228:229], v49 offset:32768
v_mfma_f32_16x16x32_bf16 v[248:251], a[200:203], a[56:59], v[248:251]
ds_read_b64_tr_b16 a[230:231], v49 offset:34816
v_mfma_f32_16x16x32_bf16 v[184:187], a[204:207], a[48:51], v[184:187]
ds_read_b64_tr_b16 a[232:233], v50 offset:32768
v_mfma_f32_16x16x32_bf16 v[188:191], a[204:207], a[52:55], v[188:191]
ds_read_b64_tr_b16 a[234:235], v50 offset:34816
v_mfma_f32_16x16x32_bf16 v[252:255], a[204:207], a[56:59], v[252:255]
s_waitcnt lgkmcnt(10)
buffer_load_dwordx4 v18, s[16:19], s34 offen offset:2048 nt lds
v_mfma_f32_16x16x32_bf16 v[192:195], a[208:211], a[48:51], v[192:195]
ds_read_b64_tr_b16 a[236:237], v51 offset:32768
v_mfma_f32_16x16x32_bf16 v[196:199], a[208:211], a[52:55], v[196:199]
ds_read_b64_tr_b16 a[238:239], v51 offset:34816
v_mfma_f32_16x16x32_bf16 v[200:203], a[212:215], a[48:51], v[200:203]
ds_read_b64_tr_b16 a[240:241], v52 offset:32768
v_mfma_f32_16x16x32_bf16 v[204:207], a[212:215], a[52:55], v[204:207]
s_waitcnt lgkmcnt(9)
ds_read_b64_tr_b16 a[242:243], v52 offset:34816
v_mfma_f32_16x16x32_bf16 v[208:211], a[216:219], a[48:51], v[208:211]
ds_read_b64_tr_b16 a[244:245], v53 offset:32768
v_mfma_f32_16x16x32_bf16 v[212:215], a[216:219], a[52:55], v[212:215]
ds_read_b64_tr_b16 a[246:247], v53 offset:34816
v_mfma_f32_16x16x32_bf16 v[216:219], a[220:223], a[48:51], v[216:219]
ds_read_b64_tr_b16 a[248:249], v54 offset:32768
v_mfma_f32_16x16x32_bf16 v[220:223], a[220:223], a[52:55], v[220:223]
s_waitcnt lgkmcnt(9)
ds_read_b64_tr_b16 a[250:251], v54 offset:34816
v_mfma_f32_16x16x32_bf16 v[96:99], a[224:227], a[36:39], v[96:99]
buffer_load_dwordx4 v19, s[16:19], s34 offen offset:3072 nt lds
v_mfma_f32_16x16x32_bf16 v[100:103], a[224:227], a[40:43], v[100:103]
ds_read_b64_tr_b16 a[252:253], v55 offset:32768
v_mfma_f32_16x16x32_bf16 v[224:227], a[224:227], a[44:47], v[224:227]
ds_read_b64_tr_b16 a[254:255], v55 offset:34816
v_mfma_f32_16x16x32_bf16 v[104:107], a[228:231], a[36:39], v[104:107]
s_add_u32 m0, s33, 147456
ds_read_b64_tr_b16 a[192:193], v48 offset:33024
s_add_u32 s35, s40, 0
v_mfma_f32_16x16x32_bf16 v[108:111], a[228:231], a[40:43], v[108:111]
s_and_b32 s35, s35, 524287
ds_read_b64_tr_b16 a[194:195], v48 offset:35072
v_mfma_f32_16x16x32_bf16 v[228:231], a[228:231], a[44:47], v[228:231]
s_waitcnt lgkmcnt(10)
ds_read_b64_tr_b16 a[196:197], v49 offset:33024
v_mfma_f32_16x16x32_bf16 v[112:115], a[232:235], a[36:39], v[112:115]
ds_read_b64_tr_b16 a[198:199], v49 offset:35072
v_mfma_f32_16x16x32_bf16 v[116:119], a[232:235], a[40:43], v[116:119]
buffer_load_dwordx4 v20, s[20:23], s35 offen offset:0 nt lds
v_mfma_f32_16x16x32_bf16 v[232:235], a[232:235], a[44:47], v[232:235]
ds_read_b64_tr_b16 a[200:201], v50 offset:33024
v_mfma_f32_16x16x32_bf16 v[120:123], a[236:239], a[36:39], v[120:123]
ds_read_b64_tr_b16 a[202:203], v50 offset:35072
v_mfma_f32_16x16x32_bf16 v[124:127], a[236:239], a[40:43], v[124:127]
ds_read_b64_tr_b16 a[204:205], v51 offset:33024
v_mfma_f32_16x16x32_bf16 v[236:239], a[236:239], a[44:47], v[236:239]
s_waitcnt lgkmcnt(11)
ds_read_b64_tr_b16 a[206:207], v51 offset:35072
v_mfma_f32_16x16x32_bf16 v[128:131], a[240:243], a[36:39], v[128:131]
ds_read_b64_tr_b16 a[208:209], v52 offset:33024
v_mfma_f32_16x16x32_bf16 v[132:135], a[240:243], a[40:43], v[132:135]
ds_read_b64_tr_b16 a[210:211], v52 offset:35072
v_mfma_f32_16x16x32_bf16 v[136:139], a[244:247], a[36:39], v[136:139]
ds_read_b64_tr_b16 a[212:213], v53 offset:33024
v_mfma_f32_16x16x32_bf16 v[140:143], a[244:247], a[40:43], v[140:143]
s_waitcnt lgkmcnt(11)
ds_read_b64_tr_b16 a[214:215], v53 offset:35072
v_mfma_f32_16x16x32_bf16 v[144:147], a[248:251], a[36:39], v[144:147]
buffer_load_dwordx4 v21, s[20:23], s35 offen offset:1024 nt lds
v_mfma_f32_16x16x32_bf16 v[148:151], a[248:251], a[40:43], v[148:151]
ds_read_b64_tr_b16 a[216:217], v54 offset:33024
v_mfma_f32_16x16x32_bf16 v[152:155], a[252:255], a[36:39], v[152:155]
ds_read_b64_tr_b16 a[218:219], v54 offset:35072
v_mfma_f32_16x16x32_bf16 v[156:159], a[252:255], a[40:43], v[156:159]
s_waitcnt lgkmcnt(10)
ds_read_b64_tr_b16 a[220:221], v55 offset:33024
v_mfma_f32_16x16x32_bf16 v[160:163], a[192:195], a[36:39], v[160:163]
ds_read_b64_tr_b16 a[222:223], v55 offset:35072
v_mfma_f32_16x16x32_bf16 v[164:167], a[192:195], a[40:43], v[164:167]
v_mfma_f32_16x16x32_bf16 v[240:243], a[192:195], a[44:47], v[240:243]
v_mfma_f32_16x16x32_bf16 v[168:171], a[196:199], a[36:39], v[168:171]
v_mfma_f32_16x16x32_bf16 v[172:175], a[196:199], a[40:43], v[172:175]
v_mfma_f32_16x16x32_bf16 v[244:247], a[196:199], a[44:47], v[244:247]
s_waitcnt vmcnt(6)
s_barrier
s_waitcnt lgkmcnt(8)
v_mfma_f32_16x16x32_bf16 v[176:179], a[200:203], a[36:39], v[176:179]
s_add_u32 m0, s33, 147456
ds_read_b64_tr_b16 a[224:225], v48 offset:49152
s_add_u32 s35, s40, 0
v_mfma_f32_16x16x32_bf16 v[180:183], a[200:203], a[40:43], v[180:183]
s_and_b32 s35, s35, 524287
ds_read_b64_tr_b16 a[226:227], v48 offset:51200
v_mfma_f32_16x16x32_bf16 v[248:251], a[200:203], a[44:47], v[248:251]
ds_read_b64_tr_b16 a[228:229], v1 offset:49152
v_mfma_f32_16x16x32_bf16 v[184:187], a[204:207], a[36:39], v[184:187]
ds_read_b64_tr_b16 a[230:231], v1 offset:51200
v_mfma_f32_16x16x32_bf16 v[188:191], a[204:207], a[40:43], v[188:191]
ds_read_b64_tr_b16 a[232:233], v48 offset:0
v_mfma_f32_16x16x32_bf16 v[252:255], a[204:207], a[44:47], v[252:255]
s_waitcnt lgkmcnt(9)
ds_read_b64_tr_b16 a[234:235], v48 offset:2048
v_mfma_f32_16x16x32_bf16 v[192:195], a[208:211], a[36:39], v[192:195]
buffer_load_dwordx4 v22, s[20:23], s35 offen offset:2048 nt lds
v_mfma_f32_16x16x32_bf16 v[196:199], a[208:211], a[40:43], v[196:199]
ds_read_b64_tr_b16 a[236:237], v49 offset:49152
v_mfma_f32_16x16x32_bf16 v[200:203], a[212:215], a[36:39], v[200:203]
ds_read_b64_tr_b16 a[238:239], v49 offset:51200
v_mfma_f32_16x16x32_bf16 v[204:207], a[212:215], a[40:43], v[204:207]
s_waitcnt lgkmcnt(8)
ds_read_b64_tr_b16 a[240:241], v2 offset:49152
v_mfma_f32_16x16x32_bf16 v[208:211], a[216:219], a[36:39], v[208:211]
ds_read_b64_tr_b16 a[242:243], v2 offset:51200
v_mfma_f32_16x16x32_bf16 v[212:215], a[216:219], a[40:43], v[212:215]
ds_read_b64_tr_b16 a[244:245], v49 offset:0
v_mfma_f32_16x16x32_bf16 v[216:219], a[220:223], a[36:39], v[216:219]
ds_read_b64_tr_b16 a[246:247], v49 offset:2048
v_mfma_f32_16x16x32_bf16 v[220:223], a[220:223], a[40:43], v[220:223]
s_waitcnt lgkmcnt(8)
buffer_load_dwordx4 v23, s[20:23], s35 offen offset:3072 nt lds
v_mfma_f32_16x16x32_bf16 v[96:99], a[224:227], a[24:27], v[96:99]
ds_read_b64_tr_b16 a[248:249], v50 offset:49152
v_mfma_f32_16x16x32_bf16 v[100:103], a[224:227], a[28:31], v[100:103]
ds_read_b64_tr_b16 a[250:251], v50 offset:51200
v_mfma_f32_16x16x32_bf16 v[224:227], a[224:227], a[32:35], v[224:227]
ds_read_b64_tr_b16 a[252:253], v3 offset:49152
v_mfma_f32_16x16x32_bf16 v[96:99], a[228:231], a[12:15], v[96:99]
s_add_u32 m0, s33, 32768
ds_read_b64_tr_b16 a[254:255], v3 offset:51200
s_add_u32 s34, s40, 32768
v_mfma_f32_16x16x32_bf16 v[100:103], a[228:231], a[16:19], v[100:103]
s_and_b32 s34, s34, 524287
ds_read_b64_tr_b16 a[192:193], v50 offset:0
v_mfma_f32_16x16x32_bf16 v[224:227], a[228:231], a[20:23], v[224:227]
s_waitcnt lgkmcnt(9)
ds_read_b64_tr_b16 a[194:195], v50 offset:2048
v_mfma_f32_16x16x32_bf16 v[96:99], a[232:235], a[0:3], v[96:99]
buffer_load_dwordx4 v16, s[16:19], s34 offen offset:0 nt lds
v_mfma_f32_16x16x32_bf16 v[100:103], a[232:235], a[4:7], v[100:103]
ds_read_b64_tr_b16 a[196:197], v51 offset:49152
v_mfma_f32_16x16x32_bf16 v[224:227], a[232:235], a[8:11], v[224:227]
ds_read_b64_tr_b16 a[198:199], v51 offset:51200
v_mfma_f32_16x16x32_bf16 v[104:107], a[236:239], a[24:27], v[104:107]
ds_read_b64_tr_b16 a[200:201], v4 offset:49152
v_mfma_f32_16x16x32_bf16 v[108:111], a[236:239], a[28:31], v[108:111]
ds_read_b64_tr_b16 a[202:203], v4 offset:51200
v_mfma_f32_16x16x32_bf16 v[228:231], a[236:239], a[32:35], v[228:231]
s_waitcnt lgkmcnt(10)
ds_read_b64_tr_b16 a[204:205], v51 offset:0
v_mul_f32 v96, s37, v96
v_mfma_f32_16x16x32_bf16 v[104:107], a[240:243], a[12:15], v[104:107]
ds_read_b64_tr_b16 a[206:207], v51 offset:2048
v_mul_f32 v97, s37, v97
v_mfma_f32_16x16x32_bf16 v[108:111], a[240:243], a[16:19], v[108:111]
buffer_load_dwordx4 v17, s[16:19], s34 offen offset:1024 nt lds
v_mfma_f32_16x16x32_bf16 v[228:231], a[240:243], a[20:23], v[228:231]
ds_read_b64_tr_b16 a[208:209], v52 offset:49152
v_mul_f32 v98, s37, v98
v_mfma_f32_16x16x32_bf16 v[104:107], a[244:247], a[0:3], v[104:107]
ds_read_b64_tr_b16 a[210:211], v52 offset:51200
v_mul_f32 v99, s37, v99
v_mfma_f32_16x16x32_bf16 v[108:111], a[244:247], a[4:7], v[108:111]
ds_read_b64_tr_b16 a[212:213], v5 offset:49152
v_cvt_pk_bf16_f32 v96, v96, v97
v_mfma_f32_16x16x32_bf16 v[228:231], a[244:247], a[8:11], v[228:231]
s_waitcnt lgkmcnt(11)
ds_read_b64_tr_b16 a[214:215], v5 offset:51200
v_cvt_pk_bf16_f32 v97, v98, v99
v_mfma_f32_16x16x32_bf16 v[112:115], a[248:251], a[24:27], v[112:115]
ds_read_b64_tr_b16 a[216:217], v52 offset:0
v_mul_f32 v100, s37, v100
v_mfma_f32_16x16x32_bf16 v[116:119], a[248:251], a[28:31], v[116:119]
ds_read_b64_tr_b16 a[218:219], v52 offset:2048
v_mul_f32 v101, s37, v101
v_mfma_f32_16x16x32_bf16 v[232:235], a[248:251], a[32:35], v[232:235]
ds_read_b64_tr_b16 a[220:221], v53 offset:49152
v_mul_f32 v102, s37, v102
v_mfma_f32_16x16x32_bf16 v[112:115], a[252:255], a[12:15], v[112:115]
ds_read_b64_tr_b16 a[222:223], v53 offset:51200
v_mul_f32 v103, s37, v103
v_mfma_f32_16x16x32_bf16 v[116:119], a[252:255], a[16:19], v[116:119]
ds_read_b64_tr_b16 a[224:225], v6 offset:49152
v_cvt_pk_bf16_f32 v100, v100, v101
v_mfma_f32_16x16x32_bf16 v[232:235], a[252:255], a[20:23], v[232:235]
s_waitcnt lgkmcnt(13)
ds_read_b64_tr_b16 a[226:227], v6 offset:51200
v_cvt_pk_bf16_f32 v101, v102, v103
v_mfma_f32_16x16x32_bf16 v[112:115], a[192:195], a[0:3], v[112:115]
ds_read_b64_tr_b16 a[228:229], v53 offset:0
v_mul_f32 v224, s37, v224
v_mfma_f32_16x16x32_bf16 v[116:119], a[192:195], a[4:7], v[116:119]
s_add_u32 m0, s33, 32768
ds_read_b64_tr_b16 a[230:231], v53 offset:2048
s_add_u32 s34, s40, 32768
v_mfma_f32_16x16x32_bf16 v[232:235], a[192:195], a[8:11], v[232:235]
s_and_b32 s34, s34, 524287
ds_read_b64_tr_b16 a[232:233], v54 offset:49152
v_mul_f32 v225, s37, v225
v_mfma_f32_16x16x32_bf16 v[120:123], a[196:199], a[24:27], v[120:123]
ds_read_b64_tr_b16 a[234:235], v54 offset:51200
v_mul_f32 v226, s37, v226
v_mfma_f32_16x16x32_bf16 v[124:127], a[196:199], a[28:31], v[124:127]
buffer_load_dwordx4 v18, s[16:19], s34 offen offset:2048 nt lds
v_mfma_f32_16x16x32_bf16 v[236:239], a[196:199], a[32:35], v[236:239]
s_waitcnt lgkmcnt(14)
ds_read_b64_tr_b16 a[236:237], v7 offset:49152
v_mul_f32 v227, s37, v227
v_mfma_f32_16x16x32_bf16 v[120:123], a[200:203], a[12:15], v[120:123]
ds_read_b64_tr_b16 a[238:239], v7 offset:51200
v_cvt_pk_bf16_f32 v224, v224, v225
v_mfma_f32_16x16x32_bf16 v[124:127], a[200:203], a[16:19], v[124:127]
ds_read_b64_tr_b16 a[240:241], v54 offset:0
v_cvt_pk_bf16_f32 v225, v226, v227
v_mfma_f32_16x16x32_bf16 v[236:239], a[200:203], a[20:23], v[236:239]
ds_read_b64_tr_b16 a[242:243], v54 offset:2048
v_mul_f32 v104, s37, v104
v_mfma_f32_16x16x32_bf16 v[120:123], a[204:207], a[0:3], v[120:123]
ds_read_b64_tr_b16 a[244:245], v55 offset:49152
v_mul_f32 v105, s37, v105
v_mfma_f32_16x16x32_bf16 v[124:127], a[204:207], a[4:7], v[124:127]
ds_read_b64_tr_b16 a[246:247], v55 offset:51200
v_mul_f32 v106, s37, v106
v_mfma_f32_16x16x32_bf16 v[236:239], a[204:207], a[8:11], v[236:239]
s_waitcnt lgkmcnt(15)
ds_read_b64_tr_b16 a[248:249], v8 offset:49152
v_mul_f32 v107, s37, v107
v_mfma_f32_16x16x32_bf16 v[128:131], a[208:211], a[24:27], v[128:131]
ds_read_b64_tr_b16 a[250:251], v8 offset:51200
v_cvt_pk_bf16_f32 v104, v104, v105
v_mfma_f32_16x16x32_bf16 v[132:135], a[208:211], a[28:31], v[132:135]
buffer_load_dwordx4 v19, s[16:19], s34 offen offset:3072 nt lds
v_mfma_f32_16x16x32_bf16 v[128:131], a[212:215], a[12:15], v[128:131]
ds_read_b64_tr_b16 a[252:253], v55 offset:0
v_cvt_pk_bf16_f32 v105, v106, v107
v_mfma_f32_16x16x32_bf16 v[132:135], a[212:215], a[16:19], v[132:135]
s_waitcnt lgkmcnt(15)
ds_read_b64_tr_b16 a[254:255], v55 offset:2048
v_mul_f32 v108, s37, v108
v_mfma_f32_16x16x32_bf16 v[128:131], a[216:219], a[0:3], v[128:131]
ds_read_b64_tr_b16 a[192:193], v48 offset:49408
v_mul_f32 v109, s37, v109
v_mfma_f32_16x16x32_bf16 v[132:135], a[216:219], a[4:7], v[132:135]
ds_read_b64_tr_b16 a[194:195], v48 offset:51456
v_mul_f32 v110, s37, v110
v_mfma_f32_16x16x32_bf16 v[136:139], a[220:223], a[24:27], v[136:139]
ds_read_b64_tr_b16 a[196:197], v1 offset:49408
v_mul_f32 v111, s37, v111
v_mfma_f32_16x16x32_bf16 v[140:143], a[220:223], a[28:31], v[140:143]
s_waitcnt lgkmcnt(15)
ds_read_b64_tr_b16 a[198:199], v1 offset:51456
s_add_u32 m0, s33, 131072
v_mfma_f32_16x16x32_bf16 v[136:139], a[224:227], a[12:15], v[136:139]
s_add_u32 s35, s40, 16384
ds_read_b64_tr_b16 a[200:201], v48 offset:256
s_and_b32 s35, s35, 524287
v_mfma_f32_16x16x32_bf16 v[140:143], a[224:227], a[16:19], v[140:143]
ds_read_b64_tr_b16 a[202:203], v48 offset:2304
v_cvt_pk_bf16_f32 v108, v108, v109
v_mfma_f32_16x16x32_bf16 v[136:139], a[228:231], a[0:3], v[136:139]
buffer_load_dwordx4 v20, s[20:23], s35 offen offset:0 nt lds
v_mfma_f32_16x16x32_bf16 v[140:143], a[228:231], a[4:7], v[140:143]
s_waitcnt lgkmcnt(14)
ds_read_b64_tr_b16 a[204:205], v49 offset:49408
v_cvt_pk_bf16_f32 v109, v110, v111
v_mfma_f32_16x16x32_bf16 v[144:147], a[232:235], a[24:27], v[144:147]
ds_read_b64_tr_b16 a[206:207], v49 offset:51456
v_mul_f32 v228, s37, v228
v_mfma_f32_16x16x32_bf16 v[148:151], a[232:235], a[28:31], v[148:151]
ds_read_b64_tr_b16 a[208:209], v2 offset:49408
v_mul_f32 v229, s37, v229
v_mfma_f32_16x16x32_bf16 v[144:147], a[236:239], a[12:15], v[144:147]
ds_read_b64_tr_b16 a[210:211], v2 offset:51456
v_mul_f32 v230, s37, v230
v_mfma_f32_16x16x32_bf16 v[148:151], a[236:239], a[16:19], v[148:151]
s_waitcnt lgkmcnt(14)
ds_read_b64_tr_b16 a[212:213], v49 offset:256
v_mul_f32 v231, s37, v231
v_mfma_f32_16x16x32_bf16 v[144:147], a[240:243], a[0:3], v[144:147]
ds_read_b64_tr_b16 a[214:215], v49 offset:2304
v_cvt_pk_bf16_f32 v228, v228, v229
v_mfma_f32_16x16x32_bf16 v[148:151], a[240:243], a[4:7], v[148:151]
buffer_load_dwordx4 v21, s[20:23], s35 offen offset:1024 nt lds
v_mfma_f32_16x16x32_bf16 v[152:155], a[244:247], a[24:27], v[152:155]
ds_read_b64_tr_b16 a[216:217], v50 offset:49408
v_cvt_pk_bf16_f32 v229, v230, v231
v_mfma_f32_16x16x32_bf16 v[156:159], a[244:247], a[28:31], v[156:159]
s_waitcnt lgkmcnt(13)
ds_read_b64_tr_b16 a[218:219], v50 offset:51456
v_mul_f32 v112, s37, v112
v_mfma_f32_16x16x32_bf16 v[152:155], a[248:251], a[12:15], v[152:155]
ds_read_b64_tr_b16 a[220:221], v3 offset:49408
v_mul_f32 v113, s37, v113
v_mfma_f32_16x16x32_bf16 v[156:159], a[248:251], a[16:19], v[156:159]
ds_read_b64_tr_b16 a[222:223], v3 offset:51456
v_mul_f32 v114, s37, v114
v_mfma_f32_16x16x32_bf16 v[152:155], a[252:255], a[0:3], v[152:155]
ds_read_b64_tr_b16 a[224:225], v50 offset:256
v_mul_f32 v115, s37, v115
v_mfma_f32_16x16x32_bf16 v[156:159], a[252:255], a[4:7], v[156:159]
s_waitcnt lgkmcnt(13)
ds_read_b64_tr_b16 a[226:227], v50 offset:2304
v_cvt_pk_bf16_f32 v112, v112, v113
v_mfma_f32_16x16x32_bf16 v[160:163], a[192:195], a[24:27], v[160:163]
ds_read_b64_tr_b16 a[228:229], v51 offset:49408
v_cvt_pk_bf16_f32 v113, v114, v115
v_mfma_f32_16x16x32_bf16 v[164:167], a[192:195], a[28:31], v[164:167]
ds_read_b64_tr_b16 a[230:231], v51 offset:51456
v_mul_f32 v116, s37, v116
v_mfma_f32_16x16x32_bf16 v[240:243], a[192:195], a[32:35], v[240:243]
ds_read_b64_tr_b16 a[232:233], v4 offset:49408
v_mul_f32 v117, s37, v117
v_mfma_f32_16x16x32_bf16 v[160:163], a[196:199], a[12:15], v[160:163]
ds_read_b64_tr_b16 a[234:235], v4 offset:51456
v_mul_f32 v118, s37, v118
v_mfma_f32_16x16x32_bf16 v[164:167], a[196:199], a[16:19], v[164:167]
ds_read_b64_tr_b16 a[236:237], v51 offset:256
v_mul_f32 v119, s37, v119
v_mfma_f32_16x16x32_bf16 v[240:243], a[196:199], a[20:23], v[240:243]
s_waitcnt lgkmcnt(15)
ds_read_b64_tr_b16 a[238:239], v51 offset:2304
s_add_u32 m0, s33, 131072
v_mfma_f32_16x16x32_bf16 v[160:163], a[200:203], a[0:3], v[160:163]
s_add_u32 s35, s40, 16384
ds_read_b64_tr_b16 a[240:241], v52 offset:49408
s_and_b32 s35, s35, 524287
v_mfma_f32_16x16x32_bf16 v[164:167], a[200:203], a[4:7], v[164:167]
ds_read_b64_tr_b16 a[242:243], v52 offset:51456
v_cvt_pk_bf16_f32 v116, v116, v117
v_mfma_f32_16x16x32_bf16 v[240:243], a[200:203], a[8:11], v[240:243]
buffer_load_dwordx4 v22, s[20:23], s35 offen offset:2048 nt lds
v_mfma_f32_16x16x32_bf16 v[168:171], a[204:207], a[24:27], v[168:171]
ds_read_b64_tr_b16 a[244:245], v5 offset:49408
v_cvt_pk_bf16_f32 v117, v118, v119
v_mfma_f32_16x16x32_bf16 v[172:175], a[204:207], a[28:31], v[172:175]
ds_read_b64_tr_b16 a[246:247], v5 offset:51456
v_mul_f32 v232, s37, v232
v_mfma_f32_16x16x32_bf16 v[244:247], a[204:207], a[32:35], v[244:247]
s_waitcnt lgkmcnt(15)
ds_read_b64_tr_b16 a[248:249], v52 offset:256
v_mul_f32 v233, s37, v233
v_mfma_f32_16x16x32_bf16 v[168:171], a[208:211], a[12:15], v[168:171]
ds_read_b64_tr_b16 a[250:251], v52 offset:2304
v_mul_f32 v234, s37, v234
v_mfma_f32_16x16x32_bf16 v[172:175], a[208:211], a[16:19], v[172:175]
ds_read_b64_tr_b16 a[252:253], v53 offset:49408
v_mul_f32 v235, s37, v235
v_mfma_f32_16x16x32_bf16 v[244:247], a[208:211], a[20:23], v[244:247]
ds_read_b64_tr_b16 a[254:255], v53 offset:51456
v_cvt_pk_bf16_f32 v232, v232, v233
v_mfma_f32_16x16x32_bf16 v[168:171], a[212:215], a[0:3], v[168:171]
ds_read_b64_tr_b16 a[192:193], v6 offset:49408
v_cvt_pk_bf16_f32 v233, v234, v235
v_mfma_f32_16x16x32_bf16 v[172:175], a[212:215], a[4:7], v[172:175]
ds_read_b64_tr_b16 a[194:195], v6 offset:51456
v_mul_f32 v120, s37, v120
v_mfma_f32_16x16x32_bf16 v[244:247], a[212:215], a[8:11], v[244:247]
s_waitcnt lgkmcnt(15)
ds_read_b64_tr_b16 a[196:197], v53 offset:256
v_mul_f32 v121, s37, v121
v_mfma_f32_16x16x32_bf16 v[176:179], a[216:219], a[24:27], v[176:179]
ds_read_b64_tr_b16 a[198:199], v53 offset:2304
v_mul_f32 v122, s37, v122
v_mfma_f32_16x16x32_bf16 v[180:183], a[216:219], a[28:31], v[180:183]
ds_read_b64_tr_b16 a[200:201], v54 offset:49408
v_mul_f32 v123, s37, v123
v_mfma_f32_16x16x32_bf16 v[248:251], a[216:219], a[32:35], v[248:251]
ds_read_b64_tr_b16 a[202:203], v54 offset:51456
v_cvt_pk_bf16_f32 v120, v120, v121
v_mfma_f32_16x16x32_bf16 v[176:179], a[220:223], a[12:15], v[176:179]
ds_read_b64_tr_b16 a[204:205], v7 offset:49408
v_cvt_pk_bf16_f32 v121, v122, v123
v_mfma_f32_16x16x32_bf16 v[180:183], a[220:223], a[16:19], v[180:183]
ds_read_b64_tr_b16 a[206:207], v7 offset:51456
v_mul_f32 v124, s37, v124
v_mfma_f32_16x16x32_bf16 v[248:251], a[220:223], a[20:23], v[248:251]
s_waitcnt lgkmcnt(15)
ds_read_b64_tr_b16 a[208:209], v54 offset:256
v_mul_f32 v125, s37, v125
v_mfma_f32_16x16x32_bf16 v[176:179], a[224:227], a[0:3], v[176:179]
ds_read_b64_tr_b16 a[210:211], v54 offset:2304
v_mul_f32 v126, s37, v126
v_mfma_f32_16x16x32_bf16 v[180:183], a[224:227], a[4:7], v[180:183]
ds_read_b64_tr_b16 a[212:213], v55 offset:49408
v_mul_f32 v127, s37, v127
v_mfma_f32_16x16x32_bf16 v[248:251], a[224:227], a[8:11], v[248:251]
ds_read_b64_tr_b16 a[214:215], v55 offset:51456
v_cvt_pk_bf16_f32 v124, v124, v125
v_mfma_f32_16x16x32_bf16 v[184:187], a[228:231], a[24:27], v[184:187]
ds_read_b64_tr_b16 a[216:217], v8 offset:49408
v_cvt_pk_bf16_f32 v125, v126, v127
v_mfma_f32_16x16x32_bf16 v[188:191], a[228:231], a[28:31], v[188:191]
ds_read_b64_tr_b16 a[218:219], v8 offset:51456
v_mul_f32 v236, s37, v236
v_mfma_f32_16x16x32_bf16 v[252:255], a[228:231], a[32:35], v[252:255]
ds_read_b64_tr_b16 a[220:221], v55 offset:256
v_mul_f32 v237, s37, v237
v_mfma_f32_16x16x32_bf16 v[184:187], a[232:235], a[12:15], v[184:187]
ds_read_b64_tr_b16 a[222:223], v55 offset:2304
v_mul_f32 v238, s37, v238
v_mfma_f32_16x16x32_bf16 v[188:191], a[232:235], a[16:19], v[188:191]
v_mul_f32 v239, s37, v239
v_cvt_pk_bf16_f32 v236, v236, v237
v_mfma_f32_16x16x32_bf16 v[252:255], a[232:235], a[20:23], v[252:255]
v_cvt_pk_bf16_f32 v237, v238, v239
v_mul_f32 v128, s37, v128
v_mfma_f32_16x16x32_bf16 v[184:187], a[236:239], a[0:3], v[184:187]
v_mul_f32 v129, s37, v129
v_mul_f32 v130, s37, v130
v_mfma_f32_16x16x32_bf16 v[188:191], a[236:239], a[4:7], v[188:191]
v_mul_f32 v131, s37, v131
v_cvt_pk_bf16_f32 v128, v128, v129
v_mfma_f32_16x16x32_bf16 v[252:255], a[236:239], a[8:11], v[252:255]
s_waitcnt lgkmcnt(15)
v_cvt_pk_bf16_f32 v129, v130, v131
v_mul_f32 v132, s37, v132
v_mfma_f32_16x16x32_bf16 v[192:195], a[240:243], a[24:27], v[192:195]
v_mul_f32 v133, s37, v133
v_mul_f32 v134, s37, v134
v_mfma_f32_16x16x32_bf16 v[196:199], a[240:243], a[28:31], v[196:199]
v_mul_f32 v135, s37, v135
v_cvt_pk_bf16_f32 v132, v132, v133
v_cvt_pk_bf16_f32 v133, v134, v135
s_waitcnt lgkmcnt(0)
s_barrier
buffer_load_dwordx4 v23, s[20:23], s35 offen offset:3072 nt lds
ds_write_b64 v59, v[96:97] offset:0
v_mul_f32 v136, s37, v136
v_mul_f32 v137, s37, v137
v_mfma_f32_16x16x32_bf16 v[192:195], a[244:247], a[12:15], v[192:195]
v_mul_f32 v138, s37, v138
v_mul_f32 v139, s37, v139
ds_write_b64 v59, v[100:101] offset:8192
v_cvt_pk_bf16_f32 v136, v136, v137
v_cvt_pk_bf16_f32 v137, v138, v139
v_mfma_f32_16x16x32_bf16 v[196:199], a[244:247], a[16:19], v[196:199]
v_mul_f32 v140, s37, v140
v_mul_f32 v141, s37, v141
ds_write_b64 v61, v[224:225] offset:0
v_mul_f32 v142, s37, v142
v_mul_f32 v143, s37, v143
v_mfma_f32_16x16x32_bf16 v[192:195], a[248:251], a[0:3], v[192:195]
v_cvt_pk_bf16_f32 v140, v140, v141
v_cvt_pk_bf16_f32 v141, v142, v143
ds_write_b64 v59, v[104:105] offset:512
v_mul_f32 v144, s37, v144
v_mul_f32 v145, s37, v145
v_mfma_f32_16x16x32_bf16 v[196:199], a[248:251], a[4:7], v[196:199]
v_mul_f32 v146, s37, v146
v_mul_f32 v147, s37, v147
ds_write_b64 v59, v[108:109] offset:8704
v_cvt_pk_bf16_f32 v144, v144, v145
v_cvt_pk_bf16_f32 v145, v146, v147
v_mfma_f32_16x16x32_bf16 v[200:203], a[252:255], a[24:27], v[200:203]
v_mul_f32 v148, s37, v148
v_mul_f32 v149, s37, v149
ds_write_b64 v61, v[228:229] offset:512
v_mul_f32 v150, s37, v150
v_mul_f32 v151, s37, v151
v_mfma_f32_16x16x32_bf16 v[204:207], a[252:255], a[28:31], v[204:207]
v_cvt_pk_bf16_f32 v148, v148, v149
v_cvt_pk_bf16_f32 v149, v150, v151
ds_write_b64 v59, v[112:113] offset:1024
v_mul_f32 v152, s37, v152
v_mul_f32 v153, s37, v153
v_mfma_f32_16x16x32_bf16 v[200:203], a[192:195], a[12:15], v[200:203]
v_mul_f32 v154, s37, v154
v_mul_f32 v155, s37, v155
ds_write_b64 v59, v[116:117] offset:9216
v_cvt_pk_bf16_f32 v152, v152, v153
v_cvt_pk_bf16_f32 v153, v154, v155
v_mfma_f32_16x16x32_bf16 v[204:207], a[192:195], a[16:19], v[204:207]
v_mul_f32 v156, s37, v156
v_mul_f32 v157, s37, v157
s_add_u32 s34, s40, 49152
s_and_b32 s34, s34, 524287
buffer_load_dwordx4 a[224:227], v16, s[16:19], s34 offen offset:0 nt
ds_write_b64 v61, v[232:233] offset:1024
v_mul_f32 v158, s37, v158
v_mul_f32 v159, s37, v159
v_mfma_f32_16x16x32_bf16 v[200:203], a[196:199], a[0:3], v[200:203]
v_cvt_pk_bf16_f32 v156, v156, v157
v_cvt_pk_bf16_f32 v157, v158, v159
ds_write_b64 v59, v[120:121] offset:1536
v_mul_f32 v160, s37, v160
v_mul_f32 v161, s37, v161
v_mfma_f32_16x16x32_bf16 v[204:207], a[196:199], a[4:7], v[204:207]
v_mul_f32 v162, s37, v162
v_mul_f32 v163, s37, v163
ds_write_b64 v59, v[124:125] offset:9728
v_cvt_pk_bf16_f32 v160, v160, v161
v_cvt_pk_bf16_f32 v161, v162, v163
v_mfma_f32_16x16x32_bf16 v[208:211], a[200:203], a[24:27], v[208:211]
v_mul_f32 v164, s37, v164
v_mul_f32 v165, s37, v165
ds_write_b64 v61, v[236:237] offset:1536
v_mul_f32 v166, s37, v166
v_mul_f32 v167, s37, v167
v_mfma_f32_16x16x32_bf16 v[212:215], a[200:203], a[28:31], v[212:215]
v_cvt_pk_bf16_f32 v164, v164, v165
v_cvt_pk_bf16_f32 v165, v166, v167
ds_read_b128 a[160:163], v9 offset:0
v_mul_f32 v240, s37, v240
v_mul_f32 v241, s37, v241
v_mfma_f32_16x16x32_bf16 v[208:211], a[204:207], a[12:15], v[208:211]
v_mul_f32 v242, s37, v242
v_mul_f32 v243, s37, v243
buffer_load_dwordx4 a[228:231], v17, s[16:19], s34 offen offset:1024 nt
ds_read_b128 a[164:167], v10 offset:0
v_cvt_pk_bf16_f32 v240, v240, v241
v_cvt_pk_bf16_f32 v241, v242, v243
v_mfma_f32_16x16x32_bf16 v[212:215], a[204:207], a[16:19], v[212:215]
v_mul_f32 v168, s37, v168
v_mul_f32 v169, s37, v169
ds_read_b128 a[168:171], v11 offset:0
v_mul_f32 v170, s37, v170
v_mul_f32 v171, s37, v171
v_mfma_f32_16x16x32_bf16 v[208:211], a[208:211], a[0:3], v[208:211]
v_cvt_pk_bf16_f32 v168, v168, v169
v_cvt_pk_bf16_f32 v169, v170, v171
ds_read_b128 a[172:175], v12 offset:0
v_mul_f32 v172, s37, v172
v_mul_f32 v173, s37, v173
v_mfma_f32_16x16x32_bf16 v[212:215], a[208:211], a[4:7], v[212:215]
v_mul_f32 v174, s37, v174
v_mul_f32 v175, s37, v175
ds_read_b128 a[176:179], v9 offset:256
v_cvt_pk_bf16_f32 v172, v172, v173
v_cvt_pk_bf16_f32 v173, v174, v175
v_mfma_f32_16x16x32_bf16 v[216:219], a[212:215], a[24:27], v[216:219]
v_mul_f32 v244, s37, v244
v_mul_f32 v245, s37, v245
ds_read_b128 a[180:183], v10 offset:256
v_mul_f32 v246, s37, v246
v_mul_f32 v247, s37, v247
v_mfma_f32_16x16x32_bf16 v[220:223], a[212:215], a[28:31], v[220:223]
v_cvt_pk_bf16_f32 v244, v244, v245
v_cvt_pk_bf16_f32 v245, v246, v247
buffer_load_dwordx4 a[232:235], v18, s[16:19], s34 offen offset:2048 nt
ds_read_b128 a[184:187], v11 offset:256
v_mul_f32 v176, s37, v176
v_mul_f32 v177, s37, v177
v_mfma_f32_16x16x32_bf16 v[216:219], a[216:219], a[12:15], v[216:219]
v_mul_f32 v178, s37, v178
v_mul_f32 v179, s37, v179
ds_read_b128 a[188:191], v12 offset:256
v_cvt_pk_bf16_f32 v176, v176, v177
v_cvt_pk_bf16_f32 v177, v178, v179
v_mfma_f32_16x16x32_bf16 v[220:223], a[216:219], a[16:19], v[220:223]
v_mul_f32 v180, s37, v180
v_mul_f32 v181, s37, v181
ds_write_b64 v60, v[128:129] offset:0
v_mul_f32 v182, s37, v182
v_mul_f32 v183, s37, v183
v_mfma_f32_16x16x32_bf16 v[216:219], a[220:223], a[0:3], v[216:219]
v_cvt_pk_bf16_f32 v180, v180, v181
v_cvt_pk_bf16_f32 v181, v182, v183
ds_write_b64 v60, v[132:133] offset:8192
v_mul_f32 v248, s37, v248
v_mul_f32 v249, s37, v249
v_mfma_f32_16x16x32_bf16 v[220:223], a[220:223], a[4:7], v[220:223]
v_mul_f32 v250, s37, v250
v_mul_f32 v251, s37, v251
ds_write_b64 v60, v[136:137] offset:512
v_cvt_pk_bf16_f32 v248, v248, v249
v_cvt_pk_bf16_f32 v249, v250, v251
v_pk_mul_f32 v[184:185], v[184:185], s[36:37] op_sel:[0,1] op_sel_hi:[1,1]
buffer_load_dwordx4 a[236:239], v19, s[16:19], s34 offen offset:3072 nt
ds_write_b64 v60, v[140:141] offset:8704
v_pk_mul_f32 v[186:187], v[186:187], s[36:37] op_sel:[0,1] op_sel_hi:[1,1]
v_cvt_pk_bf16_f32 v184, v184, v185
v_cvt_pk_bf16_f32 v185, v186, v187
ds_write_b64 v60, v[144:145] offset:1024
v_pk_mul_f32 v[188:189], v[188:189], s[36:37] op_sel:[0,1] op_sel_hi:[1,1]
v_pk_mul_f32 v[190:191], v[190:191], s[36:37] op_sel:[0,1] op_sel_hi:[1,1]
ds_write_b64 v60, v[148:149] offset:9216
v_cvt_pk_bf16_f32 v188, v188, v189
v_cvt_pk_bf16_f32 v189, v190, v191
v_pk_mul_f32 v[252:253], v[252:253], s[36:37] op_sel:[0,1] op_sel_hi:[1,1]
ds_write_b64 v60, v[152:153] offset:1536
v_pk_mul_f32 v[254:255], v[254:255], s[36:37] op_sel:[0,1] op_sel_hi:[1,1]
v_cvt_pk_bf16_f32 v252, v252, v253
v_cvt_pk_bf16_f32 v253, v254, v255
ds_write_b64 v60, v[156:157] offset:9728
v_pk_mul_f32 v[192:193], v[192:193], s[36:37] op_sel:[0,1] op_sel_hi:[1,1]
v_pk_mul_f32 v[194:195], v[194:195], s[36:37] op_sel:[0,1] op_sel_hi:[1,1]
s_add_u32 s34, s40, 65536
s_and_b32 s34, s34, 524287
buffer_load_dwordx4 a[192:195], v16, s[16:19], s34 offen offset:0 nt
ds_write_b64 v59, v[160:161] offset:4096
v_cvt_pk_bf16_f32 v192, v192, v193
v_cvt_pk_bf16_f32 v193, v194, v195
v_pk_mul_f32 v[196:197], v[196:197], s[36:37] op_sel:[0,1] op_sel_hi:[1,1]
ds_write_b64 v59, v[164:165] offset:12288
v_pk_mul_f32 v[198:199], v[198:199], s[36:37] op_sel:[0,1] op_sel_hi:[1,1]
v_cvt_pk_bf16_f32 v196, v196, v197
v_cvt_pk_bf16_f32 v197, v198, v199
ds_write_b64 v61, v[240:241] offset:4096
v_pk_mul_f32 v[200:201], v[200:201], s[36:37] op_sel:[0,1] op_sel_hi:[1,1]
v_pk_mul_f32 v[202:203], v[202:203], s[36:37] op_sel:[0,1] op_sel_hi:[1,1]
ds_write_b64 v59, v[168:169] offset:4608
v_cvt_pk_bf16_f32 v200, v200, v201
v_cvt_pk_bf16_f32 v201, v202, v203
v_pk_mul_f32 v[204:205], v[204:205], s[36:37] op_sel:[0,1] op_sel_hi:[1,1]
ds_write_b64 v59, v[172:173] offset:12800
v_pk_mul_f32 v[206:207], v[206:207], s[36:37] op_sel:[0,1] op_sel_hi:[1,1]
v_cvt_pk_bf16_f32 v204, v204, v205
v_cvt_pk_bf16_f32 v205, v206, v207
buffer_load_dwordx4 a[196:199], v17, s[16:19], s34 offen offset:1024 nt
ds_write_b64 v61, v[244:245] offset:4608
v_pk_mul_f32 v[208:209], v[208:209], s[36:37] op_sel:[0,1] op_sel_hi:[1,1]
v_pk_mul_f32 v[210:211], v[210:211], s[36:37] op_sel:[0,1] op_sel_hi:[1,1]
ds_write_b64 v59, v[176:177] offset:5120
v_cvt_pk_bf16_f32 v208, v208, v209
v_cvt_pk_bf16_f32 v209, v210, v211
v_pk_mul_f32 v[212:213], v[212:213], s[36:37] op_sel:[0,1] op_sel_hi:[1,1]
ds_write_b64 v59, v[180:181] offset:13312
v_pk_mul_f32 v[214:215], v[214:215], s[36:37] op_sel:[0,1] op_sel_hi:[1,1]
v_cvt_pk_bf16_f32 v212, v212, v213
v_cvt_pk_bf16_f32 v213, v214, v215
ds_write_b64 v61, v[248:249] offset:5120
v_pk_mul_f32 v[216:217], v[216:217], s[36:37] op_sel:[0,1] op_sel_hi:[1,1]
v_pk_mul_f32 v[218:219], v[218:219], s[36:37] op_sel:[0,1] op_sel_hi:[1,1]
ds_write_b64 v59, v[184:185] offset:5632
v_cvt_pk_bf16_f32 v216, v216, v217
v_cvt_pk_bf16_f32 v217, v218, v219
v_pk_mul_f32 v[220:221], v[220:221], s[36:37] op_sel:[0,1] op_sel_hi:[1,1]
buffer_load_dwordx4 a[200:203], v18, s[16:19], s34 offen offset:2048 nt
ds_write_b64 v59, v[188:189] offset:13824
v_pk_mul_f32 v[222:223], v[222:223], s[36:37] op_sel:[0,1] op_sel_hi:[1,1]
v_cvt_pk_bf16_f32 v220, v220, v221
v_cvt_pk_bf16_f32 v221, v222, v223
ds_write_b64 v61, v[252:253] offset:5632
ds_write_b64 v60, v[192:193] offset:4096
ds_write_b64 v60, v[196:197] offset:12288
ds_write_b64 v60, v[200:201] offset:4608
buffer_load_dwordx4 a[204:207], v19, s[16:19], s34 offen offset:3072 nt
ds_write_b64 v60, v[204:205] offset:12800
ds_write_b64 v60, v[208:209] offset:5120
ds_write_b64 v60, v[212:213] offset:13312
ds_write_b64 v60, v[216:217] offset:5632
ds_write_b64 v60, v[220:221] offset:13824
v_mov_b32 v1, v15
v_xor_b32 v2, 32, v1
v_xor_b32 v3, 64, v1
v_xor_b32 v4, 96, v1
v_xor_b32 v5, 128, v1
v_xor_b32 v6, 160, v1
v_xor_b32 v7, 192, v1
v_xor_b32 v8, 224, v1
v_and_b32 v63, 8, v0
v_cmp_eq_u32 vcc, 0, v63
v_mov_b32 v64, 1065369472
s_nop 0
v_cndmask_b32 v63, 0, v64, vcc
v_xor_b32 v64, v64, v63
v_accvgpr_write_b32 a252, v63
v_accvgpr_write_b32 a253, v63
v_accvgpr_write_b32 a254, v64
v_accvgpr_write_b32 a255, v64
v_lshrrev_b32 v41, 2, v89
v_add_u32 v41, s33, v41
v_xor_b32 v40, 4096, v41
v_add_u32 v93, s33, v89
v_add_u32 v91, 65536, v93
v_mov_b32 v15, v62
s_waitcnt vmcnt(20)
s_waitcnt lgkmcnt(0)
s_barrier
ds_read_b128 a[0:3], v15 offset:0
ds_read_b128 a[4:7], v15 offset:1024
ds_read_b128 a[8:11], v15 offset:2048
ds_read_b128 a[12:15], v15 offset:3072
ds_read_b128 a[16:19], v15 offset:4096
ds_read_b128 a[20:23], v15 offset:5120
ds_read_b128 a[24:27], v15 offset:6144
ds_read_b128 a[28:31], v15 offset:7168
ds_read_b128 a[32:35], v15 offset:8192
ds_read_b128 a[36:39], v15 offset:9216
ds_read_b128 a[40:43], v15 offset:10240
s_waitcnt lgkmcnt(9)
v_mfma_f32_16x16x32_bf16 v[48:51], a[160:163], a[0:3], 0
ds_read_b128 a[44:47], v15 offset:11264
v_mfma_f32_16x16x32_bf16 v[48:51], a[164:167], a[4:7], v[48:51]
s_waitcnt lgkmcnt(8)
ds_read_b128 a[48:51], v15 offset:12288
s_add_u32 s35, s40, 32768
v_mfma_f32_16x16x32_bf16 v[48:51], a[168:171], a[8:11], v[48:51]
s_and_b32 s35, s35, 524287
ds_read_b128 a[52:55], v15 offset:13312
v_mfma_f32_16x16x32_bf16 v[48:51], a[172:175], a[12:15], v[48:51]
s_waitcnt lgkmcnt(8)
ds_read_b128 a[56:59], v15 offset:14336
v_mfma_f32_16x16x32_bf16 v[48:51], a[176:179], a[16:19], v[48:51]
ds_read_b128 a[60:63], v15 offset:15360
v_mfma_f32_16x16x32_bf16 v[48:51], a[180:183], a[20:23], v[48:51]
s_waitcnt lgkmcnt(8)
ds_read_b128 a[64:67], v15 offset:16384
v_mfma_f32_16x16x32_bf16 v[48:51], a[184:187], a[24:27], v[48:51]
ds_read_b128 a[68:71], v15 offset:17408
v_mfma_f32_16x16x32_bf16 v[48:51], a[188:191], a[28:31], v[48:51]
s_waitcnt lgkmcnt(8)
ds_read_b128 a[72:75], v15 offset:18432
v_mfma_f32_16x16x32_bf16 v[52:55], a[160:163], a[32:35], 0
ds_read_b128 a[76:79], v15 offset:19456
v_mfma_f32_16x16x32_bf16 v[52:55], a[164:167], a[36:39], v[52:55]
s_waitcnt lgkmcnt(8)
ds_read_b128 a[80:83], v15 offset:20480
v_mfma_f32_16x16x32_bf16 v[52:55], a[168:171], a[40:43], v[52:55]
ds_read_b128 a[84:87], v15 offset:21504
buffer_load_dwordx4 a[208:211], v20, s[20:23], s35 offen offset:0 nt
v_mfma_f32_16x16x32_bf16 v[52:55], a[172:175], a[44:47], v[52:55]
s_waitcnt lgkmcnt(8)
ds_read_b128 a[88:91], v15 offset:22528
v_max3_f32 v68, v48, v49, v50
v_mfma_f32_16x16x32_bf16 v[52:55], a[176:179], a[48:51], v[52:55]
ds_read_b128 a[92:95], v15 offset:23552
v_max_f32 v68, v68, v51
v_mfma_f32_16x16x32_bf16 v[52:55], a[180:183], a[52:55], v[52:55]
s_waitcnt lgkmcnt(8)
ds_read_b128 a[96:99], v15 offset:24576
v_mov_b32 v69, v68
v_mfma_f32_16x16x32_bf16 v[52:55], a[184:187], a[56:59], v[52:55]
ds_read_b128 a[100:103], v15 offset:25600
v_permlane32_swap_b32 v68, v69
v_mfma_f32_16x16x32_bf16 v[52:55], a[188:191], a[60:63], v[52:55]
s_waitcnt lgkmcnt(8)
ds_read_b128 a[104:107], v15 offset:26624
v_max_f32 v68, v68, v69
v_mfma_f32_16x16x32_bf16 v[56:59], a[160:163], a[64:67], 0
ds_read_b128 a[108:111], v15 offset:27648
v_mov_b32 v69, v68
v_mfma_f32_16x16x32_bf16 v[56:59], a[164:167], a[68:71], v[56:59]
s_waitcnt lgkmcnt(8)
ds_read_b128 a[112:115], v15 offset:28672
v_permlane16_swap_b32 v68, v69
v_mfma_f32_16x16x32_bf16 v[56:59], a[168:171], a[72:75], v[56:59]
ds_read_b128 a[116:119], v15 offset:29696
buffer_load_dwordx4 a[212:215], v21, s[20:23], s35 offen offset:1024 nt
v_mfma_f32_16x16x32_bf16 v[56:59], a[172:175], a[76:79], v[56:59]
s_waitcnt lgkmcnt(8)
ds_read_b128 a[120:123], v15 offset:30720
v_max_f32 v68, v68, v69
v_mfma_f32_16x16x32_bf16 v[56:59], a[176:179], a[80:83], v[56:59]
ds_read_b128 a[124:127], v15 offset:31744
v_mfma_f32_16x16x32_bf16 v[56:59], a[180:183], a[84:87], v[56:59]
s_waitcnt lgkmcnt(8)
ds_read_b128 a[128:131], v15 offset:32768
v_mfma_f32_16x16x32_bf16 v[56:59], a[184:187], a[88:91], v[56:59]
ds_read_b128 a[132:135], v15 offset:33792
v_mfma_f32_16x16x32_bf16 v[56:59], a[188:191], a[92:95], v[56:59]
s_waitcnt lgkmcnt(8)
ds_read_b128 a[136:139], v15 offset:34816
v_mfma_f32_16x16x32_bf16 v[60:63], a[160:163], a[96:99], 0
ds_read_b128 a[140:143], v15 offset:35840
v_mfma_f32_16x16x32_bf16 v[60:63], a[164:167], a[100:103], v[60:63]
s_waitcnt lgkmcnt(8)
ds_read_b128 a[144:147], v15 offset:36864
v_mfma_f32_16x16x32_bf16 v[60:63], a[168:171], a[104:107], v[60:63]
ds_read_b128 a[148:151], v15 offset:37888
buffer_load_dwordx4 a[216:219], v22, s[20:23], s35 offen offset:2048 nt
v_mfma_f32_16x16x32_bf16 v[60:63], a[172:175], a[108:111], v[60:63]
s_waitcnt lgkmcnt(8)
ds_read_b128 a[152:155], v15 offset:38912
v_mfma_f32_16x16x32_bf16 v[60:63], a[176:179], a[112:115], v[60:63]
ds_read_b128 a[156:159], v15 offset:39936
v_mfma_f32_16x16x32_bf16 v[60:63], a[180:183], a[116:119], v[60:63]
s_waitcnt lgkmcnt(8)
buffer_load_dwordx4 a[220:223], v23, s[20:23], s35 offen offset:3072 nt
v_mfma_f32_16x16x32_bf16 v[60:63], a[184:187], a[120:123], v[60:63]
ds_write_b32 v40, v68 offset:0
v_mfma_f32_16x16x32_bf16 v[60:63], a[188:191], a[124:127], v[60:63]
s_waitcnt lgkmcnt(7)
v_max3_f32 v72, v52, v53, v54
v_max_f32 v72, v72, v55
v_mfma_f32_16x16x32_bf16 v[64:67], a[160:163], a[128:131], 0
v_mov_b32 v73, v72
s_nop 1
v_permlane32_swap_b32 v72, v73
v_mfma_f32_16x16x32_bf16 v[64:67], a[164:167], a[132:135], v[64:67]
s_waitcnt lgkmcnt(5)
ds_read_b128 a[160:163], v9 offset:16384
v_max_f32 v72, v72, v73
v_mfma_f32_16x16x32_bf16 v[64:67], a[168:171], a[136:139], v[64:67]
ds_read_b128 a[164:167], v10 offset:16384
v_mov_b32 v73, v72
v_mfma_f32_16x16x32_bf16 v[64:67], a[172:175], a[140:143], v[64:67]
s_waitcnt lgkmcnt(5)
ds_read_b128 a[168:171], v11 offset:16384
v_permlane16_swap_b32 v72, v73
v_mfma_f32_16x16x32_bf16 v[64:67], a[176:179], a[144:147], v[64:67]
ds_read_b128 a[172:175], v12 offset:16384
v_max_f32 v72, v72, v73
v_mfma_f32_16x16x32_bf16 v[64:67], a[180:183], a[148:151], v[64:67]
s_waitcnt lgkmcnt(5)
ds_read_b128 a[176:179], v9 offset:16640
v_mfma_f32_16x16x32_bf16 v[64:67], a[184:187], a[152:155], v[64:67]
ds_read_b128 a[180:183], v10 offset:16640
v_mfma_f32_16x16x32_bf16 v[64:67], a[188:191], a[156:159], v[64:67]
ds_read_b128 a[184:187], v11 offset:16640
ds_read_b128 a[188:191], v12 offset:16640
ds_write_b32 v40, v72 offset:256
v_max3_f32 v76, v56, v57, v58
v_max_f32 v76, v76, v59
v_mov_b32 v77, v76
s_nop 1
v_permlane32_swap_b32 v76, v77
v_max_f32 v76, v76, v77
v_mov_b32 v77, v76
s_nop 1
v_permlane16_swap_b32 v76, v77
v_max_f32 v76, v76, v77
ds_write_b32 v40, v76 offset:512
v_max3_f32 v80, v60, v61, v62
v_max_f32 v80, v80, v63
v_mov_b32 v81, v80
s_nop 1
v_permlane32_swap_b32 v80, v81
v_max_f32 v80, v80, v81
v_mov_b32 v81, v80
s_nop 1
v_permlane16_swap_b32 v80, v81
v_max_f32 v80, v80, v81
ds_write_b32 v40, v80 offset:768
v_max3_f32 v84, v64, v65, v66
v_max_f32 v84, v84, v67
v_mov_b32 v85, v84
s_nop 1
v_permlane32_swap_b32 v84, v85
v_max_f32 v84, v84, v85
v_mov_b32 v85, v84
s_nop 1
v_permlane16_swap_b32 v84, v85
v_max_f32 v84, v84, v85
ds_write_b32 v40, v84 offset:1024
s_waitcnt lgkmcnt(0)
s_barrier
ds_read_b32 v69, v41 offset:0
ds_read_b32 v73, v41 offset:256
ds_read_b32 v77, v41 offset:512
ds_read_b32 v81, v41 offset:768
ds_read_b32 v85, v41 offset:1024
s_waitcnt vmcnt(11)
ds_write_b128 v93, a[224:227] offset:49152
s_waitcnt vmcnt(10)
ds_write_b128 v93, a[228:231] offset:50176
s_waitcnt vmcnt(9)
ds_write_b128 v93, a[232:235] offset:51200
s_waitcnt vmcnt(8)
ds_write_b128 v93, a[236:239] offset:52224
s_waitcnt lgkmcnt(8)
v_max_f32 v68, v68, v69
v_sub_f32 v68, 3254779904, v68
v_add_f32 v48, v48, v68
v_add_f32 v49, v49, v68
v_add_f32 v50, v50, v68
v_add_f32 v51, v51, v68
v_exp_f32 v48, v48
v_exp_f32 v49, v49
v_exp_f32 v50, v50
v_exp_f32 v51, v51
v_mov_b32 v69, v68
v_mov_b32 v70, v68
v_mov_b32 v71, v68
v_cvt_pk_bf16_f32 v28, v48, v49
v_cvt_pk_bf16_f32 v29, v50, v51
ds_write_b64 v14, v[28:29] offset:0
s_add_u32 m0, s33, 16384
s_add_u32 s34, s40, 81920
s_and_b32 s34, s34, 524287
buffer_load_dwordx4 v16, s[16:19], s34 offen offset:0 nt lds
buffer_load_dwordx4 v17, s[16:19], s34 offen offset:1024 nt lds
s_waitcnt lgkmcnt(8)
v_max_f32 v72, v72, v73
v_sub_f32 v72, 3254779904, v72
v_add_f32 v52, v52, v72
v_add_f32 v53, v53, v72
v_add_f32 v54, v54, v72
v_add_f32 v55, v55, v72
v_exp_f32 v52, v52
v_exp_f32 v53, v53
v_exp_f32 v54, v54
v_exp_f32 v55, v55
v_mov_b32 v73, v72
v_mov_b32 v74, v72
v_mov_b32 v75, v72
v_cvt_pk_bf16_f32 v30, v52, v53
v_cvt_pk_bf16_f32 v31, v54, v55
ds_write_b64 v14, v[30:31] offset:1024
s_add_u32 m0, s33, 16384
s_add_u32 s34, s40, 81920
s_and_b32 s34, s34, 524287
buffer_load_dwordx4 v18, s[16:19], s34 offen offset:2048 nt lds
buffer_load_dwordx4 v19, s[16:19], s34 offen offset:3072 nt lds
s_waitcnt lgkmcnt(8)
v_max_f32 v76, v76, v77
v_sub_f32 v76, 3254779904, v76
v_add_f32 v56, v56, v76
v_add_f32 v57, v57, v76
v_add_f32 v58, v58, v76
v_add_f32 v59, v59, v76
v_exp_f32 v56, v56
v_exp_f32 v57, v57
v_exp_f32 v58, v58
v_exp_f32 v59, v59
v_mov_b32 v77, v76
v_mov_b32 v78, v76
v_mov_b32 v79, v76
v_cvt_pk_bf16_f32 v32, v56, v57
v_cvt_pk_bf16_f32 v33, v58, v59
ds_write_b64 v14, v[32:33] offset:2048
s_waitcnt lgkmcnt(8)
v_max_f32 v80, v80, v81
v_sub_f32 v80, 3254779904, v80
v_add_f32 v60, v60, v80
v_add_f32 v61, v61, v80
v_add_f32 v62, v62, v80
v_add_f32 v63, v63, v80
v_exp_f32 v60, v60
v_exp_f32 v61, v61
v_exp_f32 v62, v62
v_exp_f32 v63, v63
v_mov_b32 v81, v80
v_mov_b32 v82, v80
v_mov_b32 v83, v80
v_cvt_pk_bf16_f32 v34, v60, v61
v_cvt_pk_bf16_f32 v35, v62, v63
ds_write_b64 v14, v[34:35] offset:3072
s_waitcnt lgkmcnt(8)
v_max_f32 v84, v84, v85
v_sub_f32 v84, 3254779904, v84
v_add_f32 v64, v64, v84
v_add_f32 v65, v65, v84
v_add_f32 v66, v66, v84
v_add_f32 v67, v67, v84
v_exp_f32 v64, v64
v_exp_f32 v65, v65
v_exp_f32 v66, v66
v_exp_f32 v67, v67
v_mov_b32 v85, v84
v_mov_b32 v86, v84
v_mov_b32 v87, v84
v_cvt_pk_bf16_f32 v36, v64, v65
v_cvt_pk_bf16_f32 v37, v66, v67
ds_write_b64 v14, v[36:37] offset:4096
v_mfma_f32_16x16x32_bf16 a[240:243], a[252:255], v[28:31], 0
v_mfma_f32_16x16x32_bf16 a[244:247], a[252:255], v[32:35], 0
v_mfma_f32_16x16x32_bf16 a[248:251], a[252:255], v[36:39], 0
s_mov_b32 s36, 0
s_and_b32 s57, s2, 1
s_cmp_ge_u32 s2, 256
s_cselect_b32 s58, 2, 0
s_or_b32 s57, s57, s58
s_waitcnt lgkmcnt(0)
s_barrier
ds_read_b128 v[24:27], v13 offset:0
v_mfma_f32_16x16x32_bf16 v[48:51], a[160:163], a[0:3], v[68:71]
s_memrealtime s[62:63]
ds_read_b128 a[224:227], v13 offset:1024
s_and_b32 s3, s2, 4
v_mfma_f32_16x16x32_bf16 v[48:51], a[164:167], a[4:7], v[48:51]
s_lshl_b32 s3, s3, 1
ds_read_b128 a[228:231], v13 offset:2048
s_lshr_b32 s41, s2, 5
v_mfma_f32_16x16x32_bf16 v[48:51], a[168:171], a[8:11], v[48:51]
s_add_u32 s3, s3, s41
ds_read_b128 a[232:235], v13 offset:3072
s_lshl_b32 s3, s3, 4
ds_read_b128 a[236:239], v13 offset:4096
v_mfma_f32_16x16x32_bf16 v[48:51], a[172:175], a[12:15], v[48:51]
s_add_u32 s8, s98, s3
s_addc_u32 s9, s99, 0
s_mov_b32 s10, 0
v_mfma_f32_16x16x32_bf16 v[48:51], a[176:179], a[16:19], v[48:51]
s_mov_b32 s11, 0x20000
s_cmp_eq_u32 s32, 0
s_cselect_b32 s10, 16, 0
v_mfma_f32_16x16x32_bf16 v[48:51], a[180:183], a[20:23], v[48:51]
buffer_load_dword v92, v89, s[8:11], 0 offen offset:8
v_mfma_f32_16x16x32_bf16 v[48:51], a[184:187], a[24:27], v[48:51]
s_add_u32 m0, s33, 98304
s_add_u32 s35, s40, 49152
s_and_b32 s35, s35, 524287
v_mfma_f32_16x16x32_bf16 v[48:51], a[188:191], a[28:31], v[48:51]
buffer_load_dwordx4 v20, s[20:23], s35 offen offset:0 nt lds
v_mfma_f32_16x16x32_bf16 v[52:55], a[160:163], a[32:35], v[72:75]
buffer_load_dwordx4 v21, s[20:23], s35 offen offset:1024 nt lds
v_mfma_f32_16x16x32_bf16 v[52:55], a[164:167], a[36:39], v[52:55]
v_mfma_f32_16x16x32_bf16 v[52:55], a[168:171], a[40:43], v[52:55]
v_mfma_f32_16x16x32_bf16 v[52:55], a[172:175], a[44:47], v[52:55]
s_waitcnt vmcnt(14)
ds_write_b128 v93, a[192:195] offset:0
v_mfma_f32_16x16x32_bf16 v[52:55], a[176:179], a[48:51], v[52:55]
buffer_load_dwordx4 v22, s[20:23], s35 offen offset:2048 nt lds
v_mfma_f32_16x16x32_bf16 v[52:55], a[180:183], a[52:55], v[52:55]
s_waitcnt lgkmcnt(5)
v_or_b32 v15, v24, v26
v_cmp_gt_i32 vcc, 0, v15
v_mfma_f32_16x16x32_bf16 v[52:55], a[184:187], a[56:59], v[52:55]
s_waitcnt vmcnt(14)
ds_write_b128 v93, a[196:199] offset:1024
v_mfma_f32_16x16x32_bf16 v[52:55], a[188:191], a[60:63], v[52:55]
s_cbranch_vccnz L_R_t0
L_Rr_t0:
v_mfma_f32_16x16x32_bf16 v[56:59], a[160:163], a[64:67], v[76:79]
s_waitcnt vmcnt(13)
ds_write_b128 v93, a[200:203] offset:2048
v_mfma_f32_16x16x32_bf16 v[56:59], a[164:167], a[68:71], v[56:59]
buffer_load_dwordx4 v23, s[20:23], s35 offen offset:3072 nt lds
v_mfma_f32_16x16x32_bf16 v[56:59], a[168:171], a[72:75], v[56:59]
s_waitcnt vmcnt(13)
ds_write_b128 v93, a[204:207] offset:3072
v_mfma_f32_16x16x32_bf16 v[56:59], a[172:175], a[76:79], v[56:59]
s_add_u32 s34, s40, 98304
s_and_b32 s34, s34, 524287
s_add_u32 s35, s40, 65536
v_mfma_f32_16x16x32_bf16 v[56:59], a[176:179], a[80:83], v[56:59]
s_and_b32 s35, s35, 524287
v_exp_f32 v40, v48
v_mfma_f32_16x16x32_bf16 v[56:59], a[180:183], a[84:87], v[56:59]
ds_read_b64_tr_b16 a[192:193], v1 offset:49152
v_mfma_f32_16x16x32_bf16 v[56:59], a[184:187], a[88:91], v[56:59]
ds_read_b64_tr_b16 a[194:195], v1 offset:57344
v_mfma_f32_16x16x32_bf16 v[56:59], a[188:191], a[92:95], v[56:59]
ds_read_b64_tr_b16 a[196:197], v2 offset:49152
v_mfma_f32_16x16x32_bf16 v[60:63], a[160:163], a[96:99], v[80:83]
ds_read_b64_tr_b16 a[198:199], v2 offset:57344
v_mfma_f32_16x16x32_bf16 v[60:63], a[164:167], a[100:103], v[60:63]
ds_read_b64_tr_b16 a[200:201], v3 offset:49152
v_mfma_f32_16x16x32_bf16 v[60:63], a[168:171], a[104:107], v[60:63]
ds_read_b64_tr_b16 a[202:203], v3 offset:57344
v_mfma_f32_16x16x32_bf16 v[60:63], a[172:175], a[108:111], v[60:63]
ds_read_b64_tr_b16 a[204:205], v4 offset:49152
ds_read_b64_tr_b16 a[206:207], v4 offset:57344
v_mfma_f32_16x16x32_bf16 v[60:63], a[176:179], a[112:115], v[60:63]
v_exp_f32 v41, v49
v_mfma_f32_16x16x32_bf16 v[60:63], a[180:183], a[116:119], v[60:63]
v_exp_f32 v42, v50
v_mfma_f32_16x16x32_bf16 v[60:63], a[184:187], a[120:123], v[60:63]
s_waitcnt vmcnt(12)
ds_write_b128 v91, a[208:211] offset:49152
v_mfma_f32_16x16x32_bf16 v[60:63], a[188:191], a[124:127], v[60:63]
v_exp_f32 v43, v51
v_mfma_f32_16x16x32_bf16 v[64:67], a[160:163], a[128:131], v[84:87]
v_cvt_pk_bf16_f32 v28, v40, v41
v_cvt_pk_bf16_f32 v29, v42, v43
v_mfma_f32_16x16x32_bf16 v[64:67], a[164:167], a[132:135], v[64:67]
s_waitcnt vmcnt(11)
ds_write_b128 v91, a[212:215] offset:50176
v_mfma_f32_16x16x32_bf16 v[64:67], a[168:171], a[136:139], v[64:67]
v_or_b32 v15, v28, v29
v_mfma_f32_16x16x32_bf16 v[64:67], a[172:175], a[140:143], v[64:67]
v_mfma_f32_16x16x32_bf16 v[64:67], a[176:179], a[144:147], v[64:67]
s_waitcnt vmcnt(10)
ds_write_b128 v91, a[216:219] offset:51200
v_mfma_f32_16x16x32_bf16 v[64:67], a[180:183], a[148:151], v[64:67]
v_mfma_f32_16x16x32_bf16 v[64:67], a[184:187], a[152:155], v[64:67]
s_waitcnt vmcnt(9)
ds_write_b128 v91, a[220:223] offset:52224
v_mfma_f32_16x16x32_bf16 v[64:67], a[188:191], a[156:159], v[64:67]
s_waitcnt lgkmcnt(4)
v_mfma_f32_16x16x32_bf16 v[96:99], a[192:195], v[24:27], 0
v_mfma_f32_16x16x32_bf16 v[100:103], a[192:195], a[224:227], 0
ds_read_b64_tr_b16 a[208:209], v5 offset:49152
v_mfma_f32_16x16x32_bf16 v[104:107], a[192:195], a[228:231], 0
ds_read_b64_tr_b16 a[210:211], v5 offset:57344
v_mfma_f32_16x16x32_bf16 v[108:111], a[192:195], a[232:235], 0
ds_read_b64_tr_b16 a[212:213], v6 offset:49152
v_mfma_f32_16x16x32_bf16 v[112:115], a[192:195], a[236:239], 0
ds_read_b64_tr_b16 a[214:215], v6 offset:57344
v_mfma_f32_16x16x32_bf16 v[116:119], a[196:199], v[24:27], 0
ds_read_b64_tr_b16 a[216:217], v7 offset:49152
v_mfma_f32_16x16x32_bf16 v[120:123], a[196:199], a[224:227], 0
ds_read_b64_tr_b16 a[218:219], v7 offset:57344
v_mfma_f32_16x16x32_bf16 v[124:127], a[196:199], a[228:231], 0
ds_read_b64_tr_b16 a[220:221], v8 offset:49152
ds_read_b64_tr_b16 a[222:223], v8 offset:57344
v_mfma_f32_16x16x32_bf16 v[128:131], a[196:199], a[232:235], 0
ds_read_b128 a[160:163], v9 offset:32768
v_mfma_f32_16x16x32_bf16 v[132:135], a[196:199], a[236:239], 0
ds_read_b128 a[164:167], v10 offset:32768
v_mfma_f32_16x16x32_bf16 v[136:139], a[200:203], v[24:27], 0
ds_read_b128 a[168:171], v11 offset:32768
v_mfma_f32_16x16x32_bf16 v[140:143], a[200:203], a[224:227], 0
ds_read_b128 a[172:175], v12 offset:32768
v_mfma_f32_16x16x32_bf16 v[144:147], a[200:203], a[228:231], 0
ds_read_b128 a[176:179], v9 offset:33024
v_mfma_f32_16x16x32_bf16 v[148:151], a[200:203], a[232:235], 0
ds_read_b128 a[180:183], v10 offset:33024
v_mfma_f32_16x16x32_bf16 v[152:155], a[200:203], a[236:239], 0
ds_read_b128 a[184:187], v11 offset:33024
v_mfma_f32_16x16x32_bf16 v[156:159], a[204:207], v[24:27], 0
ds_read_b128 a[188:191], v12 offset:33024
v_mfma_f32_16x16x32_bf16 v[160:163], a[204:207], a[224:227], 0
ds_write_b64 v14, v[28:29] offset:10240
v_mfma_f32_16x16x32_bf16 v[164:167], a[204:207], a[228:231], 0
v_exp_f32 v44, v52
v_mfma_f32_16x16x32_bf16 v[168:171], a[204:207], a[232:235], 0
v_exp_f32 v45, v53
v_mfma_f32_16x16x32_bf16 v[172:175], a[204:207], a[236:239], 0
s_waitcnt lgkmcnt(9)
v_exp_f32 v46, v54
v_mfma_f32_16x16x32_bf16 v[176:179], a[208:211], v[24:27], 0
v_exp_f32 v47, v55
v_mfma_f32_16x16x32_bf16 v[180:183], a[208:211], a[224:227], 0
v_cvt_pk_bf16_f32 v30, v44, v45
v_cvt_pk_bf16_f32 v31, v46, v47
v_mfma_f32_16x16x32_bf16 v[184:187], a[208:211], a[228:231], 0
v_or3_b32 v15, v30, v31, v15
v_mfma_f32_16x16x32_bf16 v[188:191], a[208:211], a[232:235], 0
ds_write_b64 v14, v[30:31] offset:11264
v_mfma_f32_16x16x32_bf16 v[192:195], a[208:211], a[236:239], 0
v_exp_f32 v40, v56
v_mfma_f32_16x16x32_bf16 v[196:199], a[212:215], v[24:27], 0
v_exp_f32 v41, v57
v_mfma_f32_16x16x32_bf16 v[200:203], a[212:215], a[224:227], 0
v_exp_f32 v42, v58
v_mfma_f32_16x16x32_bf16 v[204:207], a[212:215], a[228:231], 0
v_exp_f32 v43, v59
v_mfma_f32_16x16x32_bf16 v[208:211], a[212:215], a[232:235], 0
v_cvt_pk_bf16_f32 v32, v40, v41
v_cvt_pk_bf16_f32 v33, v42, v43
v_mfma_f32_16x16x32_bf16 v[212:215], a[212:215], a[236:239], 0
v_or3_b32 v15, v32, v33, v15
v_mfma_f32_16x16x32_bf16 v[216:219], a[216:219], v[24:27], 0
ds_write_b64 v14, v[32:33] offset:12288
v_mfma_f32_16x16x32_bf16 v[220:223], a[216:219], a[224:227], 0
v_exp_f32 v44, v60
v_mfma_f32_16x16x32_bf16 v[224:227], a[216:219], a[228:231], 0
v_exp_f32 v45, v61
v_mfma_f32_16x16x32_bf16 v[228:231], a[216:219], a[232:235], 0
v_exp_f32 v46, v62
v_mfma_f32_16x16x32_bf16 v[232:235], a[216:219], a[236:239], 0
v_exp_f32 v47, v63
v_mfma_f32_16x16x32_bf16 v[236:239], a[220:223], v[24:27], 0
v_cvt_pk_bf16_f32 v34, v44, v45
v_cvt_pk_bf16_f32 v35, v46, v47
v_or3_b32 v15, v34, v35, v15
ds_write_b64 v14, v[34:35] offset:13312
v_exp_f32 v40, v64
v_exp_f32 v41, v65
v_exp_f32 v42, v66
v_exp_f32 v43, v67
v_cvt_pk_bf16_f32 v36, v40, v41
v_cvt_pk_bf16_f32 v37, v42, v43
v_or3_b32 v15, v36, v37, v15
ds_write_b64 v14, v[36:37] offset:14336
v_mfma_f32_16x16x32_bf16 v[240:243], a[220:223], a[224:227], 0
v_and_b32 v15, s43, v15
v_cmp_ne_u32 vcc, 0, v15
v_mfma_f32_16x16x32_bf16 v[244:247], a[220:223], a[228:231], 0
v_mfma_f32_16x16x32_bf16 v[248:251], a[220:223], a[232:235], 0
v_mfma_f32_16x16x32_bf16 v[252:255], a[220:223], a[236:239], 0
s_cbranch_vccnz L_D_t0
L_Dr_t0:
v_mfma_f32_16x16x32_bf16 a[240:243], a[252:255], v[28:31], a[240:243]
v_mfma_f32_16x16x32_bf16 a[244:247], a[252:255], v[32:35], a[244:247]
v_mfma_f32_16x16x32_bf16 a[248:251], a[252:255], v[36:39], a[248:251]
s_waitcnt vmcnt(9) lgkmcnt(0)
s_branch L_mid
s_nop 0
s_nop 0
s_nop 0
s_nop 0
L_loop:
s_barrier
ds_read_b128 v[24:27], v13 offset:10240
v_mfma_f32_16x16x32_bf16 v[48:51], a[160:163], a[0:3], v[68:71]
s_add_u32 m0, s33, 0
ds_read_b128 a[224:227], v13 offset:11264
v_mfma_f32_16x16x32_bf16 v[48:51], a[164:167], a[4:7], v[48:51]
ds_read_b128 a[228:231], v13 offset:12288
v_mfma_f32_16x16x32_bf16 v[48:51], a[168:171], a[8:11], v[48:51]
ds_read_b128 a[232:235], v13 offset:13312
ds_read_b128 a[236:239], v13 offset:14336
v_mfma_f32_16x16x32_bf16 v[48:51], a[172:175], a[12:15], v[48:51]
buffer_load_dwordx4 v16, s[16:19], s34 offen offset:0 nt lds
v_mfma_f32_16x16x32_bf16 v[48:51], a[176:179], a[16:19], v[48:51]
ds_read_b64_tr_b16 a[192:193], v1 offset:0
v_mfma_f32_16x16x32_bf16 v[48:51], a[180:183], a[20:23], v[48:51]
buffer_load_dwordx4 v17, s[16:19], s34 offen offset:1024 nt lds
v_mfma_f32_16x16x32_bf16 v[48:51], a[184:187], a[24:27], v[48:51]
ds_read_b64_tr_b16 a[194:195], v1 offset:8192
v_mfma_f32_16x16x32_bf16 v[48:51], a[188:191], a[28:31], v[48:51]
ds_read_b64_tr_b16 a[196:197], v2 offset:0
v_mfma_f32_16x16x32_bf16 v[52:55], a[160:163], a[32:35], v[72:75]
ds_read_b64_tr_b16 a[198:199], v2 offset:8192
v_mfma_f32_16x16x32_bf16 v[52:55], a[164:167], a[36:39], v[52:55]
ds_read_b64_tr_b16 a[200:201], v3 offset:0
v_mfma_f32_16x16x32_bf16 v[52:55], a[168:171], a[40:43], v[52:55]
buffer_load_dwordx4 v18, s[16:19], s34 offen offset:2048 nt lds
v_mfma_f32_16x16x32_bf16 v[52:55], a[172:175], a[44:47], v[52:55]
ds_read_b64_tr_b16 a[202:203], v3 offset:8192
v_mfma_f32_16x16x32_bf16 v[52:55], a[176:179], a[48:51], v[52:55]
ds_read_b64_tr_b16 a[204:205], v4 offset:0
v_mfma_f32_16x16x32_bf16 v[52:55], a[180:183], a[52:55], v[52:55]
s_waitcnt lgkmcnt(11)
v_or_b32 v15, v24, v26
v_cmp_gt_i32 vcc, 0, v15
v_mfma_f32_16x16x32_bf16 v[52:55], a[184:187], a[56:59], v[52:55]
ds_read_b64_tr_b16 a[206:207], v4 offset:8192
v_mfma_f32_16x16x32_bf16 v[52:55], a[188:191], a[60:63], v[52:55]
s_cbranch_vccnz L_R_p3
L_Rr_p3:
v_mfma_f32_16x16x32_bf16 v[56:59], a[160:163], a[64:67], v[76:79]
buffer_load_dwordx4 v19, s[16:19], s34 offen offset:3072 nt lds
v_mfma_f32_16x16x32_bf16 v[56:59], a[164:167], a[68:71], v[56:59]
ds_read_b64_tr_b16 a[208:209], v5 offset:0
v_mfma_f32_16x16x32_bf16 v[56:59], a[168:171], a[72:75], v[56:59]
ds_read_b64_tr_b16 a[210:211], v5 offset:8192
v_mfma_f32_16x16x32_bf16 v[56:59], a[172:175], a[76:79], v[56:59]
s_add_u32 s34, s34, 16384
s_and_b32 s34, s34, 524287
s_add_u32 m0, s33, 114688
v_mfma_f32_16x16x32_bf16 v[56:59], a[176:179], a[80:83], v[56:59]
buffer_load_dwordx4 v20, s[20:23], s35 offen offset:0 nt lds
v_mfma_f32_16x16x32_bf16 v[56:59], a[180:183], a[84:87], v[56:59]
ds_read_b64_tr_b16 a[212:213], v6 offset:0
v_mfma_f32_16x16x32_bf16 v[56:59], a[184:187], a[88:91], v[56:59]
ds_read_b64_tr_b16 a[214:215], v6 offset:8192
v_mfma_f32_16x16x32_bf16 v[56:59], a[188:191], a[92:95], v[56:59]
ds_read_b64_tr_b16 a[216:217], v7 offset:0
v_mfma_f32_16x16x32_bf16 v[60:63], a[160:163], a[96:99], v[80:83]
buffer_load_dwordx4 v21, s[20:23], s35 offen offset:1024 nt lds
v_mfma_f32_16x16x32_bf16 v[60:63], a[164:167], a[100:103], v[60:63]
ds_read_b64_tr_b16 a[218:219], v7 offset:8192
v_mfma_f32_16x16x32_bf16 v[60:63], a[168:171], a[104:107], v[60:63]
ds_read_b64_tr_b16 a[220:221], v8 offset:0
v_mfma_f32_16x16x32_bf16 v[60:63], a[172:175], a[108:111], v[60:63]
ds_read_b64_tr_b16 a[222:223], v8 offset:8192
v_mfma_f32_16x16x32_bf16 v[60:63], a[176:179], a[112:115], v[60:63]
v_exp_f32 v40, v48
v_mfma_f32_16x16x32_bf16 v[60:63], a[180:183], a[116:119], v[60:63]
buffer_load_dwordx4 v22, s[20:23], s35 offen offset:2048 nt lds
v_mfma_f32_16x16x32_bf16 v[60:63], a[184:187], a[120:123], v[60:63]
v_exp_f32 v41, v49
v_mfma_f32_16x16x32_bf16 v[60:63], a[188:191], a[124:127], v[60:63]
v_exp_f32 v42, v50
v_mfma_f32_16x16x32_bf16 v[64:67], a[160:163], a[128:131], v[84:87]
v_exp_f32 v43, v51
v_mfma_f32_16x16x32_bf16 v[64:67], a[164:167], a[132:135], v[64:67]
ds_read_b128 a[160:163], v9 offset:16384
v_cvt_pk_bf16_f32 v28, v40, v41
v_mfma_f32_16x16x32_bf16 v[64:67], a[168:171], a[136:139], v[64:67]
buffer_load_dwordx4 v23, s[20:23], s35 offen offset:3072 nt lds
v_mfma_f32_16x16x32_bf16 v[64:67], a[172:175], a[140:143], v[64:67]
ds_read_b128 a[164:167], v10 offset:16384
v_cvt_pk_bf16_f32 v29, v42, v43
v_mfma_f32_16x16x32_bf16 v[64:67], a[176:179], a[144:147], v[64:67]
ds_read_b128 a[168:171], v11 offset:16384
v_or_b32 v15, v28, v29
v_mfma_f32_16x16x32_bf16 v[64:67], a[180:183], a[148:151], v[64:67]
ds_read_b128 a[172:175], v12 offset:16384
v_mfma_f32_16x16x32_bf16 v[64:67], a[184:187], a[152:155], v[64:67]
ds_read_b128 a[176:179], v9 offset:16640
v_mfma_f32_16x16x32_bf16 v[64:67], a[188:191], a[156:159], v[64:67]
s_waitcnt lgkmcnt(13)
s_add_u32 s35, s35, 16384
s_and_b32 s35, s35, 524287
v_mfma_f32_16x16x32_bf16 v[96:99], a[192:195], v[24:27], v[96:99]
ds_read_b128 a[180:183], v10 offset:16640
v_mfma_f32_16x16x32_bf16 v[100:103], a[192:195], a[224:227], v[100:103]
ds_read_b128 a[184:187], v11 offset:16640
v_mfma_f32_16x16x32_bf16 v[104:107], a[192:195], a[228:231], v[104:107]
ds_read_b128 a[188:191], v12 offset:16640
v_mfma_f32_16x16x32_bf16 v[108:111], a[192:195], a[232:235], v[108:111]
ds_write_b64 v14, v[28:29] offset:0
v_mfma_f32_16x16x32_bf16 v[112:115], a[192:195], a[236:239], v[112:115]
v_exp_f32 v44, v52
v_mfma_f32_16x16x32_bf16 v[116:119], a[196:199], v[24:27], v[116:119]
v_exp_f32 v45, v53
v_mfma_f32_16x16x32_bf16 v[120:123], a[196:199], a[224:227], v[120:123]
v_exp_f32 v46, v54
v_mfma_f32_16x16x32_bf16 v[124:127], a[196:199], a[228:231], v[124:127]
v_exp_f32 v47, v55
v_mfma_f32_16x16x32_bf16 v[128:131], a[196:199], a[232:235], v[128:131]
v_cvt_pk_bf16_f32 v30, v44, v45
v_cvt_pk_bf16_f32 v31, v46, v47
v_mfma_f32_16x16x32_bf16 v[132:135], a[196:199], a[236:239], v[132:135]
v_or3_b32 v15, v30, v31, v15
v_mfma_f32_16x16x32_bf16 v[136:139], a[200:203], v[24:27], v[136:139]
ds_write_b64 v14, v[30:31] offset:1024
v_mfma_f32_16x16x32_bf16 v[140:143], a[200:203], a[224:227], v[140:143]
v_exp_f32 v40, v56
v_mfma_f32_16x16x32_bf16 v[144:147], a[200:203], a[228:231], v[144:147]
v_exp_f32 v41, v57
v_mfma_f32_16x16x32_bf16 v[148:151], a[200:203], a[232:235], v[148:151]
v_exp_f32 v42, v58
v_mfma_f32_16x16x32_bf16 v[152:155], a[200:203], a[236:239], v[152:155]
v_exp_f32 v43, v59
v_mfma_f32_16x16x32_bf16 v[156:159], a[204:207], v[24:27], v[156:159]
v_cvt_pk_bf16_f32 v32, v40, v41
v_cvt_pk_bf16_f32 v33, v42, v43
v_mfma_f32_16x16x32_bf16 v[160:163], a[204:207], a[224:227], v[160:163]
v_or3_b32 v15, v32, v33, v15
v_mfma_f32_16x16x32_bf16 v[164:167], a[204:207], a[228:231], v[164:167]
ds_write_b64 v14, v[32:33] offset:2048
v_mfma_f32_16x16x32_bf16 v[168:171], a[204:207], a[232:235], v[168:171]
v_exp_f32 v44, v60
v_mfma_f32_16x16x32_bf16 v[172:175], a[204:207], a[236:239], v[172:175]
s_waitcnt lgkmcnt(11)
v_exp_f32 v45, v61
v_mfma_f32_16x16x32_bf16 v[176:179], a[208:211], v[24:27], v[176:179]
v_exp_f32 v46, v62
v_mfma_f32_16x16x32_bf16 v[180:183], a[208:211], a[224:227], v[180:183]
v_exp_f32 v47, v63
v_mfma_f32_16x16x32_bf16 v[184:187], a[208:211], a[228:231], v[184:187]
v_cvt_pk_bf16_f32 v34, v44, v45
v_cvt_pk_bf16_f32 v35, v46, v47
v_mfma_f32_16x16x32_bf16 v[188:191], a[208:211], a[232:235], v[188:191]
v_or3_b32 v15, v34, v35, v15
v_mfma_f32_16x16x32_bf16 v[192:195], a[208:211], a[236:239], v[192:195]
ds_write_b64 v14, v[34:35] offset:3072
v_mfma_f32_16x16x32_bf16 v[196:199], a[212:215], v[24:27], v[196:199]
v_exp_f32 v40, v64
v_mfma_f32_16x16x32_bf16 v[200:203], a[212:215], a[224:227], v[200:203]
v_exp_f32 v41, v65
v_mfma_f32_16x16x32_bf16 v[204:207], a[212:215], a[228:231], v[204:207]
v_exp_f32 v42, v66
v_mfma_f32_16x16x32_bf16 v[208:211], a[212:215], a[232:235], v[208:211]
v_exp_f32 v43, v67
v_mfma_f32_16x16x32_bf16 v[212:215], a[212:215], a[236:239], v[212:215]
v_cvt_pk_bf16_f32 v36, v40, v41
v_cvt_pk_bf16_f32 v37, v42, v43
v_mfma_f32_16x16x32_bf16 v[216:219], a[216:219], v[24:27], v[216:219]
v_or3_b32 v15, v36, v37, v15
v_mfma_f32_16x16x32_bf16 v[220:223], a[216:219], a[224:227], v[220:223]
ds_write_b64 v14, v[36:37] offset:4096
v_mfma_f32_16x16x32_bf16 v[224:227], a[216:219], a[228:231], v[224:227]
v_and_b32 v15, s43, v15
v_cmp_ne_u32 vcc, 0, v15
v_mfma_f32_16x16x32_bf16 v[228:231], a[216:219], a[232:235], v[228:231]
v_mfma_f32_16x16x32_bf16 v[232:235], a[216:219], a[236:239], v[232:235]
v_mfma_f32_16x16x32_bf16 v[236:239], a[220:223], v[24:27], v[236:239]
v_mfma_f32_16x16x32_bf16 v[240:243], a[220:223], a[224:227], v[240:243]
v_mfma_f32_16x16x32_bf16 v[244:247], a[220:223], a[228:231], v[244:247]
v_mfma_f32_16x16x32_bf16 v[248:251], a[220:223], a[232:235], v[248:251]
v_mfma_f32_16x16x32_bf16 v[252:255], a[220:223], a[236:239], v[252:255]
s_cbranch_vccnz L_D_p3
L_Dr_p3:
v_mfma_f32_16x16x32_bf16 a[240:243], a[252:255], v[28:31], a[240:243]
v_mfma_f32_16x16x32_bf16 a[244:247], a[252:255], v[32:35], a[244:247]
v_mfma_f32_16x16x32_bf16 a[248:251], a[252:255], v[36:39], a[248:251]
s_waitcnt vmcnt(16) lgkmcnt(0)
s_cmp_lt_u32 s57, 2
s_cbranch_scc0 L_fcp3
s_waitcnt vmcnt(4)
s_cmp_lt_u32 s57, 1
s_cbranch_scc0 L_fcp3
s_waitcnt vmcnt(3)
L_fcp3:
s_barrier
ds_read_b128 v[24:27], v13 offset:0
v_mfma_f32_16x16x32_bf16 v[48:51], a[160:163], a[0:3], v[68:71]
s_add_u32 m0, s33, 16384
ds_read_b128 a[224:227], v13 offset:1024
v_mfma_f32_16x16x32_bf16 v[48:51], a[164:167], a[4:7], v[48:51]
ds_read_b128 a[228:231], v13 offset:2048
v_mfma_f32_16x16x32_bf16 v[48:51], a[168:171], a[8:11], v[48:51]
ds_read_b128 a[232:235], v13 offset:3072
ds_read_b128 a[236:239], v13 offset:4096
v_mfma_f32_16x16x32_bf16 v[48:51], a[172:175], a[12:15], v[48:51]
buffer_load_dwordx4 v16, s[16:19], s34 offen offset:0 nt lds
v_mfma_f32_16x16x32_bf16 v[48:51], a[176:179], a[16:19], v[48:51]
ds_read_b64_tr_b16 a[192:193], v1 offset:49152
v_mfma_f32_16x16x32_bf16 v[48:51], a[180:183], a[20:23], v[48:51]
buffer_load_dwordx4 v17, s[16:19], s34 offen offset:1024 nt lds
v_mfma_f32_16x16x32_bf16 v[48:51], a[184:187], a[24:27], v[48:51]
ds_read_b64_tr_b16 a[194:195], v1 offset:57344
v_mfma_f32_16x16x32_bf16 v[48:51], a[188:191], a[28:31], v[48:51]
ds_read_b64_tr_b16 a[196:197], v2 offset:49152
v_mfma_f32_16x16x32_bf16 v[52:55], a[160:163], a[32:35], v[72:75]
ds_read_b64_tr_b16 a[198:199], v2 offset:57344
v_mfma_f32_16x16x32_bf16 v[52:55], a[164:167], a[36:39], v[52:55]
ds_read_b64_tr_b16 a[200:201], v3 offset:49152
v_mfma_f32_16x16x32_bf16 v[52:55], a[168:171], a[40:43], v[52:55]
buffer_load_dwordx4 v18, s[16:19], s34 offen offset:2048 nt lds
v_mfma_f32_16x16x32_bf16 v[52:55], a[172:175], a[44:47], v[52:55]
ds_read_b64_tr_b16 a[202:203], v3 offset:57344
v_mfma_f32_16x16x32_bf16 v[52:55], a[176:179], a[48:51], v[52:55]
ds_read_b64_tr_b16 a[204:205], v4 offset:49152
v_mfma_f32_16x16x32_bf16 v[52:55], a[180:183], a[52:55], v[52:55]
s_waitcnt lgkmcnt(11)
v_or_b32 v15, v24, v26
v_cmp_gt_i32 vcc, 0, v15
v_mfma_f32_16x16x32_bf16 v[52:55], a[184:187], a[56:59], v[52:55]
ds_read_b64_tr_b16 a[206:207], v4 offset:57344
v_mfma_f32_16x16x32_bf16 v[52:55], a[188:191], a[60:63], v[52:55]
s_cbranch_vccnz L_R_p0
L_Rr_p0:
v_mfma_f32_16x16x32_bf16 v[56:59], a[160:163], a[64:67], v[76:79]
buffer_load_dwordx4 v19, s[16:19], s34 offen offset:3072 nt lds
v_mfma_f32_16x16x32_bf16 v[56:59], a[164:167], a[68:71], v[56:59]
ds_read_b64_tr_b16 a[208:209], v5 offset:49152
v_mfma_f32_16x16x32_bf16 v[56:59], a[168:171], a[72:75], v[56:59]
ds_read_b64_tr_b16 a[210:211], v5 offset:57344
v_mfma_f32_16x16x32_bf16 v[56:59], a[172:175], a[76:79], v[56:59]
s_add_u32 s34, s34, 16384
s_and_b32 s34, s34, 524287
s_add_u32 m0, s33, 98304
v_mfma_f32_16x16x32_bf16 v[56:59], a[176:179], a[80:83], v[56:59]
buffer_load_dwordx4 v20, s[20:23], s35 offen offset:0 nt lds
v_mfma_f32_16x16x32_bf16 v[56:59], a[180:183], a[84:87], v[56:59]
ds_read_b64_tr_b16 a[212:213], v6 offset:49152
v_mfma_f32_16x16x32_bf16 v[56:59], a[184:187], a[88:91], v[56:59]
ds_read_b64_tr_b16 a[214:215], v6 offset:57344
v_mfma_f32_16x16x32_bf16 v[56:59], a[188:191], a[92:95], v[56:59]
ds_read_b64_tr_b16 a[216:217], v7 offset:49152
v_mfma_f32_16x16x32_bf16 v[60:63], a[160:163], a[96:99], v[80:83]
buffer_load_dwordx4 v21, s[20:23], s35 offen offset:1024 nt lds
v_mfma_f32_16x16x32_bf16 v[60:63], a[164:167], a[100:103], v[60:63]
ds_read_b64_tr_b16 a[218:219], v7 offset:57344
v_mfma_f32_16x16x32_bf16 v[60:63], a[168:171], a[104:107], v[60:63]
ds_read_b64_tr_b16 a[220:221], v8 offset:49152
v_mfma_f32_16x16x32_bf16 v[60:63], a[172:175], a[108:111], v[60:63]
ds_read_b64_tr_b16 a[222:223], v8 offset:57344
v_mfma_f32_16x16x32_bf16 v[60:63], a[176:179], a[112:115], v[60:63]
v_exp_f32 v40, v48
v_mfma_f32_16x16x32_bf16 v[60:63], a[180:183], a[116:119], v[60:63]
buffer_load_dwordx4 v22, s[20:23], s35 offen offset:2048 nt lds
v_mfma_f32_16x16x32_bf16 v[60:63], a[184:187], a[120:123], v[60:63]
v_exp_f32 v41, v49
v_mfma_f32_16x16x32_bf16 v[60:63], a[188:191], a[124:127], v[60:63]
v_exp_f32 v42, v50
v_mfma_f32_16x16x32_bf16 v[64:67], a[160:163], a[128:131], v[84:87]
v_exp_f32 v43, v51
v_mfma_f32_16x16x32_bf16 v[64:67], a[164:167], a[132:135], v[64:67]
ds_read_b128 a[160:163], v9 offset:32768
v_cvt_pk_bf16_f32 v28, v40, v41
v_mfma_f32_16x16x32_bf16 v[64:67], a[168:171], a[136:139], v[64:67]
buffer_load_dwordx4 v23, s[20:23], s35 offen offset:3072 nt lds
v_mfma_f32_16x16x32_bf16 v[64:67], a[172:175], a[140:143], v[64:67]
ds_read_b128 a[164:167], v10 offset:32768
v_cvt_pk_bf16_f32 v29, v42, v43
v_mfma_f32_16x16x32_bf16 v[64:67], a[176:179], a[144:147], v[64:67]
ds_read_b128 a[168:171], v11 offset:32768
v_or_b32 v15, v28, v29
v_mfma_f32_16x16x32_bf16 v[64:67], a[180:183], a[148:151], v[64:67]
ds_read_b128 a[172:175], v12 offset:32768
v_mfma_f32_16x16x32_bf16 v[64:67], a[184:187], a[152:155], v[64:67]
ds_read_b128 a[176:179], v9 offset:33024
v_mfma_f32_16x16x32_bf16 v[64:67], a[188:191], a[156:159], v[64:67]
s_waitcnt lgkmcnt(13)
s_add_u32 s35, s35, 16384
s_and_b32 s35, s35, 524287
v_mfma_f32_16x16x32_bf16 v[96:99], a[192:195], v[24:27], v[96:99]
ds_read_b128 a[180:183], v10 offset:33024
v_mfma_f32_16x16x32_bf16 v[100:103], a[192:195], a[224:227], v[100:103]
ds_read_b128 a[184:187], v11 offset:33024
v_mfma_f32_16x16x32_bf16 v[104:107], a[192:195], a[228:231], v[104:107]
ds_read_b128 a[188:191], v12 offset:33024
v_mfma_f32_16x16x32_bf16 v[108:111], a[192:195], a[232:235], v[108:111]
ds_write_b64 v14, v[28:29] offset:10240
v_mfma_f32_16x16x32_bf16 v[112:115], a[192:195], a[236:239], v[112:115]
v_exp_f32 v44, v52
v_mfma_f32_16x16x32_bf16 v[116:119], a[196:199], v[24:27], v[116:119]
v_exp_f32 v45, v53
v_mfma_f32_16x16x32_bf16 v[120:123], a[196:199], a[224:227], v[120:123]
v_exp_f32 v46, v54
v_mfma_f32_16x16x32_bf16 v[124:127], a[196:199], a[228:231], v[124:127]
v_exp_f32 v47, v55
v_mfma_f32_16x16x32_bf16 v[128:131], a[196:199], a[232:235], v[128:131]
v_cvt_pk_bf16_f32 v30, v44, v45
v_cvt_pk_bf16_f32 v31, v46, v47
v_mfma_f32_16x16x32_bf16 v[132:135], a[196:199], a[236:239], v[132:135]
v_or3_b32 v15, v30, v31, v15
v_mfma_f32_16x16x32_bf16 v[136:139], a[200:203], v[24:27], v[136:139]
ds_write_b64 v14, v[30:31] offset:11264
v_mfma_f32_16x16x32_bf16 v[140:143], a[200:203], a[224:227], v[140:143]
v_exp_f32 v40, v56
v_mfma_f32_16x16x32_bf16 v[144:147], a[200:203], a[228:231], v[144:147]
v_exp_f32 v41, v57
v_mfma_f32_16x16x32_bf16 v[148:151], a[200:203], a[232:235], v[148:151]
v_exp_f32 v42, v58
v_mfma_f32_16x16x32_bf16 v[152:155], a[200:203], a[236:239], v[152:155]
v_exp_f32 v43, v59
v_mfma_f32_16x16x32_bf16 v[156:159], a[204:207], v[24:27], v[156:159]
v_cvt_pk_bf16_f32 v32, v40, v41
v_cvt_pk_bf16_f32 v33, v42, v43
v_mfma_f32_16x16x32_bf16 v[160:163], a[204:207], a[224:227], v[160:163]
v_or3_b32 v15, v32, v33, v15
v_mfma_f32_16x16x32_bf16 v[164:167], a[204:207], a[228:231], v[164:167]
ds_write_b64 v14, v[32:33] offset:12288
v_mfma_f32_16x16x32_bf16 v[168:171], a[204:207], a[232:235], v[168:171]
v_exp_f32 v44, v60
v_mfma_f32_16x16x32_bf16 v[172:175], a[204:207], a[236:239], v[172:175]
s_waitcnt lgkmcnt(11)
v_exp_f32 v45, v61
v_mfma_f32_16x16x32_bf16 v[176:179], a[208:211], v[24:27], v[176:179]
v_exp_f32 v46, v62
v_mfma_f32_16x16x32_bf16 v[180:183], a[208:211], a[224:227], v[180:183]
v_exp_f32 v47, v63
v_mfma_f32_16x16x32_bf16 v[184:187], a[208:211], a[228:231], v[184:187]
v_cvt_pk_bf16_f32 v34, v44, v45
v_cvt_pk_bf16_f32 v35, v46, v47
v_mfma_f32_16x16x32_bf16 v[188:191], a[208:211], a[232:235], v[188:191]
v_or3_b32 v15, v34, v35, v15
v_mfma_f32_16x16x32_bf16 v[192:195], a[208:211], a[236:239], v[192:195]
ds_write_b64 v14, v[34:35] offset:13312
v_mfma_f32_16x16x32_bf16 v[196:199], a[212:215], v[24:27], v[196:199]
v_exp_f32 v40, v64
v_mfma_f32_16x16x32_bf16 v[200:203], a[212:215], a[224:227], v[200:203]
v_exp_f32 v41, v65
v_mfma_f32_16x16x32_bf16 v[204:207], a[212:215], a[228:231], v[204:207]
v_exp_f32 v42, v66
v_mfma_f32_16x16x32_bf16 v[208:211], a[212:215], a[232:235], v[208:211]
v_exp_f32 v43, v67
v_mfma_f32_16x16x32_bf16 v[212:215], a[212:215], a[236:239], v[212:215]
v_cvt_pk_bf16_f32 v36, v40, v41
v_cvt_pk_bf16_f32 v37, v42, v43
v_mfma_f32_16x16x32_bf16 v[216:219], a[216:219], v[24:27], v[216:219]
v_or3_b32 v15, v36, v37, v15
v_mfma_f32_16x16x32_bf16 v[220:223], a[216:219], a[224:227], v[220:223]
ds_write_b64 v14, v[36:37] offset:14336
v_mfma_f32_16x16x32_bf16 v[224:227], a[216:219], a[228:231], v[224:227]
v_and_b32 v15, s43, v15
v_cmp_ne_u32 vcc, 0, v15
v_mfma_f32_16x16x32_bf16 v[228:231], a[216:219], a[232:235], v[228:231]
v_mfma_f32_16x16x32_bf16 v[232:235], a[216:219], a[236:239], v[232:235]
v_mfma_f32_16x16x32_bf16 v[236:239], a[220:223], v[24:27], v[236:239]
v_mfma_f32_16x16x32_bf16 v[240:243], a[220:223], a[224:227], v[240:243]
v_mfma_f32_16x16x32_bf16 v[244:247], a[220:223], a[228:231], v[244:247]
v_mfma_f32_16x16x32_bf16 v[248:251], a[220:223], a[232:235], v[248:251]
v_mfma_f32_16x16x32_bf16 v[252:255], a[220:223], a[236:239], v[252:255]
s_cbranch_vccnz L_D_p0
L_Dr_p0:
v_mfma_f32_16x16x32_bf16 a[240:243], a[252:255], v[28:31], a[240:243]
v_mfma_f32_16x16x32_bf16 a[244:247], a[252:255], v[32:35], a[244:247]
v_mfma_f32_16x16x32_bf16 a[248:251], a[252:255], v[36:39], a[248:251]
s_waitcnt vmcnt(16) lgkmcnt(0)
s_cmp_lt_u32 s57, 2
s_cbranch_scc0 L_fcp0
s_waitcnt vmcnt(4)
s_cmp_lt_u32 s57, 1
s_cbranch_scc0 L_fcp0
s_waitcnt vmcnt(3)
L_fcp0:
L_mid:
s_barrier
ds_read_b128 v[24:27], v13 offset:10240
v_mfma_f32_16x16x32_bf16 v[48:51], a[160:163], a[0:3], v[68:71]
s_add_u32 m0, s33, 32768
ds_read_b128 a[224:227], v13 offset:11264
v_mfma_f32_16x16x32_bf16 v[48:51], a[164:167], a[4:7], v[48:51]
ds_read_b128 a[228:231], v13 offset:12288
v_mfma_f32_16x16x32_bf16 v[48:51], a[168:171], a[8:11], v[48:51]
ds_read_b128 a[232:235], v13 offset:13312
ds_read_b128 a[236:239], v13 offset:14336
v_mfma_f32_16x16x32_bf16 v[48:51], a[172:175], a[12:15], v[48:51]
buffer_load_dwordx4 v16, s[16:19], s34 offen offset:0 nt lds
v_mfma_f32_16x16x32_bf16 v[48:51], a[176:179], a[16:19], v[48:51]
ds_read_b64_tr_b16 a[192:193], v1 offset:32768
v_mfma_f32_16x16x32_bf16 v[48:51], a[180:183], a[20:23], v[48:51]
buffer_load_dwordx4 v17, s[16:19], s34 offen offset:1024 nt lds
v_mfma_f32_16x16x32_bf16 v[48:51], a[184:187], a[24:27], v[48:51]
ds_read_b64_tr_b16 a[194:195], v1 offset:40960
v_mfma_f32_16x16x32_bf16 v[48:51], a[188:191], a[28:31], v[48:51]
ds_read_b64_tr_b16 a[196:197], v2 offset:32768
v_mfma_f32_16x16x32_bf16 v[52:55], a[160:163], a[32:35], v[72:75]
ds_read_b64_tr_b16 a[198:199], v2 offset:40960
v_mfma_f32_16x16x32_bf16 v[52:55], a[164:167], a[36:39], v[52:55]
ds_read_b64_tr_b16 a[200:201], v3 offset:32768
v_mfma_f32_16x16x32_bf16 v[52:55], a[168:171], a[40:43], v[52:55]
buffer_load_dwordx4 v18, s[16:19], s34 offen offset:2048 nt lds
v_mfma_f32_16x16x32_bf16 v[52:55], a[172:175], a[44:47], v[52:55]
ds_read_b64_tr_b16 a[202:203], v3 offset:40960
v_mfma_f32_16x16x32_bf16 v[52:55], a[176:179], a[48:51], v[52:55]
ds_read_b64_tr_b16 a[204:205], v4 offset:32768
v_mfma_f32_16x16x32_bf16 v[52:55], a[180:183], a[52:55], v[52:55]
s_waitcnt lgkmcnt(11)
v_or_b32 v15, v24, v26
v_cmp_gt_i32 vcc, 0, v15
v_mfma_f32_16x16x32_bf16 v[52:55], a[184:187], a[56:59], v[52:55]
ds_read_b64_tr_b16 a[206:207], v4 offset:40960
v_mfma_f32_16x16x32_bf16 v[52:55], a[188:191], a[60:63], v[52:55]
s_cbranch_vccnz L_R_p1
L_Rr_p1:
v_mfma_f32_16x16x32_bf16 v[56:59], a[160:163], a[64:67], v[76:79]
buffer_load_dwordx4 v19, s[16:19], s34 offen offset:3072 nt lds
v_mfma_f32_16x16x32_bf16 v[56:59], a[164:167], a[68:71], v[56:59]
ds_read_b64_tr_b16 a[208:209], v5 offset:32768
v_mfma_f32_16x16x32_bf16 v[56:59], a[168:171], a[72:75], v[56:59]
ds_read_b64_tr_b16 a[210:211], v5 offset:40960
v_mfma_f32_16x16x32_bf16 v[56:59], a[172:175], a[76:79], v[56:59]
s_add_u32 s34, s34, 16384
s_and_b32 s34, s34, 524287
s_add_u32 m0, s33, 147456
v_mfma_f32_16x16x32_bf16 v[56:59], a[176:179], a[80:83], v[56:59]
buffer_load_dwordx4 v20, s[20:23], s35 offen offset:0 nt lds
v_mfma_f32_16x16x32_bf16 v[56:59], a[180:183], a[84:87], v[56:59]
ds_read_b64_tr_b16 a[212:213], v6 offset:32768
v_mfma_f32_16x16x32_bf16 v[56:59], a[184:187], a[88:91], v[56:59]
ds_read_b64_tr_b16 a[214:215], v6 offset:40960
v_mfma_f32_16x16x32_bf16 v[56:59], a[188:191], a[92:95], v[56:59]
ds_read_b64_tr_b16 a[216:217], v7 offset:32768
v_mfma_f32_16x16x32_bf16 v[60:63], a[160:163], a[96:99], v[80:83]
buffer_load_dwordx4 v21, s[20:23], s35 offen offset:1024 nt lds
v_mfma_f32_16x16x32_bf16 v[60:63], a[164:167], a[100:103], v[60:63]
ds_read_b64_tr_b16 a[218:219], v7 offset:40960
v_mfma_f32_16x16x32_bf16 v[60:63], a[168:171], a[104:107], v[60:63]
ds_read_b64_tr_b16 a[220:221], v8 offset:32768
v_mfma_f32_16x16x32_bf16 v[60:63], a[172:175], a[108:111], v[60:63]
ds_read_b64_tr_b16 a[222:223], v8 offset:40960
v_mfma_f32_16x16x32_bf16 v[60:63], a[176:179], a[112:115], v[60:63]
v_exp_f32 v40, v48
v_mfma_f32_16x16x32_bf16 v[60:63], a[180:183], a[116:119], v[60:63]
buffer_load_dwordx4 v22, s[20:23], s35 offen offset:2048 nt lds
v_mfma_f32_16x16x32_bf16 v[60:63], a[184:187], a[120:123], v[60:63]
v_exp_f32 v41, v49
v_mfma_f32_16x16x32_bf16 v[60:63], a[188:191], a[124:127], v[60:63]
v_exp_f32 v42, v50
v_mfma_f32_16x16x32_bf16 v[64:67], a[160:163], a[128:131], v[84:87]
v_exp_f32 v43, v51
v_mfma_f32_16x16x32_bf16 v[64:67], a[164:167], a[132:135], v[64:67]
ds_read_b128 a[160:163], v9 offset:49152
v_cvt_pk_bf16_f32 v28, v40, v41
v_mfma_f32_16x16x32_bf16 v[64:67], a[168:171], a[136:139], v[64:67]
buffer_load_dwordx4 v23, s[20:23], s35 offen offset:3072 nt lds
v_mfma_f32_16x16x32_bf16 v[64:67], a[172:175], a[140:143], v[64:67]
ds_read_b128 a[164:167], v10 offset:49152
v_cvt_pk_bf16_f32 v29, v42, v43
v_mfma_f32_16x16x32_bf16 v[64:67], a[176:179], a[144:147], v[64:67]
ds_read_b128 a[168:171], v11 offset:49152
v_or_b32 v15, v28, v29
v_mfma_f32_16x16x32_bf16 v[64:67], a[180:183], a[148:151], v[64:67]
ds_read_b128 a[172:175], v12 offset:49152
v_mfma_f32_16x16x32_bf16 v[64:67], a[184:187], a[152:155], v[64:67]
ds_read_b128 a[176:179], v9 offset:49408
v_mfma_f32_16x16x32_bf16 v[64:67], a[188:191], a[156:159], v[64:67]
s_waitcnt lgkmcnt(13)
s_add_u32 s35, s35, 16384
s_and_b32 s35, s35, 524287
v_mfma_f32_16x16x32_bf16 v[96:99], a[192:195], v[24:27], v[96:99]
ds_read_b128 a[180:183], v10 offset:49408
v_mfma_f32_16x16x32_bf16 v[100:103], a[192:195], a[224:227], v[100:103]
ds_read_b128 a[184:187], v11 offset:49408
v_mfma_f32_16x16x32_bf16 v[104:107], a[192:195], a[228:231], v[104:107]
ds_read_b128 a[188:191], v12 offset:49408
v_mfma_f32_16x16x32_bf16 v[108:111], a[192:195], a[232:235], v[108:111]
ds_write_b64 v14, v[28:29] offset:0
v_mfma_f32_16x16x32_bf16 v[112:115], a[192:195], a[236:239], v[112:115]
v_exp_f32 v44, v52
v_mfma_f32_16x16x32_bf16 v[116:119], a[196:199], v[24:27], v[116:119]
v_exp_f32 v45, v53
v_mfma_f32_16x16x32_bf16 v[120:123], a[196:199], a[224:227], v[120:123]
v_exp_f32 v46, v54
v_mfma_f32_16x16x32_bf16 v[124:127], a[196:199], a[228:231], v[124:127]
v_exp_f32 v47, v55
v_mfma_f32_16x16x32_bf16 v[128:131], a[196:199], a[232:235], v[128:131]
v_cvt_pk_bf16_f32 v30, v44, v45
v_cvt_pk_bf16_f32 v31, v46, v47
v_mfma_f32_16x16x32_bf16 v[132:135], a[196:199], a[236:239], v[132:135]
v_or3_b32 v15, v30, v31, v15
v_mfma_f32_16x16x32_bf16 v[136:139], a[200:203], v[24:27], v[136:139]
ds_write_b64 v14, v[30:31] offset:1024
v_mfma_f32_16x16x32_bf16 v[140:143], a[200:203], a[224:227], v[140:143]
v_exp_f32 v40, v56
v_mfma_f32_16x16x32_bf16 v[144:147], a[200:203], a[228:231], v[144:147]
v_exp_f32 v41, v57
v_mfma_f32_16x16x32_bf16 v[148:151], a[200:203], a[232:235], v[148:151]
v_exp_f32 v42, v58
v_mfma_f32_16x16x32_bf16 v[152:155], a[200:203], a[236:239], v[152:155]
v_exp_f32 v43, v59
v_mfma_f32_16x16x32_bf16 v[156:159], a[204:207], v[24:27], v[156:159]
v_cvt_pk_bf16_f32 v32, v40, v41
v_cvt_pk_bf16_f32 v33, v42, v43
v_mfma_f32_16x16x32_bf16 v[160:163], a[204:207], a[224:227], v[160:163]
v_or3_b32 v15, v32, v33, v15
v_mfma_f32_16x16x32_bf16 v[164:167], a[204:207], a[228:231], v[164:167]
ds_write_b64 v14, v[32:33] offset:2048
v_mfma_f32_16x16x32_bf16 v[168:171], a[204:207], a[232:235], v[168:171]
v_exp_f32 v44, v60
v_mfma_f32_16x16x32_bf16 v[172:175], a[204:207], a[236:239], v[172:175]
s_waitcnt lgkmcnt(11)
v_exp_f32 v45, v61
v_mfma_f32_16x16x32_bf16 v[176:179], a[208:211], v[24:27], v[176:179]
v_exp_f32 v46, v62
v_mfma_f32_16x16x32_bf16 v[180:183], a[208:211], a[224:227], v[180:183]
v_exp_f32 v47, v63
v_mfma_f32_16x16x32_bf16 v[184:187], a[208:211], a[228:231], v[184:187]
v_cvt_pk_bf16_f32 v34, v44, v45
v_cvt_pk_bf16_f32 v35, v46, v47
v_mfma_f32_16x16x32_bf16 v[188:191], a[208:211], a[232:235], v[188:191]
v_or3_b32 v15, v34, v35, v15
v_mfma_f32_16x16x32_bf16 v[192:195], a[208:211], a[236:239], v[192:195]
ds_write_b64 v14, v[34:35] offset:3072
v_mfma_f32_16x16x32_bf16 v[196:199], a[212:215], v[24:27], v[196:199]
v_exp_f32 v40, v64
v_mfma_f32_16x16x32_bf16 v[200:203], a[212:215], a[224:227], v[200:203]
v_exp_f32 v41, v65
v_mfma_f32_16x16x32_bf16 v[204:207], a[212:215], a[228:231], v[204:207]
v_exp_f32 v42, v66
v_mfma_f32_16x16x32_bf16 v[208:211], a[212:215], a[232:235], v[208:211]
v_exp_f32 v43, v67
v_mfma_f32_16x16x32_bf16 v[212:215], a[212:215], a[236:239], v[212:215]
v_cvt_pk_bf16_f32 v36, v40, v41
v_cvt_pk_bf16_f32 v37, v42, v43
v_mfma_f32_16x16x32_bf16 v[216:219], a[216:219], v[24:27], v[216:219]
v_or3_b32 v15, v36, v37, v15
v_mfma_f32_16x16x32_bf16 v[220:223], a[216:219], a[224:227], v[220:223]
ds_write_b64 v14, v[36:37] offset:4096
v_mfma_f32_16x16x32_bf16 v[224:227], a[216:219], a[228:231], v[224:227]
v_and_b32 v15, s43, v15
v_cmp_ne_u32 vcc, 0, v15
v_mfma_f32_16x16x32_bf16 v[228:231], a[216:219], a[232:235], v[228:231]
v_mfma_f32_16x16x32_bf16 v[232:235], a[216:219], a[236:239], v[232:235]
v_mfma_f32_16x16x32_bf16 v[236:239], a[220:223], v[24:27], v[236:239]
v_mfma_f32_16x16x32_bf16 v[240:243], a[220:223], a[224:227], v[240:243]
v_mfma_f32_16x16x32_bf16 v[244:247], a[220:223], a[228:231], v[244:247]
v_mfma_f32_16x16x32_bf16 v[248:251], a[220:223], a[232:235], v[248:251]
v_mfma_f32_16x16x32_bf16 v[252:255], a[220:223], a[236:239], v[252:255]
s_cbranch_vccnz L_D_p1
L_Dr_p1:
v_mfma_f32_16x16x32_bf16 a[240:243], a[252:255], v[28:31], a[240:243]
v_mfma_f32_16x16x32_bf16 a[244:247], a[252:255], v[32:35], a[244:247]
v_mfma_f32_16x16x32_bf16 a[248:251], a[252:255], v[36:39], a[248:251]
s_waitcnt vmcnt(16) lgkmcnt(0)
s_cmp_lt_u32 s57, 2
s_cbranch_scc0 L_fcp1
s_waitcnt vmcnt(4)
s_cmp_lt_u32 s57, 1
s_cbranch_scc0 L_fcp1
s_waitcnt vmcnt(3)
L_fcp1:
s_barrier
ds_read_b128 v[24:27], v13 offset:0
v_mfma_f32_16x16x32_bf16 v[48:51], a[160:163], a[0:3], v[68:71]
s_add_u32 m0, s33, 49152
ds_read_b128 a[224:227], v13 offset:1024
v_mfma_f32_16x16x32_bf16 v[48:51], a[164:167], a[4:7], v[48:51]
ds_read_b128 a[228:231], v13 offset:2048
v_mfma_f32_16x16x32_bf16 v[48:51], a[168:171], a[8:11], v[48:51]
ds_read_b128 a[232:235], v13 offset:3072
ds_read_b128 a[236:239], v13 offset:4096
v_mfma_f32_16x16x32_bf16 v[48:51], a[172:175], a[12:15], v[48:51]
buffer_load_dwordx4 v16, s[16:19], s34 offen offset:0 nt lds
v_mfma_f32_16x16x32_bf16 v[48:51], a[176:179], a[16:19], v[48:51]
ds_read_b64_tr_b16 a[192:193], v1 offset:16384
v_mfma_f32_16x16x32_bf16 v[48:51], a[180:183], a[20:23], v[48:51]
buffer_load_dwordx4 v17, s[16:19], s34 offen offset:1024 nt lds
v_mfma_f32_16x16x32_bf16 v[48:51], a[184:187], a[24:27], v[48:51]
ds_read_b64_tr_b16 a[194:195], v1 offset:24576
v_mfma_f32_16x16x32_bf16 v[48:51], a[188:191], a[28:31], v[48:51]
ds_read_b64_tr_b16 a[196:197], v2 offset:16384
v_mfma_f32_16x16x32_bf16 v[52:55], a[160:163], a[32:35], v[72:75]
ds_read_b64_tr_b16 a[198:199], v2 offset:24576
v_mfma_f32_16x16x32_bf16 v[52:55], a[164:167], a[36:39], v[52:55]
ds_read_b64_tr_b16 a[200:201], v3 offset:16384
v_mfma_f32_16x16x32_bf16 v[52:55], a[168:171], a[40:43], v[52:55]
buffer_load_dwordx4 v18, s[16:19], s34 offen offset:2048 nt lds
v_mfma_f32_16x16x32_bf16 v[52:55], a[172:175], a[44:47], v[52:55]
ds_read_b64_tr_b16 a[202:203], v3 offset:24576
v_mfma_f32_16x16x32_bf16 v[52:55], a[176:179], a[48:51], v[52:55]
ds_read_b64_tr_b16 a[204:205], v4 offset:16384
v_mfma_f32_16x16x32_bf16 v[52:55], a[180:183], a[52:55], v[52:55]
s_waitcnt lgkmcnt(11)
v_or_b32 v15, v24, v26
v_cmp_gt_i32 vcc, 0, v15
v_mfma_f32_16x16x32_bf16 v[52:55], a[184:187], a[56:59], v[52:55]
ds_read_b64_tr_b16 a[206:207], v4 offset:24576
v_mfma_f32_16x16x32_bf16 v[52:55], a[188:191], a[60:63], v[52:55]
s_cbranch_vccnz L_R_p2
L_Rr_p2:
v_mfma_f32_16x16x32_bf16 v[56:59], a[160:163], a[64:67], v[76:79]
buffer_load_dwordx4 v19, s[16:19], s34 offen offset:3072 nt lds
v_mfma_f32_16x16x32_bf16 v[56:59], a[164:167], a[68:71], v[56:59]
ds_read_b64_tr_b16 a[208:209], v5 offset:16384
v_mfma_f32_16x16x32_bf16 v[56:59], a[168:171], a[72:75], v[56:59]
ds_read_b64_tr_b16 a[210:211], v5 offset:24576
v_mfma_f32_16x16x32_bf16 v[56:59], a[172:175], a[76:79], v[56:59]
s_add_u32 s34, s34, 16384
s_and_b32 s34, s34, 524287
s_add_u32 m0, s33, 131072
v_mfma_f32_16x16x32_bf16 v[56:59], a[176:179], a[80:83], v[56:59]
buffer_load_dwordx4 v20, s[20:23], s35 offen offset:0 nt lds
v_mfma_f32_16x16x32_bf16 v[56:59], a[180:183], a[84:87], v[56:59]
ds_read_b64_tr_b16 a[212:213], v6 offset:16384
v_mfma_f32_16x16x32_bf16 v[56:59], a[184:187], a[88:91], v[56:59]
ds_read_b64_tr_b16 a[214:215], v6 offset:24576
v_mfma_f32_16x16x32_bf16 v[56:59], a[188:191], a[92:95], v[56:59]
ds_read_b64_tr_b16 a[216:217], v7 offset:16384
v_mfma_f32_16x16x32_bf16 v[60:63], a[160:163], a[96:99], v[80:83]
buffer_load_dwordx4 v21, s[20:23], s35 offen offset:1024 nt lds
v_mfma_f32_16x16x32_bf16 v[60:63], a[164:167], a[100:103], v[60:63]
ds_read_b64_tr_b16 a[218:219], v7 offset:24576
v_mfma_f32_16x16x32_bf16 v[60:63], a[168:171], a[104:107], v[60:63]
ds_read_b64_tr_b16 a[220:221], v8 offset:16384
v_mfma_f32_16x16x32_bf16 v[60:63], a[172:175], a[108:111], v[60:63]
ds_read_b64_tr_b16 a[222:223], v8 offset:24576
v_mfma_f32_16x16x32_bf16 v[60:63], a[176:179], a[112:115], v[60:63]
v_exp_f32 v40, v48
v_mfma_f32_16x16x32_bf16 v[60:63], a[180:183], a[116:119], v[60:63]
buffer_load_dwordx4 v22, s[20:23], s35 offen offset:2048 nt lds
v_mfma_f32_16x16x32_bf16 v[60:63], a[184:187], a[120:123], v[60:63]
v_exp_f32 v41, v49
v_mfma_f32_16x16x32_bf16 v[60:63], a[188:191], a[124:127], v[60:63]
v_exp_f32 v42, v50
v_mfma_f32_16x16x32_bf16 v[64:67], a[160:163], a[128:131], v[84:87]
v_exp_f32 v43, v51
v_mfma_f32_16x16x32_bf16 v[64:67], a[164:167], a[132:135], v[64:67]
ds_read_b128 a[160:163], v9 offset:0
v_cvt_pk_bf16_f32 v28, v40, v41
v_mfma_f32_16x16x32_bf16 v[64:67], a[168:171], a[136:139], v[64:67]
buffer_load_dwordx4 v23, s[20:23], s35 offen offset:3072 nt lds
v_mfma_f32_16x16x32_bf16 v[64:67], a[172:175], a[140:143], v[64:67]
ds_read_b128 a[164:167], v10 offset:0
v_cvt_pk_bf16_f32 v29, v42, v43
v_mfma_f32_16x16x32_bf16 v[64:67], a[176:179], a[144:147], v[64:67]
ds_read_b128 a[168:171], v11 offset:0
v_or_b32 v15, v28, v29
v_mfma_f32_16x16x32_bf16 v[64:67], a[180:183], a[148:151], v[64:67]
ds_read_b128 a[172:175], v12 offset:0
v_mfma_f32_16x16x32_bf16 v[64:67], a[184:187], a[152:155], v[64:67]
ds_read_b128 a[176:179], v9 offset:256
v_mfma_f32_16x16x32_bf16 v[64:67], a[188:191], a[156:159], v[64:67]
s_waitcnt lgkmcnt(13)
s_add_u32 s35, s35, 16384
s_and_b32 s35, s35, 524287
v_mfma_f32_16x16x32_bf16 v[96:99], a[192:195], v[24:27], v[96:99]
ds_read_b128 a[180:183], v10 offset:256
v_mfma_f32_16x16x32_bf16 v[100:103], a[192:195], a[224:227], v[100:103]
ds_read_b128 a[184:187], v11 offset:256
v_mfma_f32_16x16x32_bf16 v[104:107], a[192:195], a[228:231], v[104:107]
ds_read_b128 a[188:191], v12 offset:256
v_mfma_f32_16x16x32_bf16 v[108:111], a[192:195], a[232:235], v[108:111]
ds_write_b64 v14, v[28:29] offset:10240
v_mfma_f32_16x16x32_bf16 v[112:115], a[192:195], a[236:239], v[112:115]
v_exp_f32 v44, v52
v_mfma_f32_16x16x32_bf16 v[116:119], a[196:199], v[24:27], v[116:119]
v_exp_f32 v45, v53
v_mfma_f32_16x16x32_bf16 v[120:123], a[196:199], a[224:227], v[120:123]
v_exp_f32 v46, v54
v_mfma_f32_16x16x32_bf16 v[124:127], a[196:199], a[228:231], v[124:127]
v_exp_f32 v47, v55
v_mfma_f32_16x16x32_bf16 v[128:131], a[196:199], a[232:235], v[128:131]
v_cvt_pk_bf16_f32 v30, v44, v45
v_cvt_pk_bf16_f32 v31, v46, v47
v_mfma_f32_16x16x32_bf16 v[132:135], a[196:199], a[236:239], v[132:135]
v_or3_b32 v15, v30, v31, v15
v_mfma_f32_16x16x32_bf16 v[136:139], a[200:203], v[24:27], v[136:139]
ds_write_b64 v14, v[30:31] offset:11264
v_mfma_f32_16x16x32_bf16 v[140:143], a[200:203], a[224:227], v[140:143]
v_exp_f32 v40, v56
v_mfma_f32_16x16x32_bf16 v[144:147], a[200:203], a[228:231], v[144:147]
v_exp_f32 v41, v57
v_mfma_f32_16x16x32_bf16 v[148:151], a[200:203], a[232:235], v[148:151]
v_exp_f32 v42, v58
v_mfma_f32_16x16x32_bf16 v[152:155], a[200:203], a[236:239], v[152:155]
v_exp_f32 v43, v59
v_mfma_f32_16x16x32_bf16 v[156:159], a[204:207], v[24:27], v[156:159]
v_cvt_pk_bf16_f32 v32, v40, v41
v_cvt_pk_bf16_f32 v33, v42, v43
v_mfma_f32_16x16x32_bf16 v[160:163], a[204:207], a[224:227], v[160:163]
v_or3_b32 v15, v32, v33, v15
v_mfma_f32_16x16x32_bf16 v[164:167], a[204:207], a[228:231], v[164:167]
ds_write_b64 v14, v[32:33] offset:12288
v_mfma_f32_16x16x32_bf16 v[168:171], a[204:207], a[232:235], v[168:171]
v_exp_f32 v44, v60
v_mfma_f32_16x16x32_bf16 v[172:175], a[204:207], a[236:239], v[172:175]
s_waitcnt lgkmcnt(11)
v_exp_f32 v45, v61
v_mfma_f32_16x16x32_bf16 v[176:179], a[208:211], v[24:27], v[176:179]
v_exp_f32 v46, v62
v_mfma_f32_16x16x32_bf16 v[180:183], a[208:211], a[224:227], v[180:183]
v_exp_f32 v47, v63
v_mfma_f32_16x16x32_bf16 v[184:187], a[208:211], a[228:231], v[184:187]
v_cvt_pk_bf16_f32 v34, v44, v45
v_cvt_pk_bf16_f32 v35, v46, v47
v_mfma_f32_16x16x32_bf16 v[188:191], a[208:211], a[232:235], v[188:191]
v_or3_b32 v15, v34, v35, v15
v_mfma_f32_16x16x32_bf16 v[192:195], a[208:211], a[236:239], v[192:195]
ds_write_b64 v14, v[34:35] offset:13312
v_mfma_f32_16x16x32_bf16 v[196:199], a[212:215], v[24:27], v[196:199]
v_exp_f32 v40, v64
v_mfma_f32_16x16x32_bf16 v[200:203], a[212:215], a[224:227], v[200:203]
v_exp_f32 v41, v65
v_mfma_f32_16x16x32_bf16 v[204:207], a[212:215], a[228:231], v[204:207]
v_exp_f32 v42, v66
v_mfma_f32_16x16x32_bf16 v[208:211], a[212:215], a[232:235], v[208:211]
v_exp_f32 v43, v67
v_mfma_f32_16x16x32_bf16 v[212:215], a[212:215], a[236:239], v[212:215]
v_cvt_pk_bf16_f32 v36, v40, v41
v_cvt_pk_bf16_f32 v37, v42, v43
v_mfma_f32_16x16x32_bf16 v[216:219], a[216:219], v[24:27], v[216:219]
v_or3_b32 v15, v36, v37, v15
v_mfma_f32_16x16x32_bf16 v[220:223], a[216:219], a[224:227], v[220:223]
ds_write_b64 v14, v[36:37] offset:14336
v_mfma_f32_16x16x32_bf16 v[224:227], a[216:219], a[228:231], v[224:227]
v_and_b32 v15, s43, v15
v_cmp_ne_u32 vcc, 0, v15
v_mfma_f32_16x16x32_bf16 v[228:231], a[216:219], a[232:235], v[228:231]
v_mfma_f32_16x16x32_bf16 v[232:235], a[216:219], a[236:239], v[232:235]
v_mfma_f32_16x16x32_bf16 v[236:239], a[220:223], v[24:27], v[236:239]
v_mfma_f32_16x16x32_bf16 v[240:243], a[220:223], a[224:227], v[240:243]
v_mfma_f32_16x16x32_bf16 v[244:247], a[220:223], a[228:231], v[244:247]
v_mfma_f32_16x16x32_bf16 v[248:251], a[220:223], a[232:235], v[248:251]
v_mfma_f32_16x16x32_bf16 v[252:255], a[220:223], a[236:239], v[252:255]
s_cbranch_vccnz L_D_p2
L_Dr_p2:
v_mfma_f32_16x16x32_bf16 a[240:243], a[252:255], v[28:31], a[240:243]
v_mfma_f32_16x16x32_bf16 a[244:247], a[252:255], v[32:35], a[244:247]
v_mfma_f32_16x16x32_bf16 a[248:251], a[252:255], v[36:39], a[248:251]
s_waitcnt vmcnt(16) lgkmcnt(0)
s_cmp_lt_u32 s57, 2
s_cbranch_scc0 L_fcp2
s_waitcnt vmcnt(4)
s_cmp_lt_u32 s57, 1
s_cbranch_scc0 L_fcp2
s_waitcnt vmcnt(3)
L_fcp2:
s_add_u32 s36, s36, 1
s_cmp_ge_u32 s36, 6
s_cselect_b32 s57, 31, s57
s_cmp_lt_u32 s36, 7
s_cbranch_scc1 L_loop
s_barrier
ds_read_b128 v[24:27], v13 offset:10240
v_mfma_f32_16x16x32_bf16 v[48:51], a[160:163], a[0:3], v[68:71]
ds_read_b128 a[224:227], v13 offset:11264
v_mfma_f32_16x16x32_bf16 v[48:51], a[164:167], a[4:7], v[48:51]
s_and_b32 s37, s2, 3
ds_read_b128 a[228:231], v13 offset:12288
v_mfma_f32_16x16x32_bf16 v[48:51], a[168:171], a[8:11], v[48:51]
ds_read_b128 a[232:235], v13 offset:13312
ds_read_b128 a[236:239], v13 offset:14336
v_mfma_f32_16x16x32_bf16 v[48:51], a[172:175], a[12:15], v[48:51]
s_lshl_b32 s37, s37, 2
ds_read_b64_tr_b16 a[192:193], v1 offset:0
v_mfma_f32_16x16x32_bf16 v[48:51], a[176:179], a[16:19], v[48:51]
ds_read_b64_tr_b16 a[194:195], v1 offset:8192
v_mfma_f32_16x16x32_bf16 v[48:51], a[180:183], a[20:23], v[48:51]
s_bfe_u32 s40, s2, 131075
ds_read_b64_tr_b16 a[196:197], v2 offset:0
v_mfma_f32_16x16x32_bf16 v[48:51], a[184:187], a[24:27], v[48:51]
ds_read_b64_tr_b16 a[198:199], v2 offset:8192
v_mfma_f32_16x16x32_bf16 v[48:51], a[188:191], a[28:31], v[48:51]
ds_read_b64_tr_b16 a[200:201], v3 offset:0
v_mfma_f32_16x16x32_bf16 v[52:55], a[160:163], a[32:35], v[72:75]
s_add_u32 s37, s37, s40
ds_read_b64_tr_b16 a[202:203], v3 offset:8192
v_mfma_f32_16x16x32_bf16 v[52:55], a[164:167], a[36:39], v[52:55]
s_add_u32 m0, s33, 114688
s_nop 0
buffer_load_dwordx4 v20, s[20:23], s35 offen offset:0 nt lds
v_mfma_f32_16x16x32_bf16 v[52:55], a[168:171], a[40:43], v[52:55]
s_and_b32 s40, s2, 4
ds_read_b64_tr_b16 a[204:205], v4 offset:0
v_mfma_f32_16x16x32_bf16 v[52:55], a[172:175], a[44:47], v[52:55]
ds_read_b64_tr_b16 a[206:207], v4 offset:8192
v_mfma_f32_16x16x32_bf16 v[52:55], a[176:179], a[48:51], v[52:55]
ds_read_b64_tr_b16 a[208:209], v5 offset:0
v_mfma_f32_16x16x32_bf16 v[52:55], a[180:183], a[52:55], v[52:55]
s_waitcnt lgkmcnt(13)
v_or_b32 v15, v24, v26
v_cmp_gt_i32 vcc, 0, v15
v_mfma_f32_16x16x32_bf16 v[52:55], a[184:187], a[56:59], v[52:55]
s_lshl_b32 s40, s40, 1
ds_read_b64_tr_b16 a[210:211], v5 offset:8192
v_mfma_f32_16x16x32_bf16 v[52:55], a[188:191], a[60:63], v[52:55]
s_cbranch_vccnz L_R_t27
L_Rr_t27:
v_mfma_f32_16x16x32_bf16 v[56:59], a[160:163], a[64:67], v[76:79]
buffer_load_dwordx4 v21, s[20:23], s35 offen offset:1024 nt lds
v_mfma_f32_16x16x32_bf16 v[56:59], a[164:167], a[68:71], v[56:59]
s_lshr_b32 s41, s2, 5
s_add_u32 s40, s40, s41
ds_read_b64_tr_b16 a[212:213], v6 offset:0
v_mfma_f32_16x16x32_bf16 v[56:59], a[168:171], a[72:75], v[56:59]
ds_read_b64_tr_b16 a[214:215], v6 offset:8192
v_mfma_f32_16x16x32_bf16 v[56:59], a[172:175], a[76:79], v[56:59]
s_mov_b64 s[56:57], s[72:73]
ds_read_b64_tr_b16 a[216:217], v7 offset:0
v_mfma_f32_16x16x32_bf16 v[56:59], a[176:179], a[80:83], v[56:59]
ds_read_b64_tr_b16 a[218:219], v7 offset:8192
v_mfma_f32_16x16x32_bf16 v[56:59], a[180:183], a[84:87], v[56:59]
ds_read_b64_tr_b16 a[220:221], v8 offset:0
v_mfma_f32_16x16x32_bf16 v[56:59], a[184:187], a[88:91], v[56:59]
s_mov_b32 s58, 1146880
ds_read_b64_tr_b16 a[222:223], v8 offset:8192
v_mfma_f32_16x16x32_bf16 v[56:59], a[188:191], a[92:95], v[56:59]
v_exp_f32 v40, v48
v_mfma_f32_16x16x32_bf16 v[60:63], a[160:163], a[96:99], v[80:83]
buffer_load_dwordx4 v22, s[20:23], s35 offen offset:2048 nt lds
v_mfma_f32_16x16x32_bf16 v[60:63], a[164:167], a[100:103], v[60:63]
s_mov_b32 s59, 0x20000
v_exp_f32 v41, v49
v_mfma_f32_16x16x32_bf16 v[60:63], a[168:171], a[104:107], v[60:63]
v_exp_f32 v42, v50
v_mfma_f32_16x16x32_bf16 v[60:63], a[172:175], a[108:111], v[60:63]
s_and_b32 s3, s40, 7
v_exp_f32 v43, v51
v_mfma_f32_16x16x32_bf16 v[60:63], a[176:179], a[112:115], v[60:63]
v_cvt_pk_bf16_f32 v28, v40, v41
v_cvt_pk_bf16_f32 v29, v42, v43
v_mfma_f32_16x16x32_bf16 v[60:63], a[180:183], a[116:119], v[60:63]
s_lshl_b32 s3, s3, 1
v_or_b32 v15, v28, v29
v_mfma_f32_16x16x32_bf16 v[60:63], a[184:187], a[120:123], v[60:63]
ds_write_b64 v14, v[28:29] offset:0
v_mfma_f32_16x16x32_bf16 v[60:63], a[188:191], a[124:127], v[60:63]
v_exp_f32 v44, v52
v_mfma_f32_16x16x32_bf16 v[64:67], a[160:163], a[128:131], v[84:87]
buffer_load_dwordx4 v23, s[20:23], s35 offen offset:3072 nt lds
v_mfma_f32_16x16x32_bf16 v[64:67], a[164:167], a[132:135], v[64:67]
s_lshr_b32 s41, s32, 1
ds_read_b128 a[160:163], v9 offset:16384
v_mfma_f32_16x16x32_bf16 v[64:67], a[168:171], a[136:139], v[64:67]
s_add_u32 s3, s3, s41
ds_read_b128 a[164:167], v10 offset:16384
v_mfma_f32_16x16x32_bf16 v[64:67], a[172:175], a[140:143], v[64:67]
ds_read_b128 a[168:171], v11 offset:16384
v_mfma_f32_16x16x32_bf16 v[64:67], a[176:179], a[144:147], v[64:67]
s_mul_i32 s3, s3, 143360
ds_read_b128 a[172:175], v12 offset:16384
v_mfma_f32_16x16x32_bf16 v[64:67], a[180:183], a[148:151], v[64:67]
ds_read_b128 a[176:179], v9 offset:16640
v_mfma_f32_16x16x32_bf16 v[64:67], a[184:187], a[152:155], v[64:67]
ds_read_b128 a[180:183], v10 offset:16640
v_mfma_f32_16x16x32_bf16 v[64:67], a[188:191], a[156:159], v[64:67]
s_waitcnt lgkmcnt(15)
s_lshr_b32 s41, s40, 3
ds_read_b128 a[184:187], v11 offset:16640
v_mfma_f32_16x16x32_bf16 v[96:99], a[192:195], v[24:27], v[96:99]
s_add_u32 s35, s35, 16384
s_and_b32 s35, s35, 524287
s_add_u32 m0, s33, 0
v_mfma_f32_16x16x32_bf16 v[100:103], a[192:195], a[224:227], v[100:103]
s_mov_b32 s38, 0
s_mul_i32 s41, s41, 896
ds_read_b128 a[188:191], v12 offset:16640
v_mfma_f32_16x16x32_bf16 v[104:107], a[192:195], a[228:231], v[104:107]
buffer_load_dwordx4 v88, s[24:27], s38 offen offset:0  lds
v_mfma_f32_16x16x32_bf16 v[108:111], a[192:195], a[232:235], v[108:111]
v_exp_f32 v45, v53
v_mfma_f32_16x16x32_bf16 v[112:115], a[192:195], a[236:239], v[112:115]
s_add_u32 s3, s3, s41
v_exp_f32 v46, v54
v_mfma_f32_16x16x32_bf16 v[116:119], a[196:199], v[24:27], v[116:119]
v_exp_f32 v47, v55
v_mfma_f32_16x16x32_bf16 v[120:123], a[196:199], a[224:227], v[120:123]
s_lshl_b32 s41, s47, 6
v_cvt_pk_bf16_f32 v30, v44, v45
v_cvt_pk_bf16_f32 v31, v46, v47
v_mfma_f32_16x16x32_bf16 v[124:127], a[196:199], a[228:231], v[124:127]
v_or3_b32 v15, v30, v31, v15
v_mfma_f32_16x16x32_bf16 v[128:131], a[196:199], a[232:235], v[128:131]
s_mov_b32 s38, 6144
ds_write_b64 v14, v[30:31] offset:1024
v_mfma_f32_16x16x32_bf16 v[132:135], a[196:199], a[236:239], v[132:135]
buffer_load_dwordx4 v88, s[24:27], s38 offen offset:1024  lds
v_mfma_f32_16x16x32_bf16 v[136:139], a[200:203], v[24:27], v[136:139]
s_add_u32 s3, s3, s41
v_exp_f32 v40, v56
v_mfma_f32_16x16x32_bf16 v[140:143], a[200:203], a[224:227], v[140:143]
s_add_u32 s16, s96, s3
s_addc_u32 s17, s97, 0
v_mfma_f32_16x16x32_bf16 v[144:147], a[200:203], a[228:231], v[144:147]
v_exp_f32 v41, v57
v_mfma_f32_16x16x32_bf16 v[148:151], a[200:203], a[232:235], v[148:151]
v_exp_f32 v42, v58
v_mfma_f32_16x16x32_bf16 v[152:155], a[200:203], a[236:239], v[152:155]
s_sub_u32 s18, 2293760, s3
v_exp_f32 v43, v59
v_mfma_f32_16x16x32_bf16 v[156:159], a[204:207], v[24:27], v[156:159]
v_cvt_pk_bf16_f32 v32, v40, v41
v_cvt_pk_bf16_f32 v33, v42, v43
v_mfma_f32_16x16x32_bf16 v[160:163], a[204:207], a[224:227], v[160:163]
s_mov_b32 s38, 12288
s_mov_b32 s19, 0x20000
v_or3_b32 v15, v32, v33, v15
v_mfma_f32_16x16x32_bf16 v[164:167], a[204:207], a[228:231], v[164:167]
buffer_load_dwordx4 v88, s[24:27], s38 offen offset:2048  lds
v_mfma_f32_16x16x32_bf16 v[168:171], a[204:207], a[232:235], v[168:171]
ds_write_b64 v14, v[32:33] offset:2048
v_mfma_f32_16x16x32_bf16 v[172:175], a[204:207], a[236:239], v[172:175]
s_waitcnt lgkmcnt(11)
s_mov_b32 s34, s37
v_mfma_f32_16x16x32_bf16 v[176:179], a[208:211], v[24:27], v[176:179]
v_exp_f32 v44, v60
v_mfma_f32_16x16x32_bf16 v[180:183], a[208:211], a[224:227], v[180:183]
s_lshl_b32 s70, s37, 3
v_exp_f32 v45, v61
v_mfma_f32_16x16x32_bf16 v[184:187], a[208:211], a[228:231], v[184:187]
v_exp_f32 v46, v62
v_mfma_f32_16x16x32_bf16 v[188:191], a[208:211], a[232:235], v[188:191]
v_exp_f32 v47, v63
v_mfma_f32_16x16x32_bf16 v[192:195], a[208:211], a[236:239], v[192:195]
s_mov_b32 s38, 18432
v_cvt_pk_bf16_f32 v34, v44, v45
v_cvt_pk_bf16_f32 v35, v46, v47
v_mfma_f32_16x16x32_bf16 v[196:199], a[212:215], v[24:27], v[196:199]
buffer_load_dwordx4 v88, s[24:27], s38 offen offset:3072  lds
v_mfma_f32_16x16x32_bf16 v[200:203], a[212:215], a[224:227], v[200:203]
v_or3_b32 v15, v34, v35, v15
v_mfma_f32_16x16x32_bf16 v[204:207], a[212:215], a[228:231], v[204:207]
ds_write_b64 v14, v[34:35] offset:3072
v_mfma_f32_16x16x32_bf16 v[208:211], a[212:215], a[232:235], v[208:211]
v_exp_f32 v40, v64
v_mfma_f32_16x16x32_bf16 v[212:215], a[212:215], a[236:239], v[212:215]
v_exp_f32 v41, v65
v_mfma_f32_16x16x32_bf16 v[216:219], a[216:219], v[24:27], v[216:219]
v_exp_f32 v42, v66
v_mfma_f32_16x16x32_bf16 v[220:223], a[216:219], a[224:227], v[220:223]
v_exp_f32 v43, v67
v_mfma_f32_16x16x32_bf16 v[224:227], a[216:219], a[228:231], v[224:227]
v_cvt_pk_bf16_f32 v36, v40, v41
v_cvt_pk_bf16_f32 v37, v42, v43
v_mfma_f32_16x16x32_bf16 v[228:231], a[216:219], a[232:235], v[228:231]
v_or3_b32 v15, v36, v37, v15
v_mfma_f32_16x16x32_bf16 v[232:235], a[216:219], a[236:239], v[232:235]
ds_write_b64 v14, v[36:37] offset:4096
v_mfma_f32_16x16x32_bf16 v[236:239], a[220:223], v[24:27], v[236:239]
v_and_b32 v15, s43, v15
v_cmp_ne_u32 vcc, 0, v15
v_mfma_f32_16x16x32_bf16 v[240:243], a[220:223], a[224:227], v[240:243]
v_mfma_f32_16x16x32_bf16 v[244:247], a[220:223], a[228:231], v[244:247]
v_mfma_f32_16x16x32_bf16 v[248:251], a[220:223], a[232:235], v[248:251]
v_mfma_f32_16x16x32_bf16 v[252:255], a[220:223], a[236:239], v[252:255]
s_cbranch_vccnz L_D_t27
L_Dr_t27:
v_mfma_f32_16x16x32_bf16 a[240:243], a[252:255], v[28:31], a[240:243]
v_mfma_f32_16x16x32_bf16 a[244:247], a[252:255], v[32:35], a[244:247]
v_mfma_f32_16x16x32_bf16 a[248:251], a[252:255], v[36:39], a[248:251]
s_waitcnt vmcnt(16) lgkmcnt(0)
s_barrier
ds_read_b128 v[24:27], v13 offset:0
v_mfma_f32_16x16x32_bf16 v[48:51], a[160:163], a[0:3], v[68:71]
ds_read_b128 a[224:227], v13 offset:1024
v_readfirstlane_b32 s38, v92
v_mfma_f32_16x16x32_bf16 v[48:51], a[164:167], a[4:7], v[48:51]
s_lshl_b64 s[62:63], s[62:63], 7
ds_read_b128 a[228:231], v13 offset:2048
s_and_b32 s38, s38, 0x78
v_mfma_f32_16x16x32_bf16 v[48:51], a[168:171], a[8:11], v[48:51]
ds_read_b128 a[232:235], v13 offset:3072
s_or_b32 s62, s62, s38
ds_read_b128 a[236:239], v13 offset:4096
v_mfma_f32_16x16x32_bf16 v[48:51], a[172:175], a[12:15], v[48:51]
v_mov_b32 v16, s62
v_mov_b32 v17, s63
v_mfma_f32_16x16x32_bf16 v[48:51], a[176:179], a[16:19], v[48:51]
v_mov_b32 v18, 0
v_mov_b32 v19, 0
v_mfma_f32_16x16x32_bf16 v[48:51], a[180:183], a[20:23], v[48:51]
buffer_atomic_cmpswap_x2 v[16:19], v89, s[8:11], 0 offen sc0
v_mfma_f32_16x16x32_bf16 v[48:51], a[184:187], a[24:27], v[48:51]
ds_read_b64_tr_b16 a[192:193], v1 offset:49152
v_mfma_f32_16x16x32_bf16 v[48:51], a[188:191], a[28:31], v[48:51]
ds_read_b64_tr_b16 a[194:195], v1 offset:57344
v_mov_b32 v93, 1
v_mfma_f32_16x16x32_bf16 v[52:55], a[160:163], a[32:35], v[72:75]
buffer_atomic_add v93, v89, s[8:11], 0 offen offset:12 sc0
v_mfma_f32_16x16x32_bf16 v[52:55], a[164:167], a[36:39], v[52:55]
ds_read_b64_tr_b16 a[196:197], v2 offset:49152
v_mfma_f32_16x16x32_bf16 v[52:55], a[168:171], a[40:43], v[52:55]
ds_read_b64_tr_b16 a[198:199], v2 offset:57344
v_mfma_f32_16x16x32_bf16 v[52:55], a[172:175], a[44:47], v[52:55]
ds_read_b64_tr_b16 a[200:201], v3 offset:49152
v_mfma_f32_16x16x32_bf16 v[52:55], a[176:179], a[48:51], v[52:55]
ds_read_b64_tr_b16 a[202:203], v3 offset:57344
v_mfma_f32_16x16x32_bf16 v[52:55], a[180:183], a[52:55], v[52:55]
s_waitcnt lgkmcnt(10)
v_or_b32 v15, v24, v26
v_cmp_gt_i32 vcc, 0, v15
v_mfma_f32_16x16x32_bf16 v[52:55], a[184:187], a[56:59], v[52:55]
s_add_u32 m0, s33, 98304
s_nop 0
buffer_load_dwordx4 v20, s[20:23], s35 offen offset:0 nt lds
v_mfma_f32_16x16x32_bf16 v[52:55], a[188:191], a[60:63], v[52:55]
s_cbranch_vccnz L_R_t28
L_Rr_t28:
v_mfma_f32_16x16x32_bf16 v[56:59], a[160:163], a[64:67], v[76:79]
ds_read_b64_tr_b16 a[204:205], v4 offset:49152
v_mfma_f32_16x16x32_bf16 v[56:59], a[164:167], a[68:71], v[56:59]
ds_read_b64_tr_b16 a[206:207], v4 offset:57344
v_mfma_f32_16x16x32_bf16 v[56:59], a[168:171], a[72:75], v[56:59]
ds_read_b64_tr_b16 a[208:209], v5 offset:49152
v_mfma_f32_16x16x32_bf16 v[56:59], a[172:175], a[76:79], v[56:59]
ds_read_b64_tr_b16 a[210:211], v5 offset:57344
v_mfma_f32_16x16x32_bf16 v[56:59], a[176:179], a[80:83], v[56:59]
buffer_load_dwordx4 v21, s[20:23], s35 offen offset:1024 nt lds
v_mfma_f32_16x16x32_bf16 v[56:59], a[180:183], a[84:87], v[56:59]
ds_read_b64_tr_b16 a[212:213], v6 offset:49152
v_mfma_f32_16x16x32_bf16 v[56:59], a[184:187], a[88:91], v[56:59]
ds_read_b64_tr_b16 a[214:215], v6 offset:57344
v_mfma_f32_16x16x32_bf16 v[56:59], a[188:191], a[92:95], v[56:59]
ds_read_b64_tr_b16 a[216:217], v7 offset:49152
v_mfma_f32_16x16x32_bf16 v[60:63], a[160:163], a[96:99], v[80:83]
ds_read_b64_tr_b16 a[218:219], v7 offset:57344
v_mfma_f32_16x16x32_bf16 v[60:63], a[164:167], a[100:103], v[60:63]
ds_read_b64_tr_b16 a[220:221], v8 offset:49152
v_mfma_f32_16x16x32_bf16 v[60:63], a[168:171], a[104:107], v[60:63]
ds_read_b64_tr_b16 a[222:223], v8 offset:57344
v_mfma_f32_16x16x32_bf16 v[60:63], a[172:175], a[108:111], v[60:63]
buffer_load_dwordx4 v22, s[20:23], s35 offen offset:2048 nt lds
v_mfma_f32_16x16x32_bf16 v[60:63], a[176:179], a[112:115], v[60:63]
v_exp_f32 v40, v48
v_mfma_f32_16x16x32_bf16 v[60:63], a[180:183], a[116:119], v[60:63]
v_exp_f32 v41, v49
v_mfma_f32_16x16x32_bf16 v[60:63], a[184:187], a[120:123], v[60:63]
v_exp_f32 v42, v50
v_mfma_f32_16x16x32_bf16 v[60:63], a[188:191], a[124:127], v[60:63]
v_exp_f32 v43, v51
v_mfma_f32_16x16x32_bf16 v[64:67], a[160:163], a[128:131], v[84:87]
v_cvt_pk_bf16_f32 v28, v40, v41
v_cvt_pk_bf16_f32 v29, v42, v43
v_mfma_f32_16x16x32_bf16 v[64:67], a[164:167], a[132:135], v[64:67]
ds_read_b128 a[160:163], v9 offset:32768
v_or_b32 v15, v28, v29
v_mfma_f32_16x16x32_bf16 v[64:67], a[168:171], a[136:139], v[64:67]
buffer_load_dwordx4 v23, s[20:23], s35 offen offset:3072 nt lds
v_mfma_f32_16x16x32_bf16 v[64:67], a[172:175], a[140:143], v[64:67]
ds_read_b128 a[164:167], v10 offset:32768
v_mfma_f32_16x16x32_bf16 v[64:67], a[176:179], a[144:147], v[64:67]
ds_read_b128 a[168:171], v11 offset:32768
v_mfma_f32_16x16x32_bf16 v[64:67], a[180:183], a[148:151], v[64:67]
ds_read_b128 a[172:175], v12 offset:32768
v_mfma_f32_16x16x32_bf16 v[64:67], a[184:187], a[152:155], v[64:67]
ds_read_b128 a[176:179], v9 offset:33024
v_mfma_f32_16x16x32_bf16 v[64:67], a[188:191], a[156:159], v[64:67]
s_waitcnt lgkmcnt(13)
ds_read_b128 a[180:183], v10 offset:33024
v_mfma_f32_16x16x32_bf16 v[96:99], a[192:195], v[24:27], v[96:99]
ds_read_b128 a[184:187], v11 offset:33024
v_mfma_f32_16x16x32_bf16 v[100:103], a[192:195], a[224:227], v[100:103]
s_add_u32 s35, s35, 16384
s_and_b32 s35, s35, 524287
s_add_u32 m0, s33, 16384
v_mfma_f32_16x16x32_bf16 v[104:107], a[192:195], a[228:231], v[104:107]
s_mov_b32 s38, 114688
ds_read_b128 a[188:191], v12 offset:33024
v_mfma_f32_16x16x32_bf16 v[108:111], a[192:195], a[232:235], v[108:111]
buffer_load_dwordx4 v88, s[24:27], s38 offen offset:0  lds
v_mfma_f32_16x16x32_bf16 v[112:115], a[192:195], a[236:239], v[112:115]
ds_write_b64 v14, v[28:29] offset:10240
v_mfma_f32_16x16x32_bf16 v[116:119], a[196:199], v[24:27], v[116:119]
v_exp_f32 v44, v52
v_mfma_f32_16x16x32_bf16 v[120:123], a[196:199], a[224:227], v[120:123]
v_exp_f32 v45, v53
v_mfma_f32_16x16x32_bf16 v[124:127], a[196:199], a[228:231], v[124:127]
v_exp_f32 v46, v54
v_mfma_f32_16x16x32_bf16 v[128:131], a[196:199], a[232:235], v[128:131]
s_mov_b32 s38, 120832
v_exp_f32 v47, v55
v_mfma_f32_16x16x32_bf16 v[132:135], a[196:199], a[236:239], v[132:135]
buffer_load_dwordx4 v88, s[24:27], s38 offen offset:1024  lds
v_mfma_f32_16x16x32_bf16 v[136:139], a[200:203], v[24:27], v[136:139]
v_cvt_pk_bf16_f32 v30, v44, v45
v_cvt_pk_bf16_f32 v31, v46, v47
v_mfma_f32_16x16x32_bf16 v[140:143], a[200:203], a[224:227], v[140:143]
v_or3_b32 v15, v30, v31, v15
v_mfma_f32_16x16x32_bf16 v[144:147], a[200:203], a[228:231], v[144:147]
ds_write_b64 v14, v[30:31] offset:11264
v_mfma_f32_16x16x32_bf16 v[148:151], a[200:203], a[232:235], v[148:151]
v_exp_f32 v40, v56
v_mfma_f32_16x16x32_bf16 v[152:155], a[200:203], a[236:239], v[152:155]
v_exp_f32 v41, v57
v_mfma_f32_16x16x32_bf16 v[156:159], a[204:207], v[24:27], v[156:159]
s_mov_b32 s38, 126976
v_exp_f32 v42, v58
v_mfma_f32_16x16x32_bf16 v[160:163], a[204:207], a[224:227], v[160:163]
buffer_load_dwordx4 v88, s[24:27], s38 offen offset:2048  lds
v_mfma_f32_16x16x32_bf16 v[164:167], a[204:207], a[228:231], v[164:167]
v_exp_f32 v43, v59
v_mfma_f32_16x16x32_bf16 v[168:171], a[204:207], a[232:235], v[168:171]
v_cvt_pk_bf16_f32 v32, v40, v41
v_cvt_pk_bf16_f32 v33, v42, v43
v_mfma_f32_16x16x32_bf16 v[172:175], a[204:207], a[236:239], v[172:175]
s_waitcnt lgkmcnt(10)
v_or3_b32 v15, v32, v33, v15
v_mfma_f32_16x16x32_bf16 v[176:179], a[208:211], v[24:27], v[176:179]
ds_write_b64 v14, v[32:33] offset:12288
v_mfma_f32_16x16x32_bf16 v[180:183], a[208:211], a[224:227], v[180:183]
v_exp_f32 v44, v60
v_mfma_f32_16x16x32_bf16 v[184:187], a[208:211], a[228:231], v[184:187]
s_mov_b32 s38, 133120
v_exp_f32 v45, v61
v_mfma_f32_16x16x32_bf16 v[188:191], a[208:211], a[232:235], v[188:191]
buffer_load_dwordx4 v88, s[24:27], s38 offen offset:3072  lds
v_mfma_f32_16x16x32_bf16 v[192:195], a[208:211], a[236:239], v[192:195]
v_exp_f32 v46, v62
v_mfma_f32_16x16x32_bf16 v[196:199], a[212:215], v[24:27], v[196:199]
v_exp_f32 v47, v63
v_mfma_f32_16x16x32_bf16 v[200:203], a[212:215], a[224:227], v[200:203]
v_cvt_pk_bf16_f32 v34, v44, v45
v_cvt_pk_bf16_f32 v35, v46, v47
v_mfma_f32_16x16x32_bf16 v[204:207], a[212:215], a[228:231], v[204:207]
v_or3_b32 v15, v34, v35, v15
v_mfma_f32_16x16x32_bf16 v[208:211], a[212:215], a[232:235], v[208:211]
ds_write_b64 v14, v[34:35] offset:13312
v_mfma_f32_16x16x32_bf16 v[212:215], a[212:215], a[236:239], v[212:215]
v_exp_f32 v40, v64
v_mfma_f32_16x16x32_bf16 v[216:219], a[216:219], v[24:27], v[216:219]
v_exp_f32 v41, v65
v_mfma_f32_16x16x32_bf16 v[220:223], a[216:219], a[224:227], v[220:223]
v_exp_f32 v42, v66
v_mfma_f32_16x16x32_bf16 v[224:227], a[216:219], a[228:231], v[224:227]
v_exp_f32 v43, v67
v_mfma_f32_16x16x32_bf16 v[228:231], a[216:219], a[232:235], v[228:231]
v_cvt_pk_bf16_f32 v36, v40, v41
v_cvt_pk_bf16_f32 v37, v42, v43
v_mfma_f32_16x16x32_bf16 v[232:235], a[216:219], a[236:239], v[232:235]
v_or3_b32 v15, v36, v37, v15
v_lshlrev_b32 v94, 3, v89
v_mfma_f32_16x16x32_bf16 v[236:239], a[220:223], v[24:27], v[236:239]
ds_write_b64 v14, v[36:37] offset:14336
v_mfma_f32_16x16x32_bf16 v[240:243], a[220:223], a[224:227], v[240:243]
buffer_load_dword v94, v94, s[24:27], s69 offen
v_mfma_f32_16x16x32_bf16 v[244:247], a[220:223], a[228:231], v[244:247]
v_and_b32 v15, s43, v15
v_cmp_ne_u32 vcc, 0, v15
v_mfma_f32_16x16x32_bf16 v[248:251], a[220:223], a[232:235], v[248:251]
v_mfma_f32_16x16x32_bf16 v[252:255], a[220:223], a[236:239], v[252:255]
s_cbranch_vccnz L_D_t28
L_Dr_t28:
v_mfma_f32_16x16x32_bf16 a[240:243], a[252:255], v[28:31], a[240:243]
v_mfma_f32_16x16x32_bf16 a[244:247], a[252:255], v[32:35], a[244:247]
v_mfma_f32_16x16x32_bf16 a[248:251], a[252:255], v[36:39], a[248:251]
s_waitcnt vmcnt(19) lgkmcnt(0)
s_barrier
ds_read_b128 v[24:27], v13 offset:10240
s_mov_b64 s[20:21], s[72:73]
v_mfma_f32_16x16x32_bf16 v[48:51], a[160:163], a[0:3], v[68:71]
s_add_u32 m0, s33, 32768
ds_read_b128 a[224:227], v13 offset:11264
s_mov_b32 s38, 128
v_mfma_f32_16x16x32_bf16 v[48:51], a[164:167], a[4:7], v[48:51]
s_mov_b32 s22, 0
ds_read_b128 a[228:231], v13 offset:12288
v_mfma_f32_16x16x32_bf16 v[48:51], a[168:171], a[8:11], v[48:51]
ds_read_b128 a[232:235], v13 offset:13312
ds_read_b128 a[236:239], v13 offset:14336
v_mfma_f32_16x16x32_bf16 v[48:51], a[172:175], a[12:15], v[48:51]
buffer_load_dwordx4 v88, s[24:27], s38 offen offset:0  lds
v_mfma_f32_16x16x32_bf16 v[48:51], a[176:179], a[16:19], v[48:51]
s_mov_b32 s23, 0x20000
ds_read_b64_tr_b16 a[192:193], v1 offset:32768
v_mfma_f32_16x16x32_bf16 v[48:51], a[180:183], a[20:23], v[48:51]
s_mov_b32 s38, 6272
ds_read_b64_tr_b16 a[194:195], v1 offset:40960
s_mul_i32 s3, s32, 20480
v_mfma_f32_16x16x32_bf16 v[48:51], a[184:187], a[24:27], v[48:51]
buffer_load_dwordx4 v88, s[24:27], s38 offen offset:1024  lds
v_mfma_f32_16x16x32_bf16 v[48:51], a[188:191], a[28:31], v[48:51]
s_add_u32 s3, s3, 65536
ds_read_b64_tr_b16 a[196:197], v2 offset:32768
v_mfma_f32_16x16x32_bf16 v[52:55], a[160:163], a[32:35], v[72:75]
ds_read_b64_tr_b16 a[198:199], v2 offset:40960
v_mfma_f32_16x16x32_bf16 v[52:55], a[164:167], a[36:39], v[52:55]
ds_read_b64_tr_b16 a[200:201], v3 offset:32768
v_add_u32 v20, s3, v89
v_mfma_f32_16x16x32_bf16 v[52:55], a[168:171], a[40:43], v[52:55]
s_mov_b32 s38, 12416
ds_read_b64_tr_b16 a[202:203], v3 offset:40960
v_mfma_f32_16x16x32_bf16 v[52:55], a[172:175], a[44:47], v[52:55]
buffer_load_dwordx4 v88, s[24:27], s38 offen offset:2048  lds
v_mfma_f32_16x16x32_bf16 v[52:55], a[176:179], a[48:51], v[52:55]
s_xor_b32 s3, s32, 1
ds_read_b64_tr_b16 a[204:205], v4 offset:32768
v_mfma_f32_16x16x32_bf16 v[52:55], a[180:183], a[52:55], v[52:55]
s_waitcnt lgkmcnt(11)
v_or_b32 v15, v24, v26
v_cmp_gt_i32 vcc, 0, v15
v_mfma_f32_16x16x32_bf16 v[52:55], a[184:187], a[56:59], v[52:55]
s_mul_i32 s3, s3, 20480
ds_read_b64_tr_b16 a[206:207], v4 offset:40960
v_mfma_f32_16x16x32_bf16 v[52:55], a[188:191], a[60:63], v[52:55]
s_cbranch_vccnz L_R_t29
L_Rr_t29:
v_mfma_f32_16x16x32_bf16 v[56:59], a[160:163], a[64:67], v[76:79]
s_mov_b32 s38, 18560
s_add_u32 s3, s3, 65536
v_add_u32 v21, s3, v89
v_mfma_f32_16x16x32_bf16 v[56:59], a[164:167], a[68:71], v[56:59]
buffer_load_dwordx4 v88, s[24:27], s38 offen offset:3072  lds
v_mfma_f32_16x16x32_bf16 v[56:59], a[168:171], a[72:75], v[56:59]
s_mul_i32 s3, s32, 1536
ds_read_b64_tr_b16 a[208:209], v5 offset:32768
v_mfma_f32_16x16x32_bf16 v[56:59], a[172:175], a[76:79], v[56:59]
ds_read_b64_tr_b16 a[210:211], v5 offset:40960
v_mfma_f32_16x16x32_bf16 v[56:59], a[176:179], a[80:83], v[56:59]
s_add_u32 s3, s3, 147456
ds_read_b64_tr_b16 a[212:213], v6 offset:32768
v_mfma_f32_16x16x32_bf16 v[56:59], a[180:183], a[84:87], v[56:59]
ds_read_b64_tr_b16 a[214:215], v6 offset:40960
v_mfma_f32_16x16x32_bf16 v[56:59], a[184:187], a[88:91], v[56:59]
ds_read_b64_tr_b16 a[216:217], v7 offset:32768
v_bfe_u32 v23, v0, 5, 1
v_mfma_f32_16x16x32_bf16 v[56:59], a[188:191], a[92:95], v[56:59]
ds_read_b64_tr_b16 a[218:219], v7 offset:40960
v_mfma_f32_16x16x32_bf16 v[60:63], a[160:163], a[96:99], v[80:83]
ds_read_b64_tr_b16 a[220:221], v8 offset:32768
v_mul_u32_u24 v23, 640, v23
v_mfma_f32_16x16x32_bf16 v[60:63], a[164:167], a[100:103], v[60:63]
ds_read_b64_tr_b16 a[222:223], v8 offset:40960
v_mfma_f32_16x16x32_bf16 v[60:63], a[168:171], a[104:107], v[60:63]
v_lshrrev_b32 v22, 2, v89
v_mfma_f32_16x16x32_bf16 v[60:63], a[172:175], a[108:111], v[60:63]
v_exp_f32 v40, v48
v_mfma_f32_16x16x32_bf16 v[60:63], a[176:179], a[112:115], v[60:63]
v_add3_u32 v22, v22, v23, s3
v_mfma_f32_16x16x32_bf16 v[60:63], a[180:183], a[116:119], v[60:63]
v_exp_f32 v41, v49
v_mfma_f32_16x16x32_bf16 v[60:63], a[184:187], a[120:123], v[60:63]
s_mul_i32 s41, s47, 1536
v_exp_f32 v42, v50
v_mfma_f32_16x16x32_bf16 v[60:63], a[188:191], a[124:127], v[60:63]
v_exp_f32 v43, v51
v_mfma_f32_16x16x32_bf16 v[64:67], a[160:163], a[128:131], v[84:87]
s_sub_u32 s3, s3, s41
v_cvt_pk_bf16_f32 v28, v40, v41
v_cvt_pk_bf16_f32 v29, v42, v43
v_mfma_f32_16x16x32_bf16 v[64:67], a[164:167], a[132:135], v[64:67]
ds_read_b128 a[160:163], v9 offset:49152
v_or_b32 v15, v28, v29
v_mfma_f32_16x16x32_bf16 v[64:67], a[168:171], a[136:139], v[64:67]
ds_read_b128 a[164:167], v10 offset:49152
v_and_b32 v23, 15, v0
v_mfma_f32_16x16x32_bf16 v[64:67], a[172:175], a[140:143], v[64:67]
ds_read_b128 a[168:171], v11 offset:49152
v_mfma_f32_16x16x32_bf16 v[64:67], a[176:179], a[144:147], v[64:67]
ds_read_b128 a[172:175], v12 offset:49152
v_lshl_add_u32 v23, v23, 2, s3
v_mfma_f32_16x16x32_bf16 v[64:67], a[180:183], a[148:151], v[64:67]
ds_read_b128 a[176:179], v9 offset:49408
v_mfma_f32_16x16x32_bf16 v[64:67], a[184:187], a[152:155], v[64:67]
ds_read_b128 a[180:183], v10 offset:49408
v_mfma_f32_16x16x32_bf16 v[64:67], a[188:191], a[156:159], v[64:67]
s_waitcnt lgkmcnt(14)
ds_read_b128 a[184:187], v11 offset:49408
v_mfma_f32_16x16x32_bf16 v[96:99], a[192:195], v[24:27], v[96:99]
ds_read_b128 a[188:191], v12 offset:49408
v_mfma_f32_16x16x32_bf16 v[100:103], a[192:195], a[224:227], v[100:103]
ds_write_b64 v14, v[28:29] offset:0
v_mfma_f32_16x16x32_bf16 v[104:107], a[192:195], a[228:231], v[104:107]
v_exp_f32 v44, v52
v_mfma_f32_16x16x32_bf16 v[108:111], a[192:195], a[232:235], v[108:111]
v_exp_f32 v45, v53
v_mfma_f32_16x16x32_bf16 v[112:115], a[192:195], a[236:239], v[112:115]
v_exp_f32 v46, v54
v_mfma_f32_16x16x32_bf16 v[116:119], a[196:199], v[24:27], v[116:119]
v_exp_f32 v47, v55
v_mfma_f32_16x16x32_bf16 v[120:123], a[196:199], a[224:227], v[120:123]
v_cvt_pk_bf16_f32 v30, v44, v45
v_cvt_pk_bf16_f32 v31, v46, v47
v_mfma_f32_16x16x32_bf16 v[124:127], a[196:199], a[228:231], v[124:127]
v_or3_b32 v15, v30, v31, v15
v_mfma_f32_16x16x32_bf16 v[128:131], a[196:199], a[232:235], v[128:131]
v_bfe_u32 v10, v0, 2, 2
v_bfe_u32 v11, v0, 4, 2
v_mfma_f32_16x16x32_bf16 v[132:135], a[196:199], a[236:239], v[132:135]
v_lshl_add_u32 v12, v11, 2, v10
v_and_b32 v11, 1, v11
v_mfma_f32_16x16x32_bf16 v[136:139], a[200:203], v[24:27], v[136:139]
v_xor_b32 v10, v10, v11
v_lshlrev_b32 v10, 5, v10
v_mfma_f32_16x16x32_bf16 v[140:143], a[200:203], a[224:227], v[140:143]
v_lshl_add_u32 v10, v12, 7, v10
v_mfma_f32_16x16x32_bf16 v[144:147], a[200:203], a[228:231], v[144:147]
ds_write_b64 v14, v[30:31] offset:1024
v_mfma_f32_16x16x32_bf16 v[148:151], a[200:203], a[232:235], v[148:151]
v_exp_f32 v40, v56
v_mfma_f32_16x16x32_bf16 v[152:155], a[200:203], a[236:239], v[152:155]
v_exp_f32 v41, v57
v_mfma_f32_16x16x32_bf16 v[156:159], a[204:207], v[24:27], v[156:159]
v_exp_f32 v42, v58
v_mfma_f32_16x16x32_bf16 v[160:163], a[204:207], a[224:227], v[160:163]
v_exp_f32 v43, v59
v_mfma_f32_16x16x32_bf16 v[164:167], a[204:207], a[228:231], v[164:167]
v_cvt_pk_bf16_f32 v32, v40, v41
v_cvt_pk_bf16_f32 v33, v42, v43
v_mfma_f32_16x16x32_bf16 v[168:171], a[204:207], a[232:235], v[168:171]
v_or3_b32 v15, v32, v33, v15
v_and_b32 v11, 3, v0
v_mfma_f32_16x16x32_bf16 v[172:175], a[204:207], a[236:239], v[172:175]
s_waitcnt lgkmcnt(10)
ds_write_b64 v14, v[32:33] offset:2048
v_mfma_f32_16x16x32_bf16 v[176:179], a[208:211], v[24:27], v[176:179]
v_exp_f32 v44, v60
v_mfma_f32_16x16x32_bf16 v[180:183], a[208:211], a[224:227], v[180:183]
v_exp_f32 v45, v61
v_mfma_f32_16x16x32_bf16 v[184:187], a[208:211], a[228:231], v[184:187]
v_exp_f32 v46, v62
v_mfma_f32_16x16x32_bf16 v[188:191], a[208:211], a[232:235], v[188:191]
v_exp_f32 v47, v63
v_mfma_f32_16x16x32_bf16 v[192:195], a[208:211], a[236:239], v[192:195]
v_cvt_pk_bf16_f32 v34, v44, v45
v_cvt_pk_bf16_f32 v35, v46, v47
v_mfma_f32_16x16x32_bf16 v[196:199], a[212:215], v[24:27], v[196:199]
v_or3_b32 v15, v34, v35, v15
v_lshl_add_u32 v10, v11, 3, v10
v_mfma_f32_16x16x32_bf16 v[200:203], a[212:215], a[224:227], v[200:203]
s_mul_i32 s3, s47, 16448
ds_write_b64 v14, v[34:35] offset:3072
v_mfma_f32_16x16x32_bf16 v[204:207], a[212:215], a[228:231], v[204:207]
s_and_b32 s41, s37, 1
v_exp_f32 v40, v64
v_mfma_f32_16x16x32_bf16 v[208:211], a[212:215], a[232:235], v[208:211]
s_lshl_b32 s41, s41, 5
v_exp_f32 v41, v65
v_mfma_f32_16x16x32_bf16 v[212:215], a[212:215], a[236:239], v[212:215]
s_or_b32 s3, s3, s41
v_exp_f32 v42, v66
v_mfma_f32_16x16x32_bf16 v[216:219], a[216:219], v[24:27], v[216:219]
v_exp_f32 v43, v67
v_mfma_f32_16x16x32_bf16 v[220:223], a[216:219], a[224:227], v[220:223]
v_cvt_pk_bf16_f32 v36, v40, v41
v_cvt_pk_bf16_f32 v37, v42, v43
v_mfma_f32_16x16x32_bf16 v[224:227], a[216:219], a[228:231], v[224:227]
v_or3_b32 v15, v36, v37, v15
v_xor_b32 v9, s3, v10
v_mfma_f32_16x16x32_bf16 v[228:231], a[216:219], a[232:235], v[228:231]
ds_write_b64 v14, v[36:37] offset:4096
v_mfma_f32_16x16x32_bf16 v[232:235], a[216:219], a[236:239], v[232:235]
v_and_b32 v15, s43, v15
v_cmp_ne_u32 vcc, 0, v15
v_mfma_f32_16x16x32_bf16 v[236:239], a[220:223], v[24:27], v[236:239]
v_xor_b32 v10, 32, v9
v_xor_b32 v11, 16384, v9
v_mfma_f32_16x16x32_bf16 v[240:243], a[220:223], a[224:227], v[240:243]
v_xor_b32 v12, 16416, v9
v_mfma_f32_16x16x32_bf16 v[244:247], a[220:223], a[228:231], v[244:247]
v_mfma_f32_16x16x32_bf16 v[248:251], a[220:223], a[232:235], v[248:251]
v_mfma_f32_16x16x32_bf16 v[252:255], a[220:223], a[236:239], v[252:255]
s_cbranch_vccnz L_D_t29
L_Dr_t29:
v_mfma_f32_16x16x32_bf16 a[240:243], a[252:255], v[28:31], a[240:243]
v_mfma_f32_16x16x32_bf16 a[244:247], a[252:255], v[32:35], a[244:247]
v_mfma_f32_16x16x32_bf16 a[248:251], a[252:255], v[36:39], a[248:251]
s_waitcnt vmcnt(5) lgkmcnt(0)
s_barrier
ds_read_b128 v[24:27], v13 offset:0
v_mfma_f32_16x16x32_bf16 v[48:51], a[160:163], a[0:3], v[68:71]
s_add_u32 m0, s33, 49152
ds_read_b128 a[224:227], v13 offset:1024
s_mov_b32 s38, 114816
v_mfma_f32_16x16x32_bf16 v[48:51], a[164:167], a[4:7], v[48:51]
ds_read_b128 a[228:231], v13 offset:2048
v_mfma_f32_16x16x32_bf16 v[48:51], a[168:171], a[8:11], v[48:51]
ds_read_b128 a[232:235], v13 offset:3072
ds_read_b128 a[236:239], v13 offset:4096
v_mfma_f32_16x16x32_bf16 v[48:51], a[172:175], a[12:15], v[48:51]
buffer_load_dwordx4 v88, s[24:27], s38 offen offset:0  lds
v_mfma_f32_16x16x32_bf16 v[48:51], a[176:179], a[16:19], v[48:51]
ds_read_b64_tr_b16 a[192:193], v1 offset:16384
v_mfma_f32_16x16x32_bf16 v[48:51], a[180:183], a[20:23], v[48:51]
s_mov_b32 s38, 120960
ds_read_b64_tr_b16 a[194:195], v1 offset:24576
v_mfma_f32_16x16x32_bf16 v[48:51], a[184:187], a[24:27], v[48:51]
buffer_load_dwordx4 v88, s[24:27], s38 offen offset:1024  lds
v_mfma_f32_16x16x32_bf16 v[48:51], a[188:191], a[28:31], v[48:51]
ds_read_b64_tr_b16 a[196:197], v2 offset:16384
v_mfma_f32_16x16x32_bf16 v[52:55], a[160:163], a[32:35], v[72:75]
ds_read_b64_tr_b16 a[198:199], v2 offset:24576
v_mfma_f32_16x16x32_bf16 v[52:55], a[164:167], a[36:39], v[52:55]
ds_read_b64_tr_b16 a[200:201], v3 offset:16384
v_mfma_f32_16x16x32_bf16 v[52:55], a[168:171], a[40:43], v[52:55]
s_mov_b32 s38, 127104
ds_read_b64_tr_b16 a[202:203], v3 offset:24576
v_mfma_f32_16x16x32_bf16 v[52:55], a[172:175], a[44:47], v[52:55]
buffer_load_dwordx4 v88, s[24:27], s38 offen offset:2048  lds
v_mfma_f32_16x16x32_bf16 v[52:55], a[176:179], a[48:51], v[52:55]
ds_read_b64_tr_b16 a[204:205], v4 offset:16384
v_mfma_f32_16x16x32_bf16 v[52:55], a[180:183], a[52:55], v[52:55]
s_waitcnt lgkmcnt(11)
v_or_b32 v15, v24, v26
v_cmp_gt_i32 vcc, 0, v15
v_mfma_f32_16x16x32_bf16 v[52:55], a[184:187], a[56:59], v[52:55]
ds_read_b64_tr_b16 a[206:207], v4 offset:24576
v_mfma_f32_16x16x32_bf16 v[52:55], a[188:191], a[60:63], v[52:55]
s_cbranch_vccnz L_R_t30
L_Rr_t30:
v_mfma_f32_16x16x32_bf16 v[56:59], a[160:163], a[64:67], v[76:79]
s_mov_b32 s38, 133248
v_exp_f32 v40, v48
v_mfma_f32_16x16x32_bf16 v[56:59], a[164:167], a[68:71], v[56:59]
buffer_load_dwordx4 v88, s[24:27], s38 offen offset:3072  lds
v_mfma_f32_16x16x32_bf16 v[56:59], a[168:171], a[72:75], v[56:59]
v_exp_f32 v41, v49
v_mfma_f32_16x16x32_bf16 v[56:59], a[172:175], a[76:79], v[56:59]
v_exp_f32 v42, v50
v_mfma_f32_16x16x32_bf16 v[56:59], a[176:179], a[80:83], v[56:59]
v_exp_f32 v43, v51
v_mfma_f32_16x16x32_bf16 v[56:59], a[180:183], a[84:87], v[56:59]
v_cvt_pk_bf16_f32 v28, v40, v41
v_cvt_pk_bf16_f32 v29, v42, v43
v_mfma_f32_16x16x32_bf16 v[56:59], a[184:187], a[88:91], v[56:59]
ds_read_b64_tr_b16 a[208:209], v5 offset:16384
v_or_b32 v15, v28, v29
v_mfma_f32_16x16x32_bf16 v[56:59], a[188:191], a[92:95], v[56:59]
ds_write_b64 v14, v[28:29] offset:10240
v_mfma_f32_16x16x32_bf16 v[60:63], a[160:163], a[96:99], v[80:83]
v_exp_f32 v44, v52
v_mfma_f32_16x16x32_bf16 v[60:63], a[164:167], a[100:103], v[60:63]
v_exp_f32 v45, v53
v_mfma_f32_16x16x32_bf16 v[60:63], a[168:171], a[104:107], v[60:63]
v_exp_f32 v46, v54
v_mfma_f32_16x16x32_bf16 v[60:63], a[172:175], a[108:111], v[60:63]
v_exp_f32 v47, v55
v_mfma_f32_16x16x32_bf16 v[60:63], a[176:179], a[112:115], v[60:63]
v_cvt_pk_bf16_f32 v30, v44, v45
v_cvt_pk_bf16_f32 v31, v46, v47
v_mfma_f32_16x16x32_bf16 v[60:63], a[180:183], a[116:119], v[60:63]
ds_read_b64_tr_b16 a[210:211], v5 offset:24576
v_or3_b32 v15, v30, v31, v15
v_mfma_f32_16x16x32_bf16 v[60:63], a[184:187], a[120:123], v[60:63]
ds_write_b64 v14, v[30:31] offset:11264
v_mfma_f32_16x16x32_bf16 v[60:63], a[188:191], a[124:127], v[60:63]
v_exp_f32 v40, v56
v_mfma_f32_16x16x32_bf16 v[64:67], a[160:163], a[128:131], v[84:87]
v_exp_f32 v41, v57
v_mfma_f32_16x16x32_bf16 v[64:67], a[164:167], a[132:135], v[64:67]
v_exp_f32 v42, v58
v_mfma_f32_16x16x32_bf16 v[64:67], a[168:171], a[136:139], v[64:67]
v_exp_f32 v43, v59
v_mfma_f32_16x16x32_bf16 v[64:67], a[172:175], a[140:143], v[64:67]
v_cvt_pk_bf16_f32 v32, v40, v41
v_cvt_pk_bf16_f32 v33, v42, v43
v_mfma_f32_16x16x32_bf16 v[64:67], a[176:179], a[144:147], v[64:67]
ds_read_b64_tr_b16 a[80:81], v9 offset:0
v_or3_b32 v15, v32, v33, v15
v_mfma_f32_16x16x32_bf16 v[64:67], a[180:183], a[148:151], v[64:67]
ds_read_b64_tr_b16 a[82:83], v9 offset:2048
v_mfma_f32_16x16x32_bf16 v[64:67], a[184:187], a[152:155], v[64:67]
ds_read_b64_tr_b16 a[84:85], v10 offset:0
v_mfma_f32_16x16x32_bf16 v[64:67], a[188:191], a[156:159], v[64:67]
s_waitcnt lgkmcnt(7)
ds_read_b64_tr_b16 a[86:87], v10 offset:2048
v_mfma_f32_16x16x32_bf16 v[96:99], a[192:195], v[24:27], v[96:99]
ds_read_b64_tr_b16 a[88:89], v9 offset:4096
v_mfma_f32_16x16x32_bf16 v[100:103], a[192:195], a[224:227], v[100:103]
ds_read_b64_tr_b16 a[90:91], v9 offset:6144
v_mfma_f32_16x16x32_bf16 v[104:107], a[192:195], a[228:231], v[104:107]
ds_read_b64_tr_b16 a[92:93], v10 offset:4096
v_cmp_eq_u64 s[60:61], 0, v[16:17]
v_mfma_f32_16x16x32_bf16 v[108:111], a[192:195], a[232:235], v[108:111]
ds_read_b64_tr_b16 a[212:213], v6 offset:16384
v_mov_b32 v18, s62
v_mfma_f32_16x16x32_bf16 v[112:115], a[192:195], a[236:239], v[112:115]
ds_read_b64_tr_b16 a[214:215], v6 offset:24576
v_mfma_f32_16x16x32_bf16 v[116:119], a[196:199], v[24:27], v[116:119]
ds_read_b64_tr_b16 a[216:217], v7 offset:16384
v_mov_b32 v19, s63
v_mfma_f32_16x16x32_bf16 v[120:123], a[196:199], a[224:227], v[120:123]
ds_read_b64_tr_b16 a[218:219], v7 offset:24576
v_mfma_f32_16x16x32_bf16 v[124:127], a[196:199], a[228:231], v[124:127]
ds_read_b64_tr_b16 a[220:221], v8 offset:16384
ds_read_b64_tr_b16 a[222:223], v8 offset:24576
ds_read_b64_tr_b16 a[94:95], v10 offset:6144
ds_write_b64 v14, v[32:33] offset:12288
v_mfma_f32_16x16x32_bf16 v[128:131], a[196:199], a[232:235], v[128:131]
v_exp_f32 v44, v60
v_mfma_f32_16x16x32_bf16 v[132:135], a[196:199], a[236:239], v[132:135]
ds_read_b64_tr_b16 a[96:97], v9 offset:8192
v_exp_f32 v45, v61
v_mfma_f32_16x16x32_bf16 v[136:139], a[200:203], v[24:27], v[136:139]
ds_read_b64_tr_b16 a[98:99], v9 offset:10240
v_exp_f32 v46, v62
v_exp_f32 v47, v63
v_cndmask_b32 v16, v16, v18, s[60:61]
v_mfma_f32_16x16x32_bf16 v[140:143], a[200:203], a[224:227], v[140:143]
ds_read_b64_tr_b16 a[100:101], v10 offset:8192
v_cvt_pk_bf16_f32 v34, v44, v45
v_mfma_f32_16x16x32_bf16 v[144:147], a[200:203], a[228:231], v[144:147]
v_cvt_pk_bf16_f32 v35, v46, v47
v_cndmask_b32 v17, v17, v19, s[60:61]
v_mfma_f32_16x16x32_bf16 v[148:151], a[200:203], a[232:235], v[148:151]
v_or3_b32 v15, v34, v35, v15
ds_write_b64 v14, v[34:35] offset:13312
v_mfma_f32_16x16x32_bf16 v[152:155], a[200:203], a[236:239], v[152:155]
ds_read_b64_tr_b16 a[102:103], v10 offset:10240
v_exp_f32 v40, v64
v_mov_b32 v18, v93
v_mfma_f32_16x16x32_bf16 v[156:159], a[204:207], v[24:27], v[156:159]
ds_read_b64_tr_b16 a[104:105], v9 offset:12288
v_exp_f32 v41, v65
v_mov_b32 v19, 96256
v_mfma_f32_16x16x32_bf16 v[160:163], a[204:207], a[224:227], v[160:163]
v_exp_f32 v42, v66
v_exp_f32 v43, v67
v_mfma_f32_16x16x32_bf16 v[164:167], a[204:207], a[228:231], v[164:167]
ds_read_b64_tr_b16 a[106:107], v9 offset:14336
v_cvt_pk_bf16_f32 v36, v40, v41
v_min_u32 v93, 1, v0
v_mfma_f32_16x16x32_bf16 v[168:171], a[204:207], a[232:235], v[168:171]
ds_read_b64_tr_b16 a[108:109], v10 offset:12288
v_cvt_pk_bf16_f32 v37, v42, v43
v_mfma_f32_16x16x32_bf16 v[172:175], a[204:207], a[236:239], v[172:175]
s_waitcnt lgkmcnt(10)
v_or3_b32 v15, v36, v37, v15
ds_write_b64 v14, v[36:37] offset:14336
v_lshl_add_u32 v93, v93, 4, v19
v_mfma_f32_16x16x32_bf16 v[176:179], a[208:211], v[24:27], v[176:179]
ds_read_b64_tr_b16 a[110:111], v10 offset:14336
v_and_b32 v15, s43, v15
v_cmp_ne_u32 vcc, 0, v15
v_mfma_f32_16x16x32_bf16 v[180:183], a[208:211], a[224:227], v[180:183]
ds_read_b64_tr_b16 a[112:113], v11 offset:0
ds_write_b128 v93, v[16:19] offset:0
s_cbranch_vccnz L_D_t30
L_Dr_t30:
v_mfma_f32_16x16x32_bf16 a[240:243], a[252:255], v[28:31], a[240:243]
ds_read_b64_tr_b16 a[114:115], v11 offset:2048
v_mfma_f32_16x16x32_bf16 a[244:247], a[252:255], v[32:35], a[244:247]
ds_read_b64_tr_b16 a[116:117], v12 offset:0
v_mfma_f32_16x16x32_bf16 a[248:251], a[252:255], v[36:39], a[248:251]
s_waitcnt lgkmcnt(5)
s_waitcnt lgkmcnt(2)
s_barrier
ds_read_b64_tr_b16 a[118:119], v12 offset:2048
v_mfma_f32_16x16x32_bf16 v[184:187], a[208:211], a[228:231], v[184:187]
ds_read_b64_tr_b16 a[120:121], v11 offset:4096
v_mfma_f32_16x16x32_bf16 v[188:191], a[208:211], a[232:235], v[188:191]
ds_read_b64_tr_b16 a[122:123], v11 offset:6144
v_mfma_f32_16x16x32_bf16 v[192:195], a[208:211], a[236:239], v[192:195]
ds_read_b96 v[16:18], v19 offset:0
v_mfma_f32_16x16x32_bf16 v[196:199], a[212:215], v[24:27], v[196:199]
ds_read_b128 v[48:51], v13 offset:10240
v_mfma_f32_16x16x32_bf16 v[200:203], a[212:215], a[224:227], v[200:203]
ds_read_b128 v[52:55], v13 offset:11264
ds_read_b128 v[56:59], v13 offset:12288
ds_read_b128 v[60:63], v13 offset:13312
ds_read_b128 v[64:67], v13 offset:14336
ds_read_b64_tr_b16 a[124:125], v12 offset:4096
v_mfma_f32_16x16x32_bf16 v[204:207], a[212:215], a[228:231], v[204:207]
ds_read_b64_tr_b16 a[126:127], v12 offset:6144
v_mfma_f32_16x16x32_bf16 v[208:211], a[212:215], a[232:235], v[208:211]
ds_read_b64_tr_b16 a[128:129], v11 offset:8192
v_mfma_f32_16x16x32_bf16 v[212:215], a[212:215], a[236:239], v[212:215]
ds_read_b64_tr_b16 a[160:161], v1 offset:0
v_mfma_f32_16x16x32_bf16 v[216:219], a[216:219], v[24:27], v[216:219]
ds_read_b64_tr_b16 a[162:163], v1 offset:8192
ds_read_b64_tr_b16 a[130:131], v11 offset:10240
v_mfma_f32_16x16x32_bf16 v[220:223], a[216:219], a[224:227], v[220:223]
ds_read_b64_tr_b16 a[164:165], v2 offset:0
ds_read_b64_tr_b16 a[166:167], v2 offset:8192
v_mfma_f32_16x16x32_bf16 v[224:227], a[216:219], a[228:231], v[224:227]
ds_read_b64_tr_b16 a[168:169], v3 offset:0
ds_read_b64_tr_b16 a[170:171], v3 offset:8192
ds_read_b64_tr_b16 a[132:133], v12 offset:8192
v_mfma_f32_16x16x32_bf16 v[228:231], a[216:219], a[232:235], v[228:231]
ds_read_b64_tr_b16 a[172:173], v4 offset:0
ds_read_b64_tr_b16 a[174:175], v4 offset:8192
ds_read_b64_tr_b16 a[134:135], v12 offset:10240
v_mfma_f32_16x16x32_bf16 v[232:235], a[216:219], a[236:239], v[232:235]
ds_read_b64_tr_b16 a[176:177], v5 offset:0
ds_read_b64_tr_b16 a[178:179], v5 offset:8192
v_mfma_f32_16x16x32_bf16 v[236:239], a[220:223], v[24:27], v[236:239]
ds_read_b64_tr_b16 a[180:181], v6 offset:0
ds_read_b64_tr_b16 a[182:183], v6 offset:8192
ds_read_b64_tr_b16 a[136:137], v11 offset:12288
v_mfma_f32_16x16x32_bf16 v[240:243], a[220:223], a[224:227], v[240:243]
ds_read_b64_tr_b16 a[184:185], v7 offset:0
ds_read_b64_tr_b16 a[186:187], v7 offset:8192
ds_read_b64_tr_b16 a[138:139], v11 offset:14336
v_mfma_f32_16x16x32_bf16 v[244:247], a[220:223], a[228:231], v[244:247]
ds_read_b64_tr_b16 a[188:189], v8 offset:0
ds_read_b64_tr_b16 a[190:191], v8 offset:8192
v_mfma_f32_16x16x32_bf16 v[248:251], a[220:223], a[232:235], v[248:251]
ds_read_b64_tr_b16 a[140:141], v12 offset:12288
s_waitcnt lgkmcnt(15)
v_or_b32 v15, v48, v50
v_cmp_gt_i32 vcc, 0, v15
v_mfma_f32_16x16x32_bf16 v[252:255], a[220:223], a[236:239], v[252:255]
s_nop 0
s_cbranch_vccnz L_X_t31
L_Xr_t31:
ds_read_b64_tr_b16 a[142:143], v12 offset:14336
v_readfirstlane_b32 s86, v16
v_mfma_f32_16x16x32_bf16 v[96:99], a[160:163], v[48:51], v[96:99]
v_readfirstlane_b32 s87, v17
v_add_u32 v16, 1, v16
v_mfma_f32_16x16x32_bf16 v[116:119], a[164:167], v[48:51], v[116:119]
s_or_b32 s86, s86, 7
ds_write_b32 v22, a240 offset:0
v_mfma_f32_16x16x32_bf16 v[100:103], a[160:163], v[52:55], v[100:103]
v_cvt_pk_bf16_f32 v96, v96, v97
v_cvt_pk_bf16_f32 v97, v98, v99
v_mfma_f32_16x16x32_bf16 v[120:123], a[164:167], v[52:55], v[120:123]
s_waitcnt lgkmcnt(3)
s_waitcnt vmcnt(0)
s_waitcnt lgkmcnt(1)
s_barrier
v_mfma_f32_16x16x32_bf16 v[104:107], a[160:163], v[56:59], v[104:107]
s_add_u32 m0, s33, 0
ds_read_b64_tr_b16 a[192:193], v9 offset:32768
v_cvt_pk_bf16_f32 v98, v116, v117
v_cvt_pk_bf16_f32 v99, v118, v119
v_mfma_f32_16x16x32_bf16 v[124:127], a[164:167], v[56:59], v[124:127]
s_mov_b32 s38, 256
ds_read_b64_tr_b16 a[194:195], v9 offset:34816
v_readfirstlane_b32 s37, v18
v_mfma_f32_16x16x32_bf16 v[108:111], a[160:163], v[60:63], v[108:111]
s_nop 0
s_and_b32 s37, s37, 15
ds_write_b32 v22, a244 offset:256
ds_write_b32 v22, a248 offset:512
ds_write_b128 v20, v[96:99] offset:0
v_mfma_f32_16x16x32_bf16 v[128:131], a[164:167], v[60:63], v[128:131]
ds_read_b64_tr_b16 a[196:197], v10 offset:32768
v_cvt_pk_bf16_f32 v100, v100, v101
v_cvt_pk_bf16_f32 v101, v102, v103
v_cvt_pk_bf16_f32 v102, v120, v121
v_cvt_pk_bf16_f32 v103, v122, v123
v_mfma_f32_16x16x32_bf16 v[112:115], a[160:163], v[64:67], v[112:115]
buffer_load_dwordx4 v88, s[24:27], s38 offen offset:0  lds
v_mfma_f32_16x16x32_bf16 v[132:135], a[164:167], v[64:67], v[132:135]
s_mov_b32 s34, s37
ds_read_b64_tr_b16 a[198:199], v10 offset:34816
ds_write_b128 v20, v[100:103] offset:1024
v_mfma_f32_16x16x32_bf16 v[136:139], a[168:171], v[48:51], v[136:139]
s_mov_b32 s38, 6400
v_cvt_pk_bf16_f32 v104, v104, v105
v_cvt_pk_bf16_f32 v105, v106, v107
v_cvt_pk_bf16_f32 v106, v124, v125
v_cvt_pk_bf16_f32 v107, v126, v127
v_mfma_f32_16x16x32_bf16 v[156:159], a[172:175], v[48:51], v[156:159]
s_lshr_b32 s42, s86, s32
ds_read_b64_tr_b16 a[200:201], v9 offset:36864
v_cvt_pk_bf16_f32 v108, v108, v109
v_mfma_f32_16x16x32_bf16 v[140:143], a[168:171], v[52:55], v[140:143]
s_and_b32 s42, s42, 8
ds_write_b128 v20, v[104:107] offset:2048
buffer_load_dwordx4 v88, s[24:27], s38 offen offset:1024  lds
v_mfma_f32_16x16x32_bf16 v[160:163], a[172:175], v[52:55], v[160:163]
s_mov_b32 s38, 12544
ds_read_b64_tr_b16 a[202:203], v9 offset:38912
v_cvt_pk_bf16_f32 v109, v110, v111
v_cvt_pk_bf16_f32 v110, v128, v129
v_cvt_pk_bf16_f32 v111, v130, v131
v_mfma_f32_16x16x32_bf16 v[144:147], a[168:171], v[56:59], v[144:147]
s_lshl_b32 s42, s42, 10
v_cvt_pk_bf16_f32 v112, v112, v113
v_cvt_pk_bf16_f32 v113, v114, v115
v_mfma_f32_16x16x32_bf16 v[164:167], a[172:175], v[56:59], v[164:167]
s_add_u32 s3, s42, 1179648
ds_read_b64_tr_b16 a[204:205], v10 offset:36864
ds_write_b128 v20, v[108:111] offset:3072
v_mfma_f32_16x16x32_bf16 v[148:151], a[168:171], v[60:63], v[148:151]
buffer_load_dwordx4 v88, s[24:27], s38 offen offset:2048  lds
v_cvt_pk_bf16_f32 v114, v132, v133
v_cvt_pk_bf16_f32 v115, v134, v135
v_mfma_f32_16x16x32_bf16 v[168:171], a[172:175], v[60:63], v[168:171]
s_mov_b32 s38, 18688
ds_read_b64_tr_b16 a[206:207], v10 offset:38912
v_cvt_pk_bf16_f32 v136, v136, v137
v_mfma_f32_16x16x32_bf16 v[152:155], a[168:171], v[64:67], v[152:155]
ds_read_b64_tr_b16 a[208:209], v9 offset:40960
ds_write_b128 v20, v[112:115] offset:4096
v_mfma_f32_16x16x32_bf16 v[172:175], a[172:175], v[64:67], v[172:175]
v_cvt_pk_bf16_f32 v137, v138, v139
v_cvt_pk_bf16_f32 v138, v156, v157
v_cvt_pk_bf16_f32 v139, v158, v159
v_mfma_f32_16x16x32_bf16 v[176:179], a[176:179], v[48:51], v[176:179]
ds_read_b64_tr_b16 a[210:211], v9 offset:43008
buffer_load_dwordx4 v88, s[24:27], s38 offen offset:3072  lds
v_mfma_f32_16x16x32_bf16 v[196:199], a[180:183], v[48:51], v[196:199]
s_add_u32 m0, s33, 16384
ds_write_b128 v20, v[136:139] offset:5120
v_mfma_f32_16x16x32_bf16 v[180:183], a[176:179], v[52:55], v[180:183]
ds_read_b64_tr_b16 a[212:213], v10 offset:40960
v_cvt_pk_bf16_f32 v140, v140, v141
v_cvt_pk_bf16_f32 v141, v142, v143
v_cvt_pk_bf16_f32 v142, v160, v161
v_cvt_pk_bf16_f32 v143, v162, v163
v_mfma_f32_16x16x32_bf16 v[200:203], a[180:183], v[52:55], v[200:203]
s_mov_b32 s38, 114944
v_cvt_pk_bf16_f32 v144, v144, v145
v_cvt_pk_bf16_f32 v145, v146, v147
v_mfma_f32_16x16x32_bf16 v[184:187], a[176:179], v[56:59], v[184:187]
ds_read_b64_tr_b16 a[214:215], v10 offset:43008
ds_write_b128 v20, v[140:143] offset:6144
buffer_load_dwordx4 v88, s[24:27], s38 offen offset:0  lds
v_mfma_f32_16x16x32_bf16 v[204:207], a[180:183], v[56:59], v[204:207]
s_mov_b32 s38, 121088
v_cvt_pk_bf16_f32 v146, v164, v165
v_cvt_pk_bf16_f32 v147, v166, v167
v_mfma_f32_16x16x32_bf16 v[188:191], a[176:179], v[60:63], v[188:191]
ds_read_b64_tr_b16 a[216:217], v9 offset:45056
v_cvt_pk_bf16_f32 v148, v148, v149
v_mfma_f32_16x16x32_bf16 v[208:211], a[180:183], v[60:63], v[208:211]
ds_write_b128 v20, v[144:147] offset:7168
v_mfma_f32_16x16x32_bf16 v[192:195], a[176:179], v[64:67], v[192:195]
ds_read_b64_tr_b16 a[218:219], v9 offset:47104
buffer_load_dwordx4 v88, s[24:27], s38 offen offset:1024  lds
v_cvt_pk_bf16_f32 v149, v150, v151
v_cvt_pk_bf16_f32 v150, v168, v169
v_cvt_pk_bf16_f32 v151, v170, v171
v_mfma_f32_16x16x32_bf16 v[212:215], a[180:183], v[64:67], v[212:215]
s_mov_b32 s38, 127232
v_cvt_pk_bf16_f32 v152, v152, v153
v_cvt_pk_bf16_f32 v153, v154, v155
v_mfma_f32_16x16x32_bf16 v[216:219], a[184:187], v[48:51], v[216:219]
ds_read_b64_tr_b16 a[220:221], v10 offset:45056
ds_write_b128 v20, v[148:151] offset:8192
v_mfma_f32_16x16x32_bf16 v[236:239], a[188:191], v[48:51], v[236:239]
v_cvt_pk_bf16_f32 v154, v172, v173
v_cvt_pk_bf16_f32 v155, v174, v175
v_mfma_f32_16x16x32_bf16 v[220:223], a[184:187], v[52:55], v[220:223]
ds_read_b64_tr_b16 a[222:223], v10 offset:47104
buffer_load_dwordx4 v88, s[24:27], s38 offen offset:2048  lds
v_mfma_f32_16x16x32_bf16 v[240:243], a[188:191], v[52:55], v[240:243]
s_mov_b32 s38, 133376
ds_read_b64_tr_b16 a[160:161], v11 offset:32768
ds_write_b128 v20, v[152:155] offset:9216
v_mfma_f32_16x16x32_bf16 v[224:227], a[184:187], v[56:59], v[224:227]
v_cvt_pk_bf16_f32 v176, v176, v177
v_cvt_pk_bf16_f32 v177, v178, v179
v_cvt_pk_bf16_f32 v178, v196, v197
v_cvt_pk_bf16_f32 v179, v198, v199
v_mfma_f32_16x16x32_bf16 v[244:247], a[188:191], v[56:59], v[244:247]
ds_read_b64_tr_b16 a[162:163], v11 offset:34816
v_cvt_pk_bf16_f32 v180, v180, v181
v_mfma_f32_16x16x32_bf16 v[228:231], a[184:187], v[60:63], v[228:231]
ds_write_b128 v20, v[176:179] offset:10240
buffer_load_dwordx4 v88, s[24:27], s38 offen offset:3072  lds
v_mfma_f32_16x16x32_bf16 v[248:251], a[188:191], v[60:63], v[248:251]
ds_read_b64_tr_b16 a[164:165], v12 offset:32768
v_cvt_pk_bf16_f32 v181, v182, v183
v_cvt_pk_bf16_f32 v182, v200, v201
v_cvt_pk_bf16_f32 v183, v202, v203
v_mfma_f32_16x16x32_bf16 v[232:235], a[184:187], v[64:67], v[232:235]
v_cvt_pk_bf16_f32 v184, v184, v185
v_cvt_pk_bf16_f32 v185, v186, v187
v_mfma_f32_16x16x32_bf16 v[252:255], a[188:191], v[64:67], v[252:255]
ds_read_b64_tr_b16 a[166:167], v12 offset:34816
ds_write_b128 v20, v[180:183] offset:11264
v_mfma_f32_16x16x32_bf16 v[116:119], a[80:83], v[96:99], 0
v_cvt_pk_bf16_f32 v186, v204, v205
v_cvt_pk_bf16_f32 v187, v206, v207
v_mfma_f32_16x16x32_bf16 v[120:123], a[80:83], v[100:103], 0
ds_read_b64_tr_b16 a[168:169], v11 offset:36864
v_cvt_pk_bf16_f32 v188, v188, v189
v_mfma_f32_16x16x32_bf16 v[124:127], a[80:83], v[104:107], 0
ds_write_b128 v20, v[184:187] offset:12288
v_mfma_f32_16x16x32_bf16 v[128:131], a[80:83], v[108:111], 0
ds_read_b64_tr_b16 a[170:171], v11 offset:38912
v_cvt_pk_bf16_f32 v189, v190, v191
v_cvt_pk_bf16_f32 v190, v208, v209
v_cvt_pk_bf16_f32 v191, v210, v211
v_mfma_f32_16x16x32_bf16 v[132:135], a[80:83], v[112:115], 0
v_cvt_pk_bf16_f32 v192, v192, v193
v_cvt_pk_bf16_f32 v193, v194, v195
v_mfma_f32_16x16x32_bf16 v[156:159], a[84:87], v[96:99], 0
ds_read_b64_tr_b16 a[172:173], v12 offset:36864
ds_write_b128 v20, v[188:191] offset:13312
v_mfma_f32_16x16x32_bf16 v[160:163], a[84:87], v[100:103], 0
v_cvt_pk_bf16_f32 v194, v212, v213
v_cvt_pk_bf16_f32 v195, v214, v215
v_mfma_f32_16x16x32_bf16 v[164:167], a[84:87], v[104:107], 0
ds_read_b64_tr_b16 a[174:175], v12 offset:38912
v_cvt_pk_bf16_f32 v216, v216, v217
v_mfma_f32_16x16x32_bf16 v[168:171], a[84:87], v[108:111], 0
ds_read_b64_tr_b16 a[176:177], v11 offset:40960
ds_write_b128 v20, v[192:195] offset:14336
v_mfma_f32_16x16x32_bf16 v[172:175], a[84:87], v[112:115], 0
v_cvt_pk_bf16_f32 v217, v218, v219
v_cvt_pk_bf16_f32 v218, v236, v237
v_cvt_pk_bf16_f32 v219, v238, v239
v_mfma_f32_16x16x32_bf16 v[116:119], a[88:91], v[136:139], v[116:119]
ds_read_b64_tr_b16 a[178:179], v11 offset:43008
v_cvt_pk_bf16_f32 v220, v220, v221
v_mfma_f32_16x16x32_bf16 v[120:123], a[88:91], v[140:143], v[120:123]
ds_write_b128 v20, v[216:219] offset:15360
v_mfma_f32_16x16x32_bf16 v[124:127], a[88:91], v[144:147], v[124:127]
ds_read_b64_tr_b16 a[180:181], v12 offset:40960
v_cvt_pk_bf16_f32 v221, v222, v223
v_cvt_pk_bf16_f32 v222, v240, v241
v_cvt_pk_bf16_f32 v223, v242, v243
v_mfma_f32_16x16x32_bf16 v[128:131], a[88:91], v[148:151], v[128:131]
v_cvt_pk_bf16_f32 v224, v224, v225
v_cvt_pk_bf16_f32 v225, v226, v227
v_mfma_f32_16x16x32_bf16 v[132:135], a[88:91], v[152:155], v[132:135]
ds_read_b64_tr_b16 a[182:183], v12 offset:43008
ds_write_b128 v20, v[220:223] offset:16384
v_mfma_f32_16x16x32_bf16 v[156:159], a[92:95], v[136:139], v[156:159]
v_cvt_pk_bf16_f32 v226, v244, v245
v_cvt_pk_bf16_f32 v227, v246, v247
v_mfma_f32_16x16x32_bf16 v[160:163], a[92:95], v[140:143], v[160:163]
ds_read_b64_tr_b16 a[184:185], v11 offset:45056
v_cvt_pk_bf16_f32 v228, v228, v229
v_mfma_f32_16x16x32_bf16 v[164:167], a[92:95], v[144:147], v[164:167]
ds_write_b128 v20, v[224:227] offset:17408
v_mfma_f32_16x16x32_bf16 v[168:171], a[92:95], v[148:151], v[168:171]
ds_read_b64_tr_b16 a[186:187], v11 offset:47104
v_cvt_pk_bf16_f32 v229, v230, v231
v_cvt_pk_bf16_f32 v230, v248, v249
v_cvt_pk_bf16_f32 v231, v250, v251
v_mfma_f32_16x16x32_bf16 v[172:175], a[92:95], v[152:155], v[172:175]
v_cvt_pk_bf16_f32 v232, v232, v233
v_cvt_pk_bf16_f32 v233, v234, v235
v_mfma_f32_16x16x32_bf16 v[116:119], a[96:99], v[176:179], v[116:119]
ds_read_b64_tr_b16 a[188:189], v12 offset:45056
ds_write_b128 v20, v[228:231] offset:18432
v_mfma_f32_16x16x32_bf16 v[120:123], a[96:99], v[180:183], v[120:123]
v_cvt_pk_bf16_f32 v234, v252, v253
v_cvt_pk_bf16_f32 v235, v254, v255
v_mfma_f32_16x16x32_bf16 v[124:127], a[96:99], v[184:187], v[124:127]
s_add_u32 s12, s72, s3
s_addc_u32 s13, s73, 0
ds_read_b64_tr_b16 a[190:191], v12 offset:47104
v_mfma_f32_16x16x32_bf16 v[128:131], a[96:99], v[188:191], v[128:131]
s_mov_b32 s14, 4224
ds_write_b128 v20, v[232:235] offset:19456
v_mfma_f32_16x16x32_bf16 v[132:135], a[96:99], v[192:195], v[132:135]
s_mov_b32 s15, 0x20000
s_sub_u32 s94, s86, 3
s_mov_b32 s95, s87
v_mfma_f32_16x16x32_bf16 v[156:159], a[100:103], v[176:179], v[156:159]
v_and_b32 v18, 768, v89
v_lshrrev_b32 v19, 1, v89
v_mfma_f32_16x16x32_bf16 v[160:163], a[100:103], v[180:183], v[160:163]
v_lshl_or_b32 v19, v18, 8, v19
v_lshlrev_b32 v18, 12, v89
v_mfma_f32_16x16x32_bf16 v[164:167], a[100:103], v[184:187], v[164:167]
s_and_b32 s101, s34, 7
s_lshl_b32 s101, s101, 3
v_mfma_f32_16x16x32_bf16 v[168:171], a[100:103], v[188:191], v[168:171]
s_mov_b32 s91, 0
v_mfma_f32_16x16x32_bf16 v[172:175], a[100:103], v[192:195], v[172:175]
s_waitcnt lgkmcnt(0)
s_barrier
s_add_u32 m0, s33, 32768
v_mfma_f32_16x16x32_bf16 v[116:119], a[104:107], v[216:219], v[116:119]
s_mov_b32 s38, 384
ds_read_b128 a[0:3], v21 offset:0
v_mfma_f32_16x16x32_bf16 v[120:123], a[104:107], v[220:223], v[120:123]
buffer_load_dwordx4 v88, s[24:27], s38 offen offset:0  lds
v_mfma_f32_16x16x32_bf16 v[124:127], a[104:107], v[224:227], v[124:127]
s_mov_b32 s75, 0
ds_read_b128 a[4:7], v21 offset:1024
v_mfma_f32_16x16x32_bf16 v[128:131], a[104:107], v[228:231], v[128:131]
s_mov_b32 s38, 6528
ds_read_b128 a[8:11], v21 offset:2048
v_mfma_f32_16x16x32_bf16 v[132:135], a[104:107], v[232:235], v[132:135]
buffer_load_dwordx4 v88, s[24:27], s38 offen offset:1024  lds
v_mfma_f32_16x16x32_bf16 v[156:159], a[108:111], v[216:219], v[156:159]
ds_read_b128 a[12:15], v21 offset:3072
v_mfma_f32_16x16x32_bf16 v[160:163], a[108:111], v[220:223], v[160:163]
s_mov_b32 s92, 185339150
ds_read_b128 a[16:19], v21 offset:4096
v_mfma_f32_16x16x32_bf16 v[164:167], a[108:111], v[224:227], v[164:167]
s_mov_b32 s38, 12672
ds_read_b128 a[20:23], v21 offset:5120
v_mfma_f32_16x16x32_bf16 v[168:171], a[108:111], v[228:231], v[168:171]
buffer_load_dwordx4 v88, s[24:27], s38 offen offset:2048  lds
v_mfma_f32_16x16x32_bf16 v[172:175], a[108:111], v[232:235], v[172:175]
ds_read_b128 a[24:27], v21 offset:6144
v_mfma_f32_16x16x32_bf16 v[196:199], a[192:195], v[96:99], 0
ds_read_b128 a[28:31], v21 offset:7168
v_mfma_f32_16x16x32_bf16 v[200:203], a[192:195], v[100:103], 0
s_mov_b32 s38, 18816
ds_read_b128 a[32:35], v21 offset:8192
s_mov_b32 s93, 117967114
v_mfma_f32_16x16x32_bf16 v[204:207], a[192:195], v[104:107], 0
buffer_load_dwordx4 v88, s[24:27], s38 offen offset:3072  lds
v_mfma_f32_16x16x32_bf16 v[208:211], a[192:195], v[108:111], 0
ds_read_b128 a[36:39], v21 offset:9216
v_mfma_f32_16x16x32_bf16 v[212:215], a[192:195], v[112:115], 0
ds_read_b128 a[40:43], v21 offset:10240
v_mfma_f32_16x16x32_bf16 v[236:239], a[196:199], v[96:99], 0
s_add_u32 m0, s33, 49152
ds_read_b128 a[44:47], v21 offset:11264
s_mov_b32 s38, 115072
v_mfma_f32_16x16x32_bf16 v[240:243], a[196:199], v[100:103], 0
ds_read_b128 a[48:51], v21 offset:12288
v_mfma_f32_16x16x32_bf16 v[244:247], a[196:199], v[104:107], 0
ds_read_b128 a[52:55], v21 offset:13312
v_mfma_f32_16x16x32_bf16 v[248:251], a[196:199], v[108:111], 0
ds_read_b128 a[56:59], v21 offset:14336
v_mfma_f32_16x16x32_bf16 v[252:255], a[196:199], v[112:115], 0
ds_read_b128 a[60:63], v21 offset:15360
v_mfma_f32_16x16x32_bf16 v[196:199], a[200:203], v[136:139], v[196:199]
ds_read_b128 a[64:67], v21 offset:16384
ds_read_b128 a[68:71], v21 offset:17408
ds_read_b128 a[72:75], v21 offset:18432
ds_read_b128 a[76:79], v21 offset:19456
ds_read2st64_b32 v[28:29], v23 offset0:0 offset1:6
ds_read2st64_b32 v[30:31], v23 offset0:3 offset1:9
ds_read2st64_b32 v[32:33], v23 offset0:1 offset1:7
ds_read2st64_b32 v[34:35], v23 offset0:4 offset1:10
ds_read2st64_b32 v[36:37], v23 offset0:2 offset1:8
buffer_load_dwordx4 v88, s[24:27], s38 offen offset:0  lds
v_mfma_f32_16x16x32_bf16 v[200:203], a[200:203], v[140:143], v[200:203]
s_mov_b32 s38, 121216
v_mfma_f32_16x16x32_bf16 v[204:207], a[200:203], v[144:147], v[204:207]
buffer_load_dwordx4 v88, s[24:27], s38 offen offset:1024  lds
v_mfma_f32_16x16x32_bf16 v[208:211], a[200:203], v[148:151], v[208:211]
s_mov_b32 s38, 127360
v_mfma_f32_16x16x32_bf16 v[212:215], a[200:203], v[152:155], v[212:215]
buffer_load_dwordx4 v88, s[24:27], s38 offen offset:2048  lds
v_mfma_f32_16x16x32_bf16 v[236:239], a[204:207], v[136:139], v[236:239]
s_bitcmp1_b32 s34, 3
s_cmov_b32 s92, 50595078
s_cmov_b32 s93, 1073742082
v_mfma_f32_16x16x32_bf16 v[240:243], a[204:207], v[140:143], v[240:243]
s_lshr_b64 s[92:93], s[92:93], s101
s_and_b32 s41, s92, 127
v_mfma_f32_16x16x32_bf16 v[244:247], a[204:207], v[144:147], v[244:247]
s_mov_b32 s38, 133504
v_mfma_f32_16x16x32_bf16 v[248:251], a[204:207], v[148:151], v[248:251]
buffer_load_dwordx4 v88, s[24:27], s38 offen offset:3072  lds
v_mfma_f32_16x16x32_bf16 v[252:255], a[204:207], v[152:155], v[252:255]
s_waitcnt lgkmcnt(0)
v_add_f32 v90, v28, v29
v_mfma_f32_16x16x32_bf16 v[196:199], a[208:211], v[176:179], v[196:199]
v_add_f32 v91, v30, v31
v_add_f32 v92, v32, v33
v_mfma_f32_16x16x32_bf16 v[200:203], a[208:211], v[180:183], v[200:203]
v_add_f32 v93, v34, v35
v_add_f32 v94, v36, v37
v_mfma_f32_16x16x32_bf16 v[204:207], a[208:211], v[184:187], v[204:207]
v_rcp_f32 v90, v90
v_mfma_f32_16x16x32_bf16 v[208:211], a[208:211], v[188:191], v[208:211]
v_rcp_f32 v91, v91
v_mfma_f32_16x16x32_bf16 v[212:215], a[208:211], v[192:195], v[212:215]
s_waitcnt vmcnt(8)
s_barrier
s_add_u32 m0, s33, 65536
v_mfma_f32_16x16x32_bf16 v[236:239], a[212:215], v[176:179], v[236:239]
s_mov_b32 s38, 512
v_rcp_f32 v92, v92
v_mfma_f32_16x16x32_bf16 v[240:243], a[212:215], v[180:183], v[240:243]
buffer_load_dwordx4 v88, s[24:27], s38 offen offset:0  lds
v_mfma_f32_16x16x32_bf16 v[244:247], a[212:215], v[184:187], v[244:247]
s_mov_b32 s38, 6656
v_rcp_f32 v93, v93
v_mfma_f32_16x16x32_bf16 v[248:251], a[212:215], v[188:191], v[248:251]
buffer_load_dwordx4 v88, s[24:27], s38 offen offset:1024  lds
v_mfma_f32_16x16x32_bf16 v[252:255], a[212:215], v[192:195], v[252:255]
v_rcp_f32 v94, v94
v_mfma_f32_16x16x32_bf16 v[196:199], a[216:219], v[216:219], v[196:199]
s_mov_b32 s38, 12800
v_add_u32 v21, 4096, v89
v_add_u32 v22, 16384, v89
v_mfma_f32_16x16x32_bf16 v[200:203], a[216:219], v[220:223], v[200:203]
buffer_load_dwordx4 v88, s[24:27], s38 offen offset:2048  lds
v_mfma_f32_16x16x32_bf16 v[204:207], a[216:219], v[224:227], v[204:207]
ds_read_b64_tr_b16 a[192:193], v9 offset:0
v_add_u32 v23, 20480, v89
v_mfma_f32_16x16x32_bf16 v[208:211], a[216:219], v[228:231], v[208:211]
s_mov_b32 s38, 18944
ds_read_b64_tr_b16 a[194:195], v9 offset:2048
v_mfma_f32_16x16x32_bf16 v[212:215], a[216:219], v[232:235], v[212:215]
buffer_load_dwordx4 v88, s[24:27], s38 offen offset:3072  lds
v_mfma_f32_16x16x32_bf16 v[236:239], a[220:223], v[216:219], v[236:239]
ds_read_b64_tr_b16 a[196:197], v10 offset:0
v_mfma_f32_16x16x32_bf16 v[240:243], a[220:223], v[220:223], v[240:243]
s_add_u32 m0, s33, 81920
s_mov_b32 s38, 115200
ds_read_b64_tr_b16 a[198:199], v10 offset:2048
v_mfma_f32_16x16x32_bf16 v[244:247], a[220:223], v[224:227], v[244:247]
buffer_load_dwordx4 v88, s[24:27], s38 offen offset:0  lds
v_mfma_f32_16x16x32_bf16 v[248:251], a[220:223], v[228:231], v[248:251]
ds_read_b64_tr_b16 a[200:201], v9 offset:4096
v_mfma_f32_16x16x32_bf16 v[252:255], a[220:223], v[232:235], v[252:255]
s_mov_b32 s38, 121344
ds_read_b64_tr_b16 a[202:203], v9 offset:6144
v_mfma_f32_16x16x32_bf16 v[116:119], a[112:115], a[0:3], v[116:119]
buffer_load_dwordx4 v88, s[24:27], s38 offen offset:1024  lds
v_mfma_f32_16x16x32_bf16 v[120:123], a[112:115], a[4:7], v[120:123]
ds_read_b64_tr_b16 a[204:205], v10 offset:4096
v_mfma_f32_16x16x32_bf16 v[124:127], a[112:115], a[8:11], v[124:127]
s_mov_b32 s38, 127488
ds_read_b64_tr_b16 a[206:207], v10 offset:6144
v_mfma_f32_16x16x32_bf16 v[128:131], a[112:115], a[12:15], v[128:131]
buffer_load_dwordx4 v88, s[24:27], s38 offen offset:2048  lds
v_mfma_f32_16x16x32_bf16 v[132:135], a[112:115], a[16:19], v[132:135]
ds_read_b64_tr_b16 a[208:209], v9 offset:8192
v_mfma_f32_16x16x32_bf16 v[156:159], a[116:119], a[0:3], v[156:159]
s_mov_b32 s38, 133632
ds_read_b64_tr_b16 a[210:211], v9 offset:10240
v_mfma_f32_16x16x32_bf16 v[160:163], a[116:119], a[4:7], v[160:163]
buffer_load_dwordx4 v88, s[24:27], s38 offen offset:3072  lds
v_mfma_f32_16x16x32_bf16 v[164:167], a[116:119], a[8:11], v[164:167]
s_cmp_lt_u32 s41, 35
s_cselect_b32 s88, 0, 0xffff
s_cselect_b32 s100, 0, 1
s_cselect_b32 s41, s41, 0
v_mfma_f32_16x16x32_bf16 v[168:171], a[116:119], a[12:15], v[168:171]
s_add_u32 m0, s33, 98304
s_mov_b32 s38, 640
s_or_b32 s91, s91, s100
v_mfma_f32_16x16x32_bf16 v[172:175], a[116:119], a[16:19], v[172:175]
buffer_load_dwordx4 v88, s[24:27], s38 offen offset:0  lds
v_mfma_f32_16x16x32_bf16 v[116:119], a[120:123], a[20:23], v[116:119]
s_cmp_ge_u32 s41, 35
s_cselect_b32 s100, 1, 0
s_or_b32 s75, s75, s100
v_mfma_f32_16x16x32_bf16 v[120:123], a[120:123], a[24:27], v[120:123]
s_mov_b32 s38, 6784
s_mul_i32 s3, s41, 52
s_lshr_b32 s3, s3, 8
v_mfma_f32_16x16x32_bf16 v[124:127], a[120:123], a[28:31], v[124:127]
buffer_load_dwordx4 v88, s[24:27], s38 offen offset:1024  lds
v_mfma_f32_16x16x32_bf16 v[128:131], a[120:123], a[32:35], v[128:131]
s_mul_i32 s67, s3, 5
s_sub_u32 s41, s41, s67
ds_read_b64_tr_b16 a[212:213], v10 offset:8192
v_mfma_f32_16x16x32_bf16 v[132:135], a[120:123], a[36:39], v[132:135]
s_mov_b32 s38, 12928
ds_read_b64_tr_b16 a[214:215], v10 offset:10240
v_mfma_f32_16x16x32_bf16 v[156:159], a[124:127], a[20:23], v[156:159]
buffer_load_dwordx4 v88, s[24:27], s38 offen offset:2048  lds
v_mfma_f32_16x16x32_bf16 v[160:163], a[124:127], a[24:27], v[160:163]
s_sub_u32 s80, s3, 6
ds_read_b64_tr_b16 a[216:217], v9 offset:12288
v_mfma_f32_16x16x32_bf16 v[164:167], a[124:127], a[28:31], v[164:167]
s_mov_b32 s38, 19072
ds_read_b64_tr_b16 a[218:219], v9 offset:14336
v_mfma_f32_16x16x32_bf16 v[168:171], a[124:127], a[32:35], v[168:171]
buffer_load_dwordx4 v88, s[24:27], s38 offen offset:3072  lds
v_mfma_f32_16x16x32_bf16 v[172:175], a[124:127], a[36:39], v[172:175]
ds_read_b64_tr_b16 a[220:221], v10 offset:12288
v_mfma_f32_16x16x32_bf16 v[116:119], a[128:131], a[40:43], v[116:119]
s_add_u32 m0, s33, 114688
s_mov_b32 s38, 115328
s_mul_i32 s64, s41, 7
v_mfma_f32_16x16x32_bf16 v[120:123], a[128:131], a[44:47], v[120:123]
buffer_load_dwordx4 v88, s[24:27], s38 offen offset:0  lds
v_mfma_f32_16x16x32_bf16 v[124:127], a[128:131], a[48:51], v[124:127]
ds_read_b64_tr_b16 a[222:223], v10 offset:14336
v_mfma_f32_16x16x32_bf16 v[128:131], a[128:131], a[52:55], v[128:131]
s_mov_b32 s38, 121472
v_mfma_f32_16x16x32_bf16 v[132:135], a[128:131], a[56:59], v[132:135]
buffer_load_dwordx4 v88, s[24:27], s38 offen offset:1024  lds
v_mfma_f32_16x16x32_bf16 v[156:159], a[132:135], a[40:43], v[156:159]
s_add_u32 s64, s64, s3
v_mfma_f32_16x16x32_bf16 v[160:163], a[132:135], a[44:47], v[160:163]
s_mov_b32 s38, 127616
v_mfma_f32_16x16x32_bf16 v[164:167], a[132:135], a[48:51], v[164:167]
buffer_load_dwordx4 v88, s[24:27], s38 offen offset:2048  lds
v_mfma_f32_16x16x32_bf16 v[168:171], a[132:135], a[52:55], v[168:171]
v_mfma_f32_16x16x32_bf16 v[172:175], a[132:135], a[56:59], v[172:175]
s_mov_b32 s38, 133760
v_mfma_f32_16x16x32_bf16 v[116:119], a[136:139], a[60:63], v[116:119]
buffer_load_dwordx4 v88, s[24:27], s38 offen offset:3072  lds
v_mfma_f32_16x16x32_bf16 v[120:123], a[136:139], a[64:67], v[120:123]
s_mul_i32 s64, s64, 32768
v_mfma_f32_16x16x32_bf16 v[124:127], a[136:139], a[68:71], v[124:127]
s_add_u32 m0, s33, 131072
s_mov_b32 s38, 768
v_mfma_f32_16x16x32_bf16 v[128:131], a[136:139], a[72:75], v[128:131]
buffer_load_dwordx4 v88, s[24:27], s38 offen offset:0  lds
v_mfma_f32_16x16x32_bf16 v[132:135], a[136:139], a[76:79], v[132:135]
s_mul_i32 s67, s41, 28672
v_mfma_f32_16x16x32_bf16 v[156:159], a[140:143], a[60:63], v[156:159]
s_mov_b32 s38, 6912
v_mfma_f32_16x16x32_bf16 v[160:163], a[140:143], a[64:67], v[160:163]
buffer_load_dwordx4 v88, s[24:27], s38 offen offset:1024  lds
v_mfma_f32_16x16x32_bf16 v[164:167], a[140:143], a[68:71], v[164:167]
v_mfma_f32_16x16x32_bf16 v[168:171], a[140:143], a[72:75], v[168:171]
s_mov_b32 s38, 13056
v_mfma_f32_16x16x32_bf16 v[172:175], a[140:143], a[76:79], v[172:175]
buffer_load_dwordx4 v88, s[24:27], s38 offen offset:2048  lds
v_mfma_f32_16x16x32_bf16 v[196:199], a[160:163], a[0:3], v[196:199]
s_lshl_b32 s3, s3, 7
v_mfma_f32_16x16x32_bf16 v[200:203], a[160:163], a[4:7], v[200:203]
s_mov_b32 s38, 19200
v_mul_f32 v116, v116, v90
v_mul_f32 v117, v117, v90
v_mfma_f32_16x16x32_bf16 v[204:207], a[160:163], a[8:11], v[204:207]
v_mul_f32 v118, v118, v90
v_mul_f32 v119, v119, v90
v_mfma_f32_16x16x32_bf16 v[208:211], a[160:163], a[12:15], v[208:211]
v_cvt_pk_bf16_f32 v48, v116, v117
v_cvt_pk_bf16_f32 v49, v118, v119
v_mfma_f32_16x16x32_bf16 v[212:215], a[160:163], a[16:19], v[212:215]
s_add_u32 s67, s67, s3
v_mul_f32 v156, v156, v90
v_mul_f32 v157, v157, v90
v_mfma_f32_16x16x32_bf16 v[236:239], a[164:167], a[0:3], v[236:239]
buffer_load_dwordx4 v88, s[24:27], s38 offen offset:3072  lds
v_mfma_f32_16x16x32_bf16 v[240:243], a[164:167], a[4:7], v[240:243]
s_add_u32 m0, s33, 147456
v_mul_f32 v158, v158, v90
v_mul_f32 v159, v159, v90
v_mfma_f32_16x16x32_bf16 v[244:247], a[164:167], a[8:11], v[244:247]
s_mov_b32 s38, 115456
v_cvt_pk_bf16_f32 v50, v156, v157
v_cvt_pk_bf16_f32 v51, v158, v159
v_mfma_f32_16x16x32_bf16 v[248:251], a[164:167], a[12:15], v[248:251]
buffer_load_dwordx4 v88, s[24:27], s38 offen offset:0  lds
v_mfma_f32_16x16x32_bf16 v[252:255], a[164:167], a[16:19], v[252:255]
s_add_u32 s39, s42, 0
s_mov_b32 s38, 121600
s_mov_b32 s92, 320083222
v_mfma_f32_16x16x32_bf16 v[196:199], a[168:171], a[20:23], v[196:199]
buffer_store_dwordx4 v[48:51], v89, s[28:31], s39 offen sc1
v_mfma_f32_16x16x32_bf16 v[200:203], a[168:171], a[24:27], v[200:203]
buffer_load_dwordx4 v88, s[24:27], s38 offen offset:1024  lds
v_mul_f32 v120, v120, v91
v_mul_f32 v121, v121, v91
v_mfma_f32_16x16x32_bf16 v[204:207], a[168:171], a[28:31], v[204:207]
s_mov_b32 s38, 127744
v_mul_f32 v122, v122, v91
v_mul_f32 v123, v123, v91
v_mfma_f32_16x16x32_bf16 v[208:211], a[168:171], a[32:35], v[208:211]
s_mov_b32 s93, 252711186
v_cvt_pk_bf16_f32 v52, v120, v121
v_cvt_pk_bf16_f32 v53, v122, v123
v_mfma_f32_16x16x32_bf16 v[212:215], a[168:171], a[36:39], v[212:215]
buffer_load_dwordx4 v88, s[24:27], s38 offen offset:2048  lds
v_mul_f32 v160, v160, v91
v_mfma_f32_16x16x32_bf16 v[236:239], a[172:175], a[20:23], v[236:239]
s_mov_b32 s38, 133888
v_mul_f32 v161, v161, v91
v_mul_f32 v162, v162, v91
v_mfma_f32_16x16x32_bf16 v[240:243], a[172:175], a[24:27], v[240:243]
v_mul_f32 v163, v163, v91
v_cvt_pk_bf16_f32 v54, v160, v161
v_mfma_f32_16x16x32_bf16 v[244:247], a[172:175], a[28:31], v[244:247]
buffer_load_dwordx4 v88, s[24:27], s38 offen offset:3072  lds
v_mfma_f32_16x16x32_bf16 v[248:251], a[172:175], a[32:35], v[248:251]
v_cvt_pk_bf16_f32 v55, v162, v163
s_add_u32 s39, s42, 229376
v_mfma_f32_16x16x32_bf16 v[252:255], a[172:175], a[36:39], v[252:255]
buffer_store_dwordx4 v[52:55], v89, s[28:31], s39 offen sc1
v_mfma_f32_16x16x32_bf16 v[196:199], a[176:179], a[40:43], v[196:199]
v_mul_f32 v124, v124, v92
v_mul_f32 v125, v125, v92
v_mfma_f32_16x16x32_bf16 v[200:203], a[176:179], a[44:47], v[200:203]
v_mul_f32 v126, v126, v92
v_mul_f32 v127, v127, v92
v_mfma_f32_16x16x32_bf16 v[204:207], a[176:179], a[48:51], v[204:207]
v_cvt_pk_bf16_f32 v56, v124, v125
v_cvt_pk_bf16_f32 v57, v126, v127
v_mfma_f32_16x16x32_bf16 v[208:211], a[176:179], a[52:55], v[208:211]
v_mul_f32 v164, v164, v92
v_mul_f32 v165, v165, v92
v_mfma_f32_16x16x32_bf16 v[212:215], a[176:179], a[56:59], v[212:215]
v_mul_f32 v166, v166, v92
v_mul_f32 v167, v167, v92
v_mfma_f32_16x16x32_bf16 v[236:239], a[180:183], a[40:43], v[236:239]
v_cvt_pk_bf16_f32 v58, v164, v165
v_cvt_pk_bf16_f32 v59, v166, v167
v_mfma_f32_16x16x32_bf16 v[240:243], a[180:183], a[44:47], v[240:243]
s_add_u32 s39, s42, 458752
ds_read_b64_tr_b16 a[160:161], v11 offset:0
v_mfma_f32_16x16x32_bf16 v[244:247], a[180:183], a[48:51], v[244:247]
buffer_store_dwordx4 v[56:59], v89, s[28:31], s39 offen sc1
v_mfma_f32_16x16x32_bf16 v[248:251], a[180:183], a[52:55], v[248:251]
v_mul_f32 v128, v128, v93
v_mul_f32 v129, v129, v93
v_mfma_f32_16x16x32_bf16 v[252:255], a[180:183], a[56:59], v[252:255]
v_mul_f32 v130, v130, v93
v_mul_f32 v131, v131, v93
v_mfma_f32_16x16x32_bf16 v[196:199], a[184:187], a[60:63], v[196:199]
v_cvt_pk_bf16_f32 v60, v128, v129
v_cvt_pk_bf16_f32 v61, v130, v131
v_mfma_f32_16x16x32_bf16 v[200:203], a[184:187], a[64:67], v[200:203]
v_mul_f32 v168, v168, v93
v_mul_f32 v169, v169, v93
v_mfma_f32_16x16x32_bf16 v[204:207], a[184:187], a[68:71], v[204:207]
v_mul_f32 v170, v170, v93
v_mul_f32 v171, v171, v93
v_mfma_f32_16x16x32_bf16 v[208:211], a[184:187], a[72:75], v[208:211]
v_cvt_pk_bf16_f32 v62, v168, v169
v_cvt_pk_bf16_f32 v63, v170, v171
v_mfma_f32_16x16x32_bf16 v[212:215], a[184:187], a[76:79], v[212:215]
s_add_u32 s39, s42, 688128
ds_read_b64_tr_b16 a[162:163], v11 offset:2048
v_mfma_f32_16x16x32_bf16 v[236:239], a[188:191], a[60:63], v[236:239]
buffer_store_dwordx4 v[60:63], v89, s[28:31], s39 offen sc1
v_mfma_f32_16x16x32_bf16 v[240:243], a[188:191], a[64:67], v[240:243]
v_mul_f32 v132, v132, v94
v_mul_f32 v133, v133, v94
v_mfma_f32_16x16x32_bf16 v[244:247], a[188:191], a[68:71], v[244:247]
v_mul_f32 v134, v134, v94
v_mul_f32 v135, v135, v94
v_mfma_f32_16x16x32_bf16 v[248:251], a[188:191], a[72:75], v[248:251]
v_cvt_pk_bf16_f32 v64, v132, v133
v_cvt_pk_bf16_f32 v65, v134, v135
v_mfma_f32_16x16x32_bf16 v[252:255], a[188:191], a[76:79], v[252:255]
s_waitcnt lgkmcnt(14)
v_mul_f32 v172, v172, v94
v_mul_f32 v173, v173, v94
v_mul_f32 v174, v174, v94
v_mul_f32 v175, v175, v94
v_cvt_pk_bf16_f32 v66, v172, v173
v_cvt_pk_bf16_f32 v67, v174, v175
v_mfma_f32_16x16x32_bf16 v[116:119], a[192:195], v[96:99], 0
s_add_u32 s39, s42, 917504
ds_read_b64_tr_b16 a[164:165], v12 offset:0
v_mfma_f32_16x16x32_bf16 v[120:123], a[192:195], v[100:103], 0
buffer_store_dwordx4 v[64:67], v89, s[28:31], s39 offen sc1
v_mfma_f32_16x16x32_bf16 v[124:127], a[192:195], v[104:107], 0
v_mul_f32 v196, v196, v90
v_mul_f32 v197, v197, v90
v_mfma_f32_16x16x32_bf16 v[128:131], a[192:195], v[108:111], 0
v_mul_f32 v198, v198, v90
v_mul_f32 v199, v199, v90
v_mfma_f32_16x16x32_bf16 v[132:135], a[192:195], v[112:115], 0
v_cvt_pk_bf16_f32 v68, v196, v197
v_cvt_pk_bf16_f32 v69, v198, v199
v_mfma_f32_16x16x32_bf16 v[156:159], a[196:199], v[96:99], 0
v_mul_f32 v236, v236, v90
v_mul_f32 v237, v237, v90
v_mfma_f32_16x16x32_bf16 v[160:163], a[196:199], v[100:103], 0
v_mul_f32 v238, v238, v90
v_mul_f32 v239, v239, v90
v_mfma_f32_16x16x32_bf16 v[164:167], a[196:199], v[104:107], 0
s_bitcmp1_b32 s34, 3
s_cmov_b32 s92, 1077952576
s_cmov_b32 s93, 1077952576
v_mfma_f32_16x16x32_bf16 v[168:171], a[196:199], v[108:111], 0
s_lshr_b64 s[92:93], s[92:93], s101
v_cvt_pk_bf16_f32 v70, v236, v237
v_cvt_pk_bf16_f32 v71, v238, v239
v_mfma_f32_16x16x32_bf16 v[172:175], a[196:199], v[112:115], 0
s_waitcnt lgkmcnt(11)
s_add_u32 s39, s42, 32768
s_and_b32 s41, s92, 127
v_mfma_f32_16x16x32_bf16 v[116:119], a[200:203], v[136:139], v[116:119]
buffer_store_dwordx4 v[68:71], v89, s[28:31], s39 offen sc1
v_mfma_f32_16x16x32_bf16 v[120:123], a[200:203], v[140:143], v[120:123]
v_mul_f32 v200, v200, v91
v_mul_f32 v201, v201, v91
v_mfma_f32_16x16x32_bf16 v[124:127], a[200:203], v[144:147], v[124:127]
v_mul_f32 v202, v202, v91
v_mul_f32 v203, v203, v91
v_mfma_f32_16x16x32_bf16 v[128:131], a[200:203], v[148:151], v[128:131]
v_cvt_pk_bf16_f32 v72, v200, v201
v_cvt_pk_bf16_f32 v73, v202, v203
v_mfma_f32_16x16x32_bf16 v[132:135], a[200:203], v[152:155], v[132:135]
v_mul_f32 v240, v240, v91
v_mul_f32 v241, v241, v91
v_mfma_f32_16x16x32_bf16 v[156:159], a[204:207], v[136:139], v[156:159]
v_mul_f32 v242, v242, v91
v_mul_f32 v243, v243, v91
v_mfma_f32_16x16x32_bf16 v[160:163], a[204:207], v[140:143], v[160:163]
v_cvt_pk_bf16_f32 v74, v240, v241
v_cvt_pk_bf16_f32 v75, v242, v243
v_mfma_f32_16x16x32_bf16 v[164:167], a[204:207], v[144:147], v[164:167]
s_add_u32 s39, s42, 262144
ds_read_b64_tr_b16 a[166:167], v12 offset:2048
v_mfma_f32_16x16x32_bf16 v[168:171], a[204:207], v[148:151], v[168:171]
buffer_store_dwordx4 v[72:75], v89, s[28:31], s39 offen sc1
v_mfma_f32_16x16x32_bf16 v[172:175], a[204:207], v[152:155], v[172:175]
s_waitcnt lgkmcnt(8)
v_mul_f32 v204, v204, v92
v_mul_f32 v205, v205, v92
v_mfma_f32_16x16x32_bf16 v[116:119], a[208:211], v[176:179], v[116:119]
v_mul_f32 v206, v206, v92
v_mul_f32 v207, v207, v92
v_mfma_f32_16x16x32_bf16 v[120:123], a[208:211], v[180:183], v[120:123]
s_cmp_lt_u32 s41, 35
s_cselect_b32 s89, 0, 0xffff
s_cselect_b32 s100, 0, 2
s_cselect_b32 s41, s41, 0
v_mfma_f32_16x16x32_bf16 v[124:127], a[208:211], v[184:187], v[124:127]
s_or_b32 s91, s91, s100
v_cvt_pk_bf16_f32 v76, v204, v205
v_cvt_pk_bf16_f32 v77, v206, v207
v_mfma_f32_16x16x32_bf16 v[128:131], a[208:211], v[188:191], v[128:131]
v_mul_f32 v244, v244, v92
v_mul_f32 v245, v245, v92
v_mfma_f32_16x16x32_bf16 v[132:135], a[208:211], v[192:195], v[132:135]
v_mul_f32 v246, v246, v92
v_mul_f32 v247, v247, v92
v_mfma_f32_16x16x32_bf16 v[156:159], a[212:215], v[176:179], v[156:159]
v_cvt_pk_bf16_f32 v78, v244, v245
v_cvt_pk_bf16_f32 v79, v246, v247
v_mfma_f32_16x16x32_bf16 v[160:163], a[212:215], v[180:183], v[160:163]
s_add_u32 s39, s42, 491520
s_cmp_ge_u32 s41, 35
s_cselect_b32 s100, 2, 0
v_mfma_f32_16x16x32_bf16 v[164:167], a[212:215], v[184:187], v[164:167]
buffer_store_dwordx4 v[76:79], v89, s[28:31], s39 offen sc1
v_mfma_f32_16x16x32_bf16 v[168:171], a[212:215], v[188:191], v[168:171]
s_or_b32 s75, s75, s100
v_mul_f32 v208, v208, v93
v_mul_f32 v209, v209, v93
v_mfma_f32_16x16x32_bf16 v[172:175], a[212:215], v[192:195], v[172:175]
s_waitcnt lgkmcnt(4)
v_mul_f32 v210, v210, v93
v_mul_f32 v211, v211, v93
v_mfma_f32_16x16x32_bf16 v[116:119], a[216:219], v[216:219], v[116:119]
s_mul_i32 s3, s41, 52
v_cvt_pk_bf16_f32 v40, v208, v209
v_cvt_pk_bf16_f32 v41, v210, v211
v_mfma_f32_16x16x32_bf16 v[120:123], a[216:219], v[220:223], v[120:123]
s_lshr_b32 s3, s3, 8
v_mul_f32 v248, v248, v93
v_mul_f32 v249, v249, v93
v_mfma_f32_16x16x32_bf16 v[124:127], a[216:219], v[224:227], v[124:127]
s_mul_i32 s68, s3, 5
ds_read_b64_tr_b16 a[168:169], v11 offset:4096
v_mul_f32 v250, v250, v93
v_mfma_f32_16x16x32_bf16 v[128:131], a[216:219], v[228:231], v[128:131]
s_sub_u32 s41, s41, s68
ds_read_b64_tr_b16 a[170:171], v11 offset:6144
v_mul_f32 v251, v251, v93
v_mfma_f32_16x16x32_bf16 v[132:135], a[216:219], v[232:235], v[132:135]
s_sub_u32 s82, s3, 6
v_cvt_pk_bf16_f32 v42, v248, v249
v_cvt_pk_bf16_f32 v43, v250, v251
v_mfma_f32_16x16x32_bf16 v[156:159], a[220:223], v[216:219], v[156:159]
s_add_u32 s39, s42, 720896
ds_read_b64_tr_b16 a[172:173], v12 offset:4096
s_mul_i32 s65, s41, 7
v_mfma_f32_16x16x32_bf16 v[160:163], a[220:223], v[220:223], v[160:163]
buffer_store_dwordx4 v[40:43], v89, s[28:31], s39 offen sc1
v_mfma_f32_16x16x32_bf16 v[164:167], a[220:223], v[224:227], v[164:167]
v_mul_f32 v212, v212, v94
v_mul_f32 v213, v213, v94
v_mfma_f32_16x16x32_bf16 v[168:171], a[220:223], v[228:231], v[168:171]
s_add_u32 s65, s65, s3
v_mul_f32 v214, v214, v94
v_mul_f32 v215, v215, v94
v_mfma_f32_16x16x32_bf16 v[172:175], a[220:223], v[232:235], v[172:175]
s_waitcnt lgkmcnt(3)
ds_read_b64_tr_b16 a[174:175], v12 offset:6144
v_cvt_pk_bf16_f32 v44, v212, v213
v_mfma_f32_16x16x32_bf16 v[116:119], a[160:163], a[0:3], v[116:119]
v_cvt_pk_bf16_f32 v45, v214, v215
v_mul_f32 v252, v252, v94
v_mfma_f32_16x16x32_bf16 v[120:123], a[160:163], a[4:7], v[120:123]
v_mul_f32 v253, v253, v94
v_mul_f32 v254, v254, v94
v_mfma_f32_16x16x32_bf16 v[124:127], a[160:163], a[8:11], v[124:127]
v_mul_f32 v255, v255, v94
v_cvt_pk_bf16_f32 v46, v252, v253
v_mfma_f32_16x16x32_bf16 v[128:131], a[160:163], a[12:15], v[128:131]
s_mul_i32 s65, s65, 32768
ds_read_b64_tr_b16 a[176:177], v11 offset:8192
v_cvt_pk_bf16_f32 v47, v254, v255
v_mfma_f32_16x16x32_bf16 v[132:135], a[160:163], a[16:19], v[132:135]
s_add_u32 s39, s42, 950272
ds_read_b64_tr_b16 a[178:179], v11 offset:10240
v_mfma_f32_16x16x32_bf16 v[156:159], a[164:167], a[0:3], v[156:159]
buffer_store_dwordx4 v[44:47], v89, s[28:31], s39 offen sc1
v_mfma_f32_16x16x32_bf16 v[160:163], a[164:167], a[4:7], v[160:163]
ds_read_b64_tr_b16 a[180:181], v12 offset:8192
v_mfma_f32_16x16x32_bf16 v[164:167], a[164:167], a[8:11], v[164:167]
s_mul_i32 s68, s41, 28672
ds_read_b64_tr_b16 a[182:183], v12 offset:10240
v_mfma_f32_16x16x32_bf16 v[168:171], a[164:167], a[12:15], v[168:171]
ds_read_b64_tr_b16 a[184:185], v11 offset:12288
v_mfma_f32_16x16x32_bf16 v[172:175], a[164:167], a[16:19], v[172:175]
s_waitcnt lgkmcnt(5)
ds_read_b64_tr_b16 a[186:187], v11 offset:14336
v_mfma_f32_16x16x32_bf16 v[116:119], a[168:171], a[20:23], v[116:119]
ds_read_b64_tr_b16 a[188:189], v12 offset:12288
v_mfma_f32_16x16x32_bf16 v[120:123], a[168:171], a[24:27], v[120:123]
ds_read_b64_tr_b16 a[190:191], v12 offset:14336
v_mfma_f32_16x16x32_bf16 v[124:127], a[168:171], a[28:31], v[124:127]
s_lshl_b32 s3, s3, 7
v_mfma_f32_16x16x32_bf16 v[128:131], a[168:171], a[32:35], v[128:131]
v_mfma_f32_16x16x32_bf16 v[132:135], a[168:171], a[36:39], v[132:135]
s_waitcnt vmcnt(9)
s_barrier
ds_read_b64_tr_b16 a[192:193], v9 offset:32768
v_mfma_f32_16x16x32_bf16 v[156:159], a[172:175], a[20:23], v[156:159]
ds_read_b64_tr_b16 a[194:195], v9 offset:34816
v_mfma_f32_16x16x32_bf16 v[160:163], a[172:175], a[24:27], v[160:163]
s_add_u32 s68, s68, s3
ds_read_b64_tr_b16 a[196:197], v10 offset:32768
v_mfma_f32_16x16x32_bf16 v[164:167], a[172:175], a[28:31], v[164:167]
ds_read_b64_tr_b16 a[198:199], v10 offset:34816
v_mfma_f32_16x16x32_bf16 v[168:171], a[172:175], a[32:35], v[168:171]
ds_read_b64_tr_b16 a[200:201], v9 offset:36864
v_mfma_f32_16x16x32_bf16 v[172:175], a[172:175], a[36:39], v[172:175]
s_waitcnt lgkmcnt(9)
ds_read_b64_tr_b16 a[202:203], v9 offset:38912
v_mfma_f32_16x16x32_bf16 v[116:119], a[176:179], a[40:43], v[116:119]
s_mov_b32 s92, 522199330
ds_read_b64_tr_b16 a[204:205], v10 offset:36864
v_mfma_f32_16x16x32_bf16 v[120:123], a[176:179], a[44:47], v[120:123]
ds_read_b64_tr_b16 a[206:207], v10 offset:38912
v_mfma_f32_16x16x32_bf16 v[124:127], a[176:179], a[48:51], v[124:127]
ds_read_b64_tr_b16 a[208:209], v9 offset:40960
v_mfma_f32_16x16x32_bf16 v[128:131], a[176:179], a[52:55], v[128:131]
ds_read_b64_tr_b16 a[210:211], v9 offset:43008
v_mfma_f32_16x16x32_bf16 v[132:135], a[176:179], a[56:59], v[132:135]
ds_read_b64_tr_b16 a[212:213], v10 offset:40960
v_mfma_f32_16x16x32_bf16 v[156:159], a[180:183], a[40:43], v[156:159]
s_mov_b32 s93, 454827294
ds_read_b64_tr_b16 a[214:215], v10 offset:43008
v_mfma_f32_16x16x32_bf16 v[160:163], a[180:183], a[44:47], v[160:163]
ds_read_b64_tr_b16 a[216:217], v9 offset:45056
v_mfma_f32_16x16x32_bf16 v[164:167], a[180:183], a[48:51], v[164:167]
ds_read_b64_tr_b16 a[218:219], v9 offset:47104
v_mfma_f32_16x16x32_bf16 v[168:171], a[180:183], a[52:55], v[168:171]
ds_read_b64_tr_b16 a[220:221], v10 offset:45056
v_mfma_f32_16x16x32_bf16 v[172:175], a[180:183], a[56:59], v[172:175]
s_waitcnt lgkmcnt(15)
ds_read_b64_tr_b16 a[222:223], v10 offset:47104
v_mfma_f32_16x16x32_bf16 v[116:119], a[184:187], a[60:63], v[116:119]
s_bitcmp1_b32 s34, 3
s_cmov_b32 s92, 387455258
s_cmov_b32 s93, 1077952576
v_mfma_f32_16x16x32_bf16 v[120:123], a[184:187], a[64:67], v[120:123]
ds_read_b64_tr_b16 a[160:161], v11 offset:32768
v_mfma_f32_16x16x32_bf16 v[124:127], a[184:187], a[68:71], v[124:127]
ds_read_b64_tr_b16 a[162:163], v11 offset:34816
v_mfma_f32_16x16x32_bf16 v[128:131], a[184:187], a[72:75], v[128:131]
ds_read_b64_tr_b16 a[164:165], v12 offset:32768
v_mfma_f32_16x16x32_bf16 v[132:135], a[184:187], a[76:79], v[132:135]
s_lshr_b64 s[92:93], s[92:93], s101
ds_read_b64_tr_b16 a[166:167], v12 offset:34816
v_mfma_f32_16x16x32_bf16 v[156:159], a[188:191], a[60:63], v[156:159]
ds_read_b64_tr_b16 a[168:169], v11 offset:36864
v_mfma_f32_16x16x32_bf16 v[160:163], a[188:191], a[64:67], v[160:163]
ds_read_b64_tr_b16 a[170:171], v11 offset:38912
v_mfma_f32_16x16x32_bf16 v[164:167], a[188:191], a[68:71], v[164:167]
ds_read_b64_tr_b16 a[172:173], v12 offset:36864
v_mfma_f32_16x16x32_bf16 v[168:171], a[188:191], a[72:75], v[168:171]
ds_read_b64_tr_b16 a[174:175], v12 offset:38912
v_mfma_f32_16x16x32_bf16 v[172:175], a[188:191], a[76:79], v[172:175]
s_waitcnt lgkmcnt(15)
s_and_b32 s41, s92, 127
ds_read_b64_tr_b16 a[176:177], v11 offset:40960
v_mfma_f32_16x16x32_bf16 v[196:199], a[192:195], v[96:99], 0
ds_read_b64_tr_b16 a[178:179], v11 offset:43008
v_mfma_f32_16x16x32_bf16 v[200:203], a[192:195], v[100:103], 0
v_mul_f32 v116, v116, v90
v_mul_f32 v117, v117, v90
v_mfma_f32_16x16x32_bf16 v[204:207], a[192:195], v[104:107], 0
v_mul_f32 v118, v118, v90
v_mul_f32 v119, v119, v90
v_mfma_f32_16x16x32_bf16 v[208:211], a[192:195], v[108:111], 0
v_cvt_pk_bf16_f32 v24, v116, v117
v_cvt_pk_bf16_f32 v25, v118, v119
v_mfma_f32_16x16x32_bf16 v[212:215], a[192:195], v[112:115], 0
v_mul_f32 v156, v156, v90
v_mul_f32 v157, v157, v90
v_mfma_f32_16x16x32_bf16 v[236:239], a[196:199], v[96:99], 0
v_mul_f32 v158, v158, v90
v_mul_f32 v159, v159, v90
v_mfma_f32_16x16x32_bf16 v[240:243], a[196:199], v[100:103], 0
v_cvt_pk_bf16_f32 v26, v156, v157
v_cvt_pk_bf16_f32 v27, v158, v159
v_mfma_f32_16x16x32_bf16 v[244:247], a[196:199], v[104:107], 0
s_add_u32 s39, s42, 65536
ds_read_b64_tr_b16 a[180:181], v12 offset:40960
v_mfma_f32_16x16x32_bf16 v[248:251], a[196:199], v[108:111], 0
buffer_store_dwordx4 v[24:27], v89, s[28:31], s39 offen sc1
v_mfma_f32_16x16x32_bf16 v[252:255], a[196:199], v[112:115], 0
v_mul_f32 v120, v120, v91
v_mul_f32 v121, v121, v91
v_mfma_f32_16x16x32_bf16 v[196:199], a[200:203], v[136:139], v[196:199]
v_mul_f32 v122, v122, v91
v_mul_f32 v123, v123, v91
v_mfma_f32_16x16x32_bf16 v[200:203], a[200:203], v[140:143], v[200:203]
v_cvt_pk_bf16_f32 v28, v120, v121
v_cvt_pk_bf16_f32 v29, v122, v123
v_mfma_f32_16x16x32_bf16 v[204:207], a[200:203], v[144:147], v[204:207]
v_mul_f32 v160, v160, v91
v_mul_f32 v161, v161, v91
v_mfma_f32_16x16x32_bf16 v[208:211], a[200:203], v[148:151], v[208:211]
v_mul_f32 v162, v162, v91
v_mul_f32 v163, v163, v91
v_mfma_f32_16x16x32_bf16 v[212:215], a[200:203], v[152:155], v[212:215]
v_cvt_pk_bf16_f32 v30, v160, v161
v_cvt_pk_bf16_f32 v31, v162, v163
v_mfma_f32_16x16x32_bf16 v[236:239], a[204:207], v[136:139], v[236:239]
s_add_u32 s39, s42, 294912
ds_read_b64_tr_b16 a[182:183], v12 offset:43008
v_mfma_f32_16x16x32_bf16 v[240:243], a[204:207], v[140:143], v[240:243]
buffer_store_dwordx4 v[28:31], v89, s[28:31], s39 offen sc1
v_mfma_f32_16x16x32_bf16 v[244:247], a[204:207], v[144:147], v[244:247]
v_mul_f32 v124, v124, v92
v_mul_f32 v125, v125, v92
v_mfma_f32_16x16x32_bf16 v[248:251], a[204:207], v[148:151], v[248:251]
v_mul_f32 v126, v126, v92
v_mul_f32 v127, v127, v92
v_mfma_f32_16x16x32_bf16 v[252:255], a[204:207], v[152:155], v[252:255]
s_waitcnt lgkmcnt(15)
v_cvt_pk_bf16_f32 v48, v124, v125
v_cvt_pk_bf16_f32 v49, v126, v127
v_mfma_f32_16x16x32_bf16 v[196:199], a[208:211], v[176:179], v[196:199]
v_mul_f32 v164, v164, v92
v_mul_f32 v165, v165, v92
v_mfma_f32_16x16x32_bf16 v[200:203], a[208:211], v[180:183], v[200:203]
v_mul_f32 v166, v166, v92
v_mul_f32 v167, v167, v92
v_mfma_f32_16x16x32_bf16 v[204:207], a[208:211], v[184:187], v[204:207]
v_cvt_pk_bf16_f32 v50, v164, v165
v_cvt_pk_bf16_f32 v51, v166, v167
v_mfma_f32_16x16x32_bf16 v[208:211], a[208:211], v[188:191], v[208:211]
s_add_u32 s39, s42, 524288
ds_read_b64_tr_b16 a[184:185], v11 offset:45056
v_mfma_f32_16x16x32_bf16 v[212:215], a[208:211], v[192:195], v[212:215]
buffer_store_dwordx4 v[48:51], v89, s[28:31], s39 offen sc1
v_mfma_f32_16x16x32_bf16 v[236:239], a[212:215], v[176:179], v[236:239]
v_mul_f32 v128, v128, v93
v_mul_f32 v129, v129, v93
v_mfma_f32_16x16x32_bf16 v[240:243], a[212:215], v[180:183], v[240:243]
v_mul_f32 v130, v130, v93
v_mul_f32 v131, v131, v93
v_mfma_f32_16x16x32_bf16 v[244:247], a[212:215], v[184:187], v[244:247]
v_cvt_pk_bf16_f32 v52, v128, v129
v_cvt_pk_bf16_f32 v53, v130, v131
v_mfma_f32_16x16x32_bf16 v[248:251], a[212:215], v[188:191], v[248:251]
v_mul_f32 v168, v168, v93
v_mul_f32 v169, v169, v93
v_mfma_f32_16x16x32_bf16 v[252:255], a[212:215], v[192:195], v[252:255]
s_waitcnt lgkmcnt(13)
v_mul_f32 v170, v170, v93
v_mul_f32 v171, v171, v93
v_mfma_f32_16x16x32_bf16 v[196:199], a[216:219], v[216:219], v[196:199]
v_cvt_pk_bf16_f32 v54, v168, v169
v_cvt_pk_bf16_f32 v55, v170, v171
v_mfma_f32_16x16x32_bf16 v[200:203], a[216:219], v[220:223], v[200:203]
s_add_u32 s39, s42, 753664
ds_read_b64_tr_b16 a[186:187], v11 offset:47104
v_mfma_f32_16x16x32_bf16 v[204:207], a[216:219], v[224:227], v[204:207]
buffer_store_dwordx4 v[52:55], v89, s[28:31], s39 offen sc1
v_mfma_f32_16x16x32_bf16 v[208:211], a[216:219], v[228:231], v[208:211]
s_cmp_lt_u32 s41, 35
s_cselect_b32 s90, 0, 0xffff
s_cselect_b32 s100, 0, 4
s_cselect_b32 s41, s41, 0
v_mfma_f32_16x16x32_bf16 v[212:215], a[216:219], v[232:235], v[212:215]
s_or_b32 s91, s91, s100
v_mul_f32 v132, v132, v94
v_mul_f32 v133, v133, v94
v_mfma_f32_16x16x32_bf16 v[236:239], a[220:223], v[216:219], v[236:239]
v_mul_f32 v134, v134, v94
v_mul_f32 v135, v135, v94
v_mfma_f32_16x16x32_bf16 v[240:243], a[220:223], v[220:223], v[240:243]
v_cvt_pk_bf16_f32 v56, v132, v133
v_cvt_pk_bf16_f32 v57, v134, v135
v_mfma_f32_16x16x32_bf16 v[244:247], a[220:223], v[224:227], v[244:247]
v_mul_f32 v172, v172, v94
v_mul_f32 v173, v173, v94
v_mfma_f32_16x16x32_bf16 v[248:251], a[220:223], v[228:231], v[248:251]
s_cmp_ge_u32 s41, 35
s_cselect_b32 s100, 4, 0
v_mul_f32 v174, v174, v94
v_mfma_f32_16x16x32_bf16 v[252:255], a[220:223], v[232:235], v[252:255]
s_waitcnt lgkmcnt(10)
v_mul_f32 v175, v175, v94
s_or_b32 s75, s75, s100
v_mfma_f32_16x16x32_bf16 v[196:199], a[160:163], a[0:3], v[196:199]
s_mul_i32 s3, s41, 52
s_lshr_b32 s3, s3, 8
s_mul_i32 s71, s3, 5
v_mfma_f32_16x16x32_bf16 v[200:203], a[160:163], a[4:7], v[200:203]
s_sub_u32 s41, s41, s71
v_add_u32 v16, 1, v16
v_cvt_pk_bf16_f32 v58, v172, v173
v_mfma_f32_16x16x32_bf16 v[204:207], a[160:163], a[8:11], v[204:207]
s_waitcnt vmcnt(4)
buffer_store_dwordx2 v[16:17], v18, s[12:15], s70 offen sc1
v_mfma_f32_16x16x32_bf16 v[208:211], a[160:163], a[12:15], v[208:211]
s_sub_u32 s84, s3, 6
v_cvt_pk_bf16_f32 v59, v174, v175
s_add_u32 s39, s42, 983040
v_mfma_f32_16x16x32_bf16 v[212:215], a[160:163], a[16:19], v[212:215]
buffer_store_dwordx4 v[56:59], v89, s[28:31], s39 offen sc1
v_mfma_f32_16x16x32_bf16 v[236:239], a[164:167], a[0:3], v[236:239]
ds_read_b64_tr_b16 a[188:189], v12 offset:45056
v_mfma_f32_16x16x32_bf16 v[240:243], a[164:167], a[4:7], v[240:243]
s_mul_i32 s66, s41, 7
ds_read_b64_tr_b16 a[190:191], v12 offset:47104
v_add_u32 v9, 65536, v9
v_mfma_f32_16x16x32_bf16 v[244:247], a[164:167], a[8:11], v[244:247]
v_add_u32 v10, 65536, v10
v_add_u32 v11, 65536, v11
v_mfma_f32_16x16x32_bf16 v[248:251], a[164:167], a[12:15], v[248:251]
v_add_u32 v12, 65536, v12
v_mfma_f32_16x16x32_bf16 v[252:255], a[164:167], a[16:19], v[252:255]
s_waitcnt lgkmcnt(8)
ds_read_b64_tr_b16 a[192:193], v9 offset:0
v_mfma_f32_16x16x32_bf16 v[196:199], a[168:171], a[20:23], v[196:199]
s_add_u32 s66, s66, s3
ds_read_b64_tr_b16 a[194:195], v9 offset:2048
v_mfma_f32_16x16x32_bf16 v[200:203], a[168:171], a[24:27], v[200:203]
ds_read_b64_tr_b16 a[196:197], v10 offset:0
v_mfma_f32_16x16x32_bf16 v[204:207], a[168:171], a[28:31], v[204:207]
ds_read_b64_tr_b16 a[198:199], v10 offset:2048
v_mfma_f32_16x16x32_bf16 v[208:211], a[168:171], a[32:35], v[208:211]
ds_read_b64_tr_b16 a[200:201], v9 offset:4096
v_mfma_f32_16x16x32_bf16 v[212:215], a[168:171], a[36:39], v[212:215]
ds_read_b64_tr_b16 a[202:203], v9 offset:6144
v_mfma_f32_16x16x32_bf16 v[236:239], a[172:175], a[20:23], v[236:239]
s_mul_i32 s66, s66, 32768
ds_read_b64_tr_b16 a[204:205], v10 offset:4096
v_mfma_f32_16x16x32_bf16 v[240:243], a[172:175], a[24:27], v[240:243]
ds_read_b64_tr_b16 a[206:207], v10 offset:6144
v_mfma_f32_16x16x32_bf16 v[244:247], a[172:175], a[28:31], v[244:247]
ds_read_b64_tr_b16 a[208:209], v9 offset:8192
v_mfma_f32_16x16x32_bf16 v[248:251], a[172:175], a[32:35], v[248:251]
ds_read_b64_tr_b16 a[210:211], v9 offset:10240
v_mfma_f32_16x16x32_bf16 v[252:255], a[172:175], a[36:39], v[252:255]
s_waitcnt lgkmcnt(14)
ds_read_b64_tr_b16 a[212:213], v10 offset:8192
v_mfma_f32_16x16x32_bf16 v[196:199], a[176:179], a[40:43], v[196:199]
s_mul_i32 s71, s41, 28672
ds_read_b64_tr_b16 a[214:215], v10 offset:10240
v_mfma_f32_16x16x32_bf16 v[200:203], a[176:179], a[44:47], v[200:203]
ds_read_b64_tr_b16 a[216:217], v9 offset:12288
v_mfma_f32_16x16x32_bf16 v[204:207], a[176:179], a[48:51], v[204:207]
ds_read_b64_tr_b16 a[218:219], v9 offset:14336
v_mfma_f32_16x16x32_bf16 v[208:211], a[176:179], a[52:55], v[208:211]
ds_read_b64_tr_b16 a[220:221], v10 offset:12288
v_mfma_f32_16x16x32_bf16 v[212:215], a[176:179], a[56:59], v[212:215]
s_lshl_b32 s3, s3, 7
ds_read_b64_tr_b16 a[222:223], v10 offset:14336
v_mfma_f32_16x16x32_bf16 v[236:239], a[180:183], a[40:43], v[236:239]
ds_read_b64_tr_b16 a[160:161], v11 offset:0
v_mfma_f32_16x16x32_bf16 v[240:243], a[180:183], a[44:47], v[240:243]
ds_read_b64_tr_b16 a[162:163], v11 offset:2048
v_mfma_f32_16x16x32_bf16 v[244:247], a[180:183], a[48:51], v[244:247]
ds_read_b64_tr_b16 a[164:165], v12 offset:0
v_mfma_f32_16x16x32_bf16 v[248:251], a[180:183], a[52:55], v[248:251]
ds_read_b64_tr_b16 a[166:167], v12 offset:2048
v_mfma_f32_16x16x32_bf16 v[252:255], a[180:183], a[56:59], v[252:255]
s_waitcnt lgkmcnt(15)
s_add_u32 s71, s71, s3
ds_read_b64_tr_b16 a[168:169], v11 offset:4096
v_mfma_f32_16x16x32_bf16 v[196:199], a[184:187], a[60:63], v[196:199]
ds_read_b64_tr_b16 a[170:171], v11 offset:6144
v_mfma_f32_16x16x32_bf16 v[200:203], a[184:187], a[64:67], v[200:203]
ds_read_b64_tr_b16 a[172:173], v12 offset:4096
v_mfma_f32_16x16x32_bf16 v[204:207], a[184:187], a[68:71], v[204:207]
ds_read_b64_tr_b16 a[174:175], v12 offset:6144
v_mfma_f32_16x16x32_bf16 v[208:211], a[184:187], a[72:75], v[208:211]
ds_read_b64_tr_b16 a[176:177], v11 offset:8192
v_mfma_f32_16x16x32_bf16 v[212:215], a[184:187], a[76:79], v[212:215]
s_add_u32 s80, s80, s86
ds_read_b64_tr_b16 a[178:179], v11 offset:10240
v_mfma_f32_16x16x32_bf16 v[236:239], a[188:191], a[60:63], v[236:239]
ds_read_b64_tr_b16 a[180:181], v12 offset:8192
v_mfma_f32_16x16x32_bf16 v[240:243], a[188:191], a[64:67], v[240:243]
ds_read_b64_tr_b16 a[182:183], v12 offset:10240
v_mfma_f32_16x16x32_bf16 v[244:247], a[188:191], a[68:71], v[244:247]
ds_read_b64_tr_b16 a[184:185], v11 offset:12288
v_mfma_f32_16x16x32_bf16 v[248:251], a[188:191], a[72:75], v[248:251]
s_mov_b32 s81, s87
ds_read_b64_tr_b16 a[186:187], v11 offset:14336
v_mfma_f32_16x16x32_bf16 v[252:255], a[188:191], a[76:79], v[252:255]
ds_read_b64_tr_b16 a[188:189], v12 offset:12288
v_mfma_f32_16x16x32_bf16 v[116:119], a[192:195], v[96:99], 0
ds_read_b64_tr_b16 a[190:191], v12 offset:14336
v_mfma_f32_16x16x32_bf16 v[120:123], a[192:195], v[100:103], 0
v_mul_f32 v196, v196, v90
v_mul_f32 v197, v197, v90
v_mfma_f32_16x16x32_bf16 v[124:127], a[192:195], v[104:107], 0
v_mul_f32 v198, v198, v90
v_mul_f32 v199, v199, v90
v_mfma_f32_16x16x32_bf16 v[128:131], a[192:195], v[108:111], 0
s_add_u32 s64, s64, s42
v_cvt_pk_bf16_f32 v60, v196, v197
v_cvt_pk_bf16_f32 v61, v198, v199
v_mfma_f32_16x16x32_bf16 v[132:135], a[192:195], v[112:115], 0
v_mul_f32 v236, v236, v90
v_mul_f32 v237, v237, v90
v_mfma_f32_16x16x32_bf16 v[156:159], a[196:199], v[96:99], 0
v_mul_f32 v238, v238, v90
v_mul_f32 v239, v239, v90
v_mfma_f32_16x16x32_bf16 v[160:163], a[196:199], v[100:103], 0
v_cvt_pk_bf16_f32 v62, v236, v237
v_cvt_pk_bf16_f32 v63, v238, v239
v_mfma_f32_16x16x32_bf16 v[164:167], a[196:199], v[104:107], 0
s_add_u32 s39, s42, 98304
ds_read_b64_tr_b16 a[192:193], v9 offset:32768
v_mfma_f32_16x16x32_bf16 v[168:171], a[196:199], v[108:111], 0
buffer_store_dwordx4 v[60:63], v89, s[28:31], s39 offen sc1
v_mfma_f32_16x16x32_bf16 v[172:175], a[196:199], v[112:115], 0
s_waitcnt lgkmcnt(15)
v_mul_f32 v200, v200, v91
v_mul_f32 v201, v201, v91
v_mfma_f32_16x16x32_bf16 v[116:119], a[200:203], v[136:139], v[116:119]
s_add_u32 s82, s82, s86
v_mul_f32 v202, v202, v91
v_mul_f32 v203, v203, v91
v_mfma_f32_16x16x32_bf16 v[120:123], a[200:203], v[140:143], v[120:123]
v_cvt_pk_bf16_f32 v64, v200, v201
v_cvt_pk_bf16_f32 v65, v202, v203
v_mfma_f32_16x16x32_bf16 v[124:127], a[200:203], v[144:147], v[124:127]
s_mov_b32 s83, s87
v_mul_f32 v240, v240, v91
v_mul_f32 v241, v241, v91
v_mfma_f32_16x16x32_bf16 v[128:131], a[200:203], v[148:151], v[128:131]
v_mul_f32 v242, v242, v91
v_mul_f32 v243, v243, v91
v_mfma_f32_16x16x32_bf16 v[132:135], a[200:203], v[152:155], v[132:135]
v_cvt_pk_bf16_f32 v66, v240, v241
v_cvt_pk_bf16_f32 v67, v242, v243
v_mfma_f32_16x16x32_bf16 v[156:159], a[204:207], v[136:139], v[156:159]
s_add_u32 s39, s42, 327680
ds_read_b64_tr_b16 a[194:195], v9 offset:34816
v_mfma_f32_16x16x32_bf16 v[160:163], a[204:207], v[140:143], v[160:163]
buffer_store_dwordx4 v[64:67], v89, s[28:31], s39 offen sc1
v_mfma_f32_16x16x32_bf16 v[164:167], a[204:207], v[144:147], v[164:167]
s_add_u32 s65, s65, s42
v_mul_f32 v204, v204, v92
v_mul_f32 v205, v205, v92
v_mfma_f32_16x16x32_bf16 v[168:171], a[204:207], v[148:151], v[168:171]
v_mul_f32 v206, v206, v92
v_mul_f32 v207, v207, v92
v_mfma_f32_16x16x32_bf16 v[172:175], a[204:207], v[152:155], v[172:175]
v_cvt_pk_bf16_f32 v68, v204, v205
v_cvt_pk_bf16_f32 v69, v206, v207
v_mfma_f32_16x16x32_bf16 v[116:119], a[208:211], v[176:179], v[116:119]
v_mul_f32 v244, v244, v92
v_mul_f32 v245, v245, v92
v_mfma_f32_16x16x32_bf16 v[120:123], a[208:211], v[180:183], v[120:123]
v_mul_f32 v246, v246, v92
v_mul_f32 v247, v247, v92
v_mfma_f32_16x16x32_bf16 v[124:127], a[208:211], v[184:187], v[124:127]
s_add_u32 s84, s84, s86
v_cvt_pk_bf16_f32 v70, v244, v245
v_cvt_pk_bf16_f32 v71, v246, v247
v_mfma_f32_16x16x32_bf16 v[128:131], a[208:211], v[188:191], v[128:131]
s_add_u32 s39, s42, 557056
ds_read_b64_tr_b16 a[196:197], v10 offset:32768
v_mfma_f32_16x16x32_bf16 v[132:135], a[208:211], v[192:195], v[132:135]
buffer_store_dwordx4 v[68:71], v89, s[28:31], s39 offen sc1
v_mfma_f32_16x16x32_bf16 v[156:159], a[212:215], v[176:179], v[156:159]
v_mul_f32 v208, v208, v93
v_mul_f32 v209, v209, v93
v_mfma_f32_16x16x32_bf16 v[160:163], a[212:215], v[180:183], v[160:163]
s_mov_b32 s85, s87
v_mul_f32 v210, v210, v93
v_mul_f32 v211, v211, v93
v_mfma_f32_16x16x32_bf16 v[164:167], a[212:215], v[184:187], v[164:167]
v_cvt_pk_bf16_f32 v72, v208, v209
v_cvt_pk_bf16_f32 v73, v210, v211
v_mfma_f32_16x16x32_bf16 v[168:171], a[212:215], v[188:191], v[168:171]
v_mul_f32 v248, v248, v93
v_mul_f32 v249, v249, v93
v_mfma_f32_16x16x32_bf16 v[172:175], a[212:215], v[192:195], v[172:175]
v_mul_f32 v250, v250, v93
v_mul_f32 v251, v251, v93
v_mfma_f32_16x16x32_bf16 v[116:119], a[216:219], v[216:219], v[116:119]
v_cvt_pk_bf16_f32 v74, v248, v249
v_cvt_pk_bf16_f32 v75, v250, v251
v_mfma_f32_16x16x32_bf16 v[120:123], a[216:219], v[220:223], v[120:123]
s_add_u32 s39, s42, 786432
s_add_u32 s66, s66, s42
ds_read_b64_tr_b16 a[198:199], v10 offset:34816
v_mfma_f32_16x16x32_bf16 v[124:127], a[216:219], v[224:227], v[124:127]
buffer_store_dwordx4 v[72:75], v89, s[28:31], s39 offen sc1
v_mfma_f32_16x16x32_bf16 v[128:131], a[216:219], v[228:231], v[128:131]
v_mul_f32 v212, v212, v94
v_mul_f32 v213, v213, v94
v_mfma_f32_16x16x32_bf16 v[132:135], a[216:219], v[232:235], v[132:135]
v_mul_f32 v214, v214, v94
v_mul_f32 v215, v215, v94
v_mfma_f32_16x16x32_bf16 v[156:159], a[220:223], v[216:219], v[156:159]
v_cvt_pk_bf16_f32 v76, v212, v213
v_cvt_pk_bf16_f32 v77, v214, v215
v_mfma_f32_16x16x32_bf16 v[160:163], a[220:223], v[220:223], v[160:163]
v_mul_f32 v252, v252, v94
v_mul_f32 v253, v253, v94
v_mfma_f32_16x16x32_bf16 v[164:167], a[220:223], v[224:227], v[164:167]
v_mul_f32 v254, v254, v94
v_mul_f32 v255, v255, v94
v_mfma_f32_16x16x32_bf16 v[168:171], a[220:223], v[228:231], v[168:171]
v_cvt_pk_bf16_f32 v78, v252, v253
v_cvt_pk_bf16_f32 v79, v254, v255
v_mfma_f32_16x16x32_bf16 v[172:175], a[220:223], v[232:235], v[172:175]
s_waitcnt lgkmcnt(15)
s_add_u32 s39, s42, 1015808
ds_read_b64_tr_b16 a[200:201], v9 offset:36864
v_mfma_f32_16x16x32_bf16 v[116:119], a[160:163], a[0:3], v[116:119]
ds_read_b64_tr_b16 a[202:203], v9 offset:38912
v_add_u32 v16, 1, v16
v_mfma_f32_16x16x32_bf16 v[120:123], a[160:163], a[4:7], v[120:123]
s_waitcnt vmcnt(4)
buffer_store_dwordx2 v[16:17], v18, s[12:15], s70 offen sc1
v_mfma_f32_16x16x32_bf16 v[124:127], a[160:163], a[8:11], v[124:127]
buffer_store_dwordx4 v[76:79], v89, s[28:31], s39 offen sc1
v_mfma_f32_16x16x32_bf16 v[128:131], a[160:163], a[12:15], v[128:131]
ds_read_b64_tr_b16 a[204:205], v10 offset:36864
v_mfma_f32_16x16x32_bf16 v[132:135], a[160:163], a[16:19], v[132:135]
ds_read_b64_tr_b16 a[206:207], v10 offset:38912
v_mfma_f32_16x16x32_bf16 v[156:159], a[164:167], a[0:3], v[156:159]
ds_read_b64_tr_b16 a[208:209], v9 offset:40960
v_mfma_f32_16x16x32_bf16 v[160:163], a[164:167], a[4:7], v[160:163]
ds_read_b64_tr_b16 a[210:211], v9 offset:43008
v_mfma_f32_16x16x32_bf16 v[164:167], a[164:167], a[8:11], v[164:167]
ds_read_b64_tr_b16 a[212:213], v10 offset:40960
v_mfma_f32_16x16x32_bf16 v[168:171], a[164:167], a[12:15], v[168:171]
ds_read_b64_tr_b16 a[214:215], v10 offset:43008
v_mfma_f32_16x16x32_bf16 v[172:175], a[164:167], a[16:19], v[172:175]
s_waitcnt lgkmcnt(15)
ds_read_b64_tr_b16 a[216:217], v9 offset:45056
v_mfma_f32_16x16x32_bf16 v[116:119], a[168:171], a[20:23], v[116:119]
ds_read_b64_tr_b16 a[218:219], v9 offset:47104
v_mfma_f32_16x16x32_bf16 v[120:123], a[168:171], a[24:27], v[120:123]
ds_read_b64_tr_b16 a[220:221], v10 offset:45056
v_mfma_f32_16x16x32_bf16 v[124:127], a[168:171], a[28:31], v[124:127]
ds_read_b64_tr_b16 a[222:223], v10 offset:47104
v_mfma_f32_16x16x32_bf16 v[128:131], a[168:171], a[32:35], v[128:131]
ds_read_b64_tr_b16 a[160:161], v11 offset:32768
v_mfma_f32_16x16x32_bf16 v[132:135], a[168:171], a[36:39], v[132:135]
ds_read_b64_tr_b16 a[162:163], v11 offset:34816
v_mfma_f32_16x16x32_bf16 v[156:159], a[172:175], a[20:23], v[156:159]
ds_read_b64_tr_b16 a[164:165], v12 offset:32768
v_mfma_f32_16x16x32_bf16 v[160:163], a[172:175], a[24:27], v[160:163]
ds_read_b64_tr_b16 a[166:167], v12 offset:34816
v_mfma_f32_16x16x32_bf16 v[164:167], a[172:175], a[28:31], v[164:167]
ds_read_b64_tr_b16 a[168:169], v11 offset:36864
v_mfma_f32_16x16x32_bf16 v[168:171], a[172:175], a[32:35], v[168:171]
ds_read_b64_tr_b16 a[170:171], v11 offset:38912
v_mfma_f32_16x16x32_bf16 v[172:175], a[172:175], a[36:39], v[172:175]
ds_read_b64_tr_b16 a[172:173], v12 offset:36864
v_mfma_f32_16x16x32_bf16 v[116:119], a[176:179], a[40:43], v[116:119]
ds_read_b64_tr_b16 a[174:175], v12 offset:38912
v_mfma_f32_16x16x32_bf16 v[120:123], a[176:179], a[44:47], v[120:123]
v_mfma_f32_16x16x32_bf16 v[124:127], a[176:179], a[48:51], v[124:127]
v_mfma_f32_16x16x32_bf16 v[128:131], a[176:179], a[52:55], v[128:131]
v_mfma_f32_16x16x32_bf16 v[132:135], a[176:179], a[56:59], v[132:135]
ds_read_b64_tr_b16 a[176:177], v11 offset:40960
v_mfma_f32_16x16x32_bf16 v[156:159], a[180:183], a[40:43], v[156:159]
ds_read_b64_tr_b16 a[178:179], v11 offset:43008
v_mfma_f32_16x16x32_bf16 v[160:163], a[180:183], a[44:47], v[160:163]
v_mfma_f32_16x16x32_bf16 v[164:167], a[180:183], a[48:51], v[164:167]
v_mfma_f32_16x16x32_bf16 v[168:171], a[180:183], a[52:55], v[168:171]
v_mfma_f32_16x16x32_bf16 v[172:175], a[180:183], a[56:59], v[172:175]
s_waitcnt lgkmcnt(15)
ds_read_b64_tr_b16 a[180:181], v12 offset:40960
v_mfma_f32_16x16x32_bf16 v[116:119], a[184:187], a[60:63], v[116:119]
ds_read_b64_tr_b16 a[182:183], v12 offset:43008
v_mfma_f32_16x16x32_bf16 v[120:123], a[184:187], a[64:67], v[120:123]
v_mfma_f32_16x16x32_bf16 v[124:127], a[184:187], a[68:71], v[124:127]
v_mfma_f32_16x16x32_bf16 v[128:131], a[184:187], a[72:75], v[128:131]
v_mfma_f32_16x16x32_bf16 v[132:135], a[184:187], a[76:79], v[132:135]
ds_read_b64_tr_b16 a[184:185], v11 offset:45056
v_mfma_f32_16x16x32_bf16 v[156:159], a[188:191], a[60:63], v[156:159]
ds_read_b64_tr_b16 a[186:187], v11 offset:47104
v_mfma_f32_16x16x32_bf16 v[160:163], a[188:191], a[64:67], v[160:163]
v_mfma_f32_16x16x32_bf16 v[164:167], a[188:191], a[68:71], v[164:167]
v_mfma_f32_16x16x32_bf16 v[168:171], a[188:191], a[72:75], v[168:171]
v_mfma_f32_16x16x32_bf16 v[172:175], a[188:191], a[76:79], v[172:175]
ds_read_b64_tr_b16 a[188:189], v12 offset:45056
v_mfma_f32_16x16x32_bf16 v[196:199], a[192:195], v[96:99], 0
ds_read_b64_tr_b16 a[190:191], v12 offset:47104
v_add_u32 v9, 65536, v9
v_mfma_f32_16x16x32_bf16 v[200:203], a[192:195], v[100:103], 0
v_mul_f32 v116, v116, v90
v_mul_f32 v117, v117, v90
v_mfma_f32_16x16x32_bf16 v[204:207], a[192:195], v[104:107], 0
v_mul_f32 v118, v118, v90
v_mul_f32 v119, v119, v90
v_mfma_f32_16x16x32_bf16 v[208:211], a[192:195], v[108:111], 0
v_cvt_pk_bf16_f32 v40, v116, v117
v_cvt_pk_bf16_f32 v41, v118, v119
v_mfma_f32_16x16x32_bf16 v[212:215], a[192:195], v[112:115], 0
v_mul_f32 v156, v156, v90
v_mul_f32 v157, v157, v90
v_mfma_f32_16x16x32_bf16 v[236:239], a[196:199], v[96:99], 0
v_mul_f32 v158, v158, v90
v_mul_f32 v159, v159, v90
v_mfma_f32_16x16x32_bf16 v[240:243], a[196:199], v[100:103], 0
v_cvt_pk_bf16_f32 v42, v156, v157
v_cvt_pk_bf16_f32 v43, v158, v159
v_mfma_f32_16x16x32_bf16 v[244:247], a[196:199], v[104:107], 0
s_add_u32 s39, s42, 131072
v_add_u32 v10, 65536, v10
v_add_u32 v11, 65536, v11
v_mfma_f32_16x16x32_bf16 v[248:251], a[196:199], v[108:111], 0
buffer_store_dwordx4 v[40:43], v89, s[28:31], s39 offen sc1
v_mfma_f32_16x16x32_bf16 v[252:255], a[196:199], v[112:115], 0
v_mul_f32 v120, v120, v91
v_mul_f32 v121, v121, v91
v_mfma_f32_16x16x32_bf16 v[196:199], a[200:203], v[136:139], v[196:199]
v_mul_f32 v122, v122, v91
v_mul_f32 v123, v123, v91
v_mfma_f32_16x16x32_bf16 v[200:203], a[200:203], v[140:143], v[200:203]
v_cvt_pk_bf16_f32 v44, v120, v121
v_cvt_pk_bf16_f32 v45, v122, v123
v_mfma_f32_16x16x32_bf16 v[204:207], a[200:203], v[144:147], v[204:207]
v_mul_f32 v160, v160, v91
v_mul_f32 v161, v161, v91
v_mfma_f32_16x16x32_bf16 v[208:211], a[200:203], v[148:151], v[208:211]
v_mul_f32 v162, v162, v91
v_mul_f32 v163, v163, v91
v_mfma_f32_16x16x32_bf16 v[212:215], a[200:203], v[152:155], v[212:215]
v_cvt_pk_bf16_f32 v46, v160, v161
v_cvt_pk_bf16_f32 v47, v162, v163
v_mfma_f32_16x16x32_bf16 v[236:239], a[204:207], v[136:139], v[236:239]
s_add_u32 s39, s42, 360448
v_add_u32 v12, 65536, v12
v_mfma_f32_16x16x32_bf16 v[240:243], a[204:207], v[140:143], v[240:243]
buffer_store_dwordx4 v[44:47], v89, s[28:31], s39 offen sc1
v_mfma_f32_16x16x32_bf16 v[244:247], a[204:207], v[144:147], v[244:247]
v_mul_f32 v124, v124, v92
v_mul_f32 v125, v125, v92
v_mfma_f32_16x16x32_bf16 v[248:251], a[204:207], v[148:151], v[248:251]
v_mul_f32 v126, v126, v92
v_mul_f32 v127, v127, v92
v_mfma_f32_16x16x32_bf16 v[252:255], a[204:207], v[152:155], v[252:255]
s_waitcnt lgkmcnt(15)
v_cvt_pk_bf16_f32 v24, v124, v125
v_cvt_pk_bf16_f32 v25, v126, v127
v_mfma_f32_16x16x32_bf16 v[196:199], a[208:211], v[176:179], v[196:199]
v_mul_f32 v164, v164, v92
v_mul_f32 v165, v165, v92
v_mfma_f32_16x16x32_bf16 v[200:203], a[208:211], v[180:183], v[200:203]
v_mul_f32 v166, v166, v92
v_mul_f32 v167, v167, v92
v_mfma_f32_16x16x32_bf16 v[204:207], a[208:211], v[184:187], v[204:207]
v_cvt_pk_bf16_f32 v26, v164, v165
v_cvt_pk_bf16_f32 v27, v166, v167
v_mfma_f32_16x16x32_bf16 v[208:211], a[208:211], v[188:191], v[208:211]
s_add_u32 s39, s42, 589824
ds_read_b64_tr_b16 a[192:193], v9 offset:0
v_mfma_f32_16x16x32_bf16 v[212:215], a[208:211], v[192:195], v[212:215]
buffer_store_dwordx4 v[24:27], v89, s[28:31], s39 offen sc1
v_mfma_f32_16x16x32_bf16 v[236:239], a[212:215], v[176:179], v[236:239]
v_mul_f32 v128, v128, v93
v_mul_f32 v129, v129, v93
v_mfma_f32_16x16x32_bf16 v[240:243], a[212:215], v[180:183], v[240:243]
v_mul_f32 v130, v130, v93
v_mul_f32 v131, v131, v93
v_mfma_f32_16x16x32_bf16 v[244:247], a[212:215], v[184:187], v[244:247]
v_cvt_pk_bf16_f32 v28, v128, v129
v_cvt_pk_bf16_f32 v29, v130, v131
v_mfma_f32_16x16x32_bf16 v[248:251], a[212:215], v[188:191], v[248:251]
v_mul_f32 v168, v168, v93
v_mul_f32 v169, v169, v93
v_mfma_f32_16x16x32_bf16 v[252:255], a[212:215], v[192:195], v[252:255]
v_mul_f32 v170, v170, v93
v_mul_f32 v171, v171, v93
v_mfma_f32_16x16x32_bf16 v[196:199], a[216:219], v[216:219], v[196:199]
v_cvt_pk_bf16_f32 v30, v168, v169
v_cvt_pk_bf16_f32 v31, v170, v171
v_mfma_f32_16x16x32_bf16 v[200:203], a[216:219], v[220:223], v[200:203]
s_add_u32 s39, s42, 819200
ds_read_b64_tr_b16 a[194:195], v9 offset:2048
v_mfma_f32_16x16x32_bf16 v[204:207], a[216:219], v[224:227], v[204:207]
buffer_store_dwordx4 v[28:31], v89, s[28:31], s39 offen sc1
v_mfma_f32_16x16x32_bf16 v[208:211], a[216:219], v[228:231], v[208:211]
v_mul_f32 v132, v132, v94
v_mul_f32 v133, v133, v94
v_mfma_f32_16x16x32_bf16 v[212:215], a[216:219], v[232:235], v[212:215]
v_mul_f32 v134, v134, v94
v_mul_f32 v135, v135, v94
v_mfma_f32_16x16x32_bf16 v[236:239], a[220:223], v[216:219], v[236:239]
v_cvt_pk_bf16_f32 v48, v132, v133
v_cvt_pk_bf16_f32 v49, v134, v135
v_mfma_f32_16x16x32_bf16 v[240:243], a[220:223], v[220:223], v[240:243]
v_mul_f32 v172, v172, v94
v_mul_f32 v173, v173, v94
v_mfma_f32_16x16x32_bf16 v[244:247], a[220:223], v[224:227], v[244:247]
v_mul_f32 v174, v174, v94
v_mul_f32 v175, v175, v94
v_mfma_f32_16x16x32_bf16 v[248:251], a[220:223], v[228:231], v[248:251]
v_cvt_pk_bf16_f32 v50, v172, v173
v_cvt_pk_bf16_f32 v51, v174, v175
v_mfma_f32_16x16x32_bf16 v[252:255], a[220:223], v[232:235], v[252:255]
s_waitcnt lgkmcnt(14)
s_add_u32 s39, s42, 1048576
ds_read_b64_tr_b16 a[196:197], v10 offset:0
v_mfma_f32_16x16x32_bf16 v[196:199], a[160:163], a[0:3], v[196:199]
ds_read_b64_tr_b16 a[198:199], v10 offset:2048
v_add_u32 v16, 1, v16
v_mfma_f32_16x16x32_bf16 v[200:203], a[160:163], a[4:7], v[200:203]
s_waitcnt vmcnt(4)
buffer_store_dwordx2 v[16:17], v18, s[12:15], s70 offen sc1
v_mfma_f32_16x16x32_bf16 v[204:207], a[160:163], a[8:11], v[204:207]
buffer_store_dwordx4 v[48:51], v89, s[28:31], s39 offen sc1
v_mfma_f32_16x16x32_bf16 v[208:211], a[160:163], a[12:15], v[208:211]
ds_read_b64_tr_b16 a[200:201], v9 offset:4096
v_mfma_f32_16x16x32_bf16 v[212:215], a[160:163], a[16:19], v[212:215]
ds_read_b64_tr_b16 a[202:203], v9 offset:6144
v_mfma_f32_16x16x32_bf16 v[236:239], a[164:167], a[0:3], v[236:239]
ds_read_b64_tr_b16 a[204:205], v10 offset:4096
v_mfma_f32_16x16x32_bf16 v[240:243], a[164:167], a[4:7], v[240:243]
ds_read_b64_tr_b16 a[206:207], v10 offset:6144
v_mfma_f32_16x16x32_bf16 v[244:247], a[164:167], a[8:11], v[244:247]
ds_read_b64_tr_b16 a[208:209], v9 offset:8192
v_mfma_f32_16x16x32_bf16 v[248:251], a[164:167], a[12:15], v[248:251]
ds_read_b64_tr_b16 a[210:211], v9 offset:10240
v_mfma_f32_16x16x32_bf16 v[252:255], a[164:167], a[16:19], v[252:255]
s_waitcnt lgkmcnt(15)
ds_read_b64_tr_b16 a[212:213], v10 offset:8192
v_mfma_f32_16x16x32_bf16 v[196:199], a[168:171], a[20:23], v[196:199]
ds_read_b64_tr_b16 a[214:215], v10 offset:10240
v_mfma_f32_16x16x32_bf16 v[200:203], a[168:171], a[24:27], v[200:203]
ds_read_b64_tr_b16 a[216:217], v9 offset:12288
v_mfma_f32_16x16x32_bf16 v[204:207], a[168:171], a[28:31], v[204:207]
ds_read_b64_tr_b16 a[218:219], v9 offset:14336
v_mfma_f32_16x16x32_bf16 v[208:211], a[168:171], a[32:35], v[208:211]
ds_read_b64_tr_b16 a[220:221], v10 offset:12288
v_mfma_f32_16x16x32_bf16 v[212:215], a[168:171], a[36:39], v[212:215]
ds_read_b64_tr_b16 a[222:223], v10 offset:14336
v_mfma_f32_16x16x32_bf16 v[236:239], a[172:175], a[20:23], v[236:239]
ds_read_b64_tr_b16 a[160:161], v11 offset:0
v_mfma_f32_16x16x32_bf16 v[240:243], a[172:175], a[24:27], v[240:243]
ds_read_b64_tr_b16 a[162:163], v11 offset:2048
v_mfma_f32_16x16x32_bf16 v[244:247], a[172:175], a[28:31], v[244:247]
ds_read_b64_tr_b16 a[164:165], v12 offset:0
v_mfma_f32_16x16x32_bf16 v[248:251], a[172:175], a[32:35], v[248:251]
ds_read_b64_tr_b16 a[166:167], v12 offset:2048
v_mfma_f32_16x16x32_bf16 v[252:255], a[172:175], a[36:39], v[252:255]
s_waitcnt lgkmcnt(15)
ds_read_b64_tr_b16 a[168:169], v11 offset:4096
v_mfma_f32_16x16x32_bf16 v[196:199], a[176:179], a[40:43], v[196:199]
ds_read_b64_tr_b16 a[170:171], v11 offset:6144
v_mfma_f32_16x16x32_bf16 v[200:203], a[176:179], a[44:47], v[200:203]
ds_read_b64_tr_b16 a[172:173], v12 offset:4096
v_mfma_f32_16x16x32_bf16 v[204:207], a[176:179], a[48:51], v[204:207]
ds_read_b64_tr_b16 a[174:175], v12 offset:6144
v_mfma_f32_16x16x32_bf16 v[208:211], a[176:179], a[52:55], v[208:211]
v_mfma_f32_16x16x32_bf16 v[212:215], a[176:179], a[56:59], v[212:215]
ds_read_b64_tr_b16 a[176:177], v11 offset:8192
v_mfma_f32_16x16x32_bf16 v[236:239], a[180:183], a[40:43], v[236:239]
ds_read_b64_tr_b16 a[178:179], v11 offset:10240
v_mfma_f32_16x16x32_bf16 v[240:243], a[180:183], a[44:47], v[240:243]
v_mfma_f32_16x16x32_bf16 v[244:247], a[180:183], a[48:51], v[244:247]
v_mfma_f32_16x16x32_bf16 v[248:251], a[180:183], a[52:55], v[248:251]
v_mfma_f32_16x16x32_bf16 v[252:255], a[180:183], a[56:59], v[252:255]
ds_read_b64_tr_b16 a[180:181], v12 offset:8192
v_mfma_f32_16x16x32_bf16 v[196:199], a[184:187], a[60:63], v[196:199]
ds_read_b64_tr_b16 a[182:183], v12 offset:10240
v_mfma_f32_16x16x32_bf16 v[200:203], a[184:187], a[64:67], v[200:203]
v_mfma_f32_16x16x32_bf16 v[204:207], a[184:187], a[68:71], v[204:207]
v_mfma_f32_16x16x32_bf16 v[208:211], a[184:187], a[72:75], v[208:211]
v_mfma_f32_16x16x32_bf16 v[212:215], a[184:187], a[76:79], v[212:215]
ds_read_b64_tr_b16 a[184:185], v11 offset:12288
v_mfma_f32_16x16x32_bf16 v[236:239], a[188:191], a[60:63], v[236:239]
ds_read_b64_tr_b16 a[186:187], v11 offset:14336
v_mfma_f32_16x16x32_bf16 v[240:243], a[188:191], a[64:67], v[240:243]
v_mfma_f32_16x16x32_bf16 v[244:247], a[188:191], a[68:71], v[244:247]
v_mfma_f32_16x16x32_bf16 v[248:251], a[188:191], a[72:75], v[248:251]
v_mfma_f32_16x16x32_bf16 v[252:255], a[188:191], a[76:79], v[252:255]
ds_read_b64_tr_b16 a[188:189], v12 offset:12288
v_mfma_f32_16x16x32_bf16 v[116:119], a[192:195], v[96:99], 0
v_mov_b32 v84, 0
v_mov_b32 v85, 0
v_mfma_f32_16x16x32_bf16 v[120:123], a[192:195], v[100:103], 0
v_mul_f32 v196, v196, v90
v_mul_f32 v197, v197, v90
v_mfma_f32_16x16x32_bf16 v[124:127], a[192:195], v[104:107], 0
v_mul_f32 v198, v198, v90
v_mul_f32 v199, v199, v90
v_mfma_f32_16x16x32_bf16 v[128:131], a[192:195], v[108:111], 0
buffer_atomic_or_x2 v[84:85], v19, s[12:15], 0 offen sc0 sc1
v_mfma_f32_16x16x32_bf16 v[132:135], a[192:195], v[112:115], 0
v_cvt_pk_bf16_f32 v52, v196, v197
v_cvt_pk_bf16_f32 v53, v198, v199
v_mfma_f32_16x16x32_bf16 v[156:159], a[196:199], v[96:99], 0
v_mul_f32 v236, v236, v90
v_mul_f32 v237, v237, v90
v_mfma_f32_16x16x32_bf16 v[160:163], a[196:199], v[100:103], 0
v_mul_f32 v238, v238, v90
v_mul_f32 v239, v239, v90
v_mfma_f32_16x16x32_bf16 v[164:167], a[196:199], v[104:107], 0
v_cvt_pk_bf16_f32 v54, v236, v237
v_cvt_pk_bf16_f32 v55, v238, v239
v_mfma_f32_16x16x32_bf16 v[168:171], a[196:199], v[108:111], 0
s_add_u32 s39, s42, 163840
ds_read_b64_tr_b16 a[190:191], v12 offset:14336
v_mfma_f32_16x16x32_bf16 v[172:175], a[196:199], v[112:115], 0
s_waitcnt lgkmcnt(15)
buffer_store_dwordx4 v[52:55], v89, s[28:31], s39 offen sc1
v_mfma_f32_16x16x32_bf16 v[116:119], a[200:203], v[136:139], v[116:119]
v_mul_f32 v200, v200, v91
v_mul_f32 v201, v201, v91
v_mfma_f32_16x16x32_bf16 v[120:123], a[200:203], v[140:143], v[120:123]
v_mul_f32 v202, v202, v91
v_mul_f32 v203, v203, v91
v_mfma_f32_16x16x32_bf16 v[124:127], a[200:203], v[144:147], v[124:127]
v_cvt_pk_bf16_f32 v56, v200, v201
v_cvt_pk_bf16_f32 v57, v202, v203
v_mfma_f32_16x16x32_bf16 v[128:131], a[200:203], v[148:151], v[128:131]
v_mul_f32 v240, v240, v91
v_mul_f32 v241, v241, v91
v_mfma_f32_16x16x32_bf16 v[132:135], a[200:203], v[152:155], v[132:135]
v_mul_f32 v242, v242, v91
v_mul_f32 v243, v243, v91
v_mfma_f32_16x16x32_bf16 v[156:159], a[204:207], v[136:139], v[156:159]
v_cvt_pk_bf16_f32 v58, v240, v241
v_cvt_pk_bf16_f32 v59, v242, v243
v_mfma_f32_16x16x32_bf16 v[160:163], a[204:207], v[140:143], v[160:163]
s_add_u32 s39, s42, 393216
v_mfma_f32_16x16x32_bf16 v[164:167], a[204:207], v[144:147], v[164:167]
buffer_store_dwordx4 v[56:59], v89, s[28:31], s39 offen sc1
v_mfma_f32_16x16x32_bf16 v[168:171], a[204:207], v[148:151], v[168:171]
v_mul_f32 v204, v204, v92
v_mul_f32 v205, v205, v92
v_mfma_f32_16x16x32_bf16 v[172:175], a[204:207], v[152:155], v[172:175]
v_mul_f32 v206, v206, v92
v_mul_f32 v207, v207, v92
v_mfma_f32_16x16x32_bf16 v[116:119], a[208:211], v[176:179], v[116:119]
v_cvt_pk_bf16_f32 v60, v204, v205
v_cvt_pk_bf16_f32 v61, v206, v207
v_mfma_f32_16x16x32_bf16 v[120:123], a[208:211], v[180:183], v[120:123]
v_mul_f32 v244, v244, v92
v_mul_f32 v245, v245, v92
v_mfma_f32_16x16x32_bf16 v[124:127], a[208:211], v[184:187], v[124:127]
v_mul_f32 v246, v246, v92
v_mul_f32 v247, v247, v92
v_mfma_f32_16x16x32_bf16 v[128:131], a[208:211], v[188:191], v[128:131]
v_cvt_pk_bf16_f32 v62, v244, v245
v_cvt_pk_bf16_f32 v63, v246, v247
v_mfma_f32_16x16x32_bf16 v[132:135], a[208:211], v[192:195], v[132:135]
s_add_u32 s39, s42, 622592
v_mfma_f32_16x16x32_bf16 v[156:159], a[212:215], v[176:179], v[156:159]
buffer_store_dwordx4 v[60:63], v89, s[28:31], s39 offen sc1
v_mfma_f32_16x16x32_bf16 v[160:163], a[212:215], v[180:183], v[160:163]
v_mul_f32 v208, v208, v93
v_mul_f32 v209, v209, v93
v_mfma_f32_16x16x32_bf16 v[164:167], a[212:215], v[184:187], v[164:167]
v_mul_f32 v210, v210, v93
v_mul_f32 v211, v211, v93
v_mfma_f32_16x16x32_bf16 v[168:171], a[212:215], v[188:191], v[168:171]
v_cvt_pk_bf16_f32 v64, v208, v209
v_cvt_pk_bf16_f32 v65, v210, v211
v_mfma_f32_16x16x32_bf16 v[172:175], a[212:215], v[192:195], v[172:175]
v_mul_f32 v248, v248, v93
v_mul_f32 v249, v249, v93
v_mfma_f32_16x16x32_bf16 v[116:119], a[216:219], v[216:219], v[116:119]
v_mul_f32 v250, v250, v93
v_mul_f32 v251, v251, v93
v_mfma_f32_16x16x32_bf16 v[120:123], a[216:219], v[220:223], v[120:123]
v_cvt_pk_bf16_f32 v66, v248, v249
v_cvt_pk_bf16_f32 v67, v250, v251
v_mfma_f32_16x16x32_bf16 v[124:127], a[216:219], v[224:227], v[124:127]
s_add_u32 s39, s42, 851968
v_mfma_f32_16x16x32_bf16 v[128:131], a[216:219], v[228:231], v[128:131]
buffer_store_dwordx4 v[64:67], v89, s[28:31], s39 offen sc1
v_mfma_f32_16x16x32_bf16 v[132:135], a[216:219], v[232:235], v[132:135]
v_mul_f32 v212, v212, v94
v_mul_f32 v213, v213, v94
v_mfma_f32_16x16x32_bf16 v[156:159], a[220:223], v[216:219], v[156:159]
v_mul_f32 v214, v214, v94
v_mul_f32 v215, v215, v94
v_mfma_f32_16x16x32_bf16 v[160:163], a[220:223], v[220:223], v[160:163]
v_cvt_pk_bf16_f32 v68, v212, v213
v_cvt_pk_bf16_f32 v69, v214, v215
v_mfma_f32_16x16x32_bf16 v[164:167], a[220:223], v[224:227], v[164:167]
v_mul_f32 v252, v252, v94
v_mul_f32 v253, v253, v94
v_mfma_f32_16x16x32_bf16 v[168:171], a[220:223], v[228:231], v[168:171]
v_mul_f32 v254, v254, v94
v_mul_f32 v255, v255, v94
v_mfma_f32_16x16x32_bf16 v[172:175], a[220:223], v[232:235], v[172:175]
s_waitcnt lgkmcnt(8)
v_cvt_pk_bf16_f32 v70, v252, v253
v_cvt_pk_bf16_f32 v71, v254, v255
v_mfma_f32_16x16x32_bf16 v[116:119], a[160:163], a[0:3], v[116:119]
s_add_u32 s39, s42, 1081344
v_add_u32 v16, 1, v16
v_mfma_f32_16x16x32_bf16 v[156:159], a[164:167], a[0:3], v[156:159]
s_waitcnt vmcnt(5)
buffer_store_dwordx2 v[16:17], v18, s[12:15], s70 offen sc1
v_mfma_f32_16x16x32_bf16 v[116:119], a[168:171], a[20:23], v[116:119]
buffer_store_dwordx4 v[68:71], v89, s[28:31], s39 offen sc1
v_mfma_f32_16x16x32_bf16 v[156:159], a[172:175], a[20:23], v[156:159]
s_waitcnt lgkmcnt(0)
v_mfma_f32_16x16x32_bf16 v[116:119], a[176:179], a[40:43], v[116:119]
v_mfma_f32_16x16x32_bf16 v[156:159], a[180:183], a[40:43], v[156:159]
v_mfma_f32_16x16x32_bf16 v[116:119], a[184:187], a[60:63], v[116:119]
v_mfma_f32_16x16x32_bf16 v[156:159], a[188:191], a[60:63], v[156:159]
v_mfma_f32_16x16x32_bf16 v[120:123], a[160:163], a[4:7], v[120:123]
v_mfma_f32_16x16x32_bf16 v[160:163], a[164:167], a[4:7], v[160:163]
v_mul_f32 v116, v116, v90
v_mul_f32 v117, v117, v90
v_mfma_f32_16x16x32_bf16 v[120:123], a[168:171], a[24:27], v[120:123]
v_mul_f32 v118, v118, v90
v_mul_f32 v119, v119, v90
v_mfma_f32_16x16x32_bf16 v[160:163], a[172:175], a[24:27], v[160:163]
v_cvt_pk_bf16_f32 v72, v116, v117
v_cvt_pk_bf16_f32 v73, v118, v119
v_mfma_f32_16x16x32_bf16 v[120:123], a[176:179], a[44:47], v[120:123]
v_mul_f32 v156, v156, v90
v_mul_f32 v157, v157, v90
v_mfma_f32_16x16x32_bf16 v[160:163], a[180:183], a[44:47], v[160:163]
v_mul_f32 v158, v158, v90
v_mul_f32 v159, v159, v90
v_mfma_f32_16x16x32_bf16 v[120:123], a[184:187], a[64:67], v[120:123]
v_cvt_pk_bf16_f32 v74, v156, v157
v_cvt_pk_bf16_f32 v75, v158, v159
v_mfma_f32_16x16x32_bf16 v[160:163], a[188:191], a[64:67], v[160:163]
s_add_u32 s39, s42, 196608
v_mfma_f32_16x16x32_bf16 v[124:127], a[160:163], a[8:11], v[124:127]
buffer_store_dwordx4 v[72:75], v89, s[28:31], s39 offen sc1
v_mfma_f32_16x16x32_bf16 v[164:167], a[164:167], a[8:11], v[164:167]
v_mul_f32 v120, v120, v91
v_mul_f32 v121, v121, v91
v_mfma_f32_16x16x32_bf16 v[124:127], a[168:171], a[28:31], v[124:127]
v_mul_f32 v122, v122, v91
v_mul_f32 v123, v123, v91
v_mfma_f32_16x16x32_bf16 v[164:167], a[172:175], a[28:31], v[164:167]
v_cvt_pk_bf16_f32 v76, v120, v121
v_cvt_pk_bf16_f32 v77, v122, v123
v_mfma_f32_16x16x32_bf16 v[124:127], a[176:179], a[48:51], v[124:127]
v_mul_f32 v160, v160, v91
v_mul_f32 v161, v161, v91
v_mfma_f32_16x16x32_bf16 v[164:167], a[180:183], a[48:51], v[164:167]
v_mul_f32 v162, v162, v91
v_mul_f32 v163, v163, v91
v_mfma_f32_16x16x32_bf16 v[124:127], a[184:187], a[68:71], v[124:127]
v_cvt_pk_bf16_f32 v78, v160, v161
v_cvt_pk_bf16_f32 v79, v162, v163
v_mfma_f32_16x16x32_bf16 v[164:167], a[188:191], a[68:71], v[164:167]
s_add_u32 s39, s42, 425984
v_mfma_f32_16x16x32_bf16 v[128:131], a[160:163], a[12:15], v[128:131]
buffer_store_dwordx4 v[76:79], v89, s[28:31], s39 offen sc1
v_mfma_f32_16x16x32_bf16 v[168:171], a[164:167], a[12:15], v[168:171]
v_mul_f32 v124, v124, v92
v_mul_f32 v125, v125, v92
v_mfma_f32_16x16x32_bf16 v[128:131], a[168:171], a[32:35], v[128:131]
v_mul_f32 v126, v126, v92
v_mul_f32 v127, v127, v92
v_mfma_f32_16x16x32_bf16 v[168:171], a[172:175], a[32:35], v[168:171]
v_cvt_pk_bf16_f32 v40, v124, v125
v_cvt_pk_bf16_f32 v41, v126, v127
v_mfma_f32_16x16x32_bf16 v[128:131], a[176:179], a[52:55], v[128:131]
v_mul_f32 v164, v164, v92
v_mul_f32 v165, v165, v92
v_mfma_f32_16x16x32_bf16 v[168:171], a[180:183], a[52:55], v[168:171]
v_mul_f32 v166, v166, v92
v_mul_f32 v167, v167, v92
v_mfma_f32_16x16x32_bf16 v[128:131], a[184:187], a[72:75], v[128:131]
v_cvt_pk_bf16_f32 v42, v164, v165
v_cvt_pk_bf16_f32 v43, v166, v167
v_mfma_f32_16x16x32_bf16 v[168:171], a[188:191], a[72:75], v[168:171]
s_add_u32 s39, s42, 655360
v_mfma_f32_16x16x32_bf16 v[132:135], a[160:163], a[16:19], v[132:135]
buffer_store_dwordx4 v[40:43], v89, s[28:31], s39 offen sc1
v_mfma_f32_16x16x32_bf16 v[172:175], a[164:167], a[16:19], v[172:175]
v_mul_f32 v128, v128, v93
v_mul_f32 v129, v129, v93
v_mfma_f32_16x16x32_bf16 v[132:135], a[168:171], a[36:39], v[132:135]
v_mul_f32 v130, v130, v93
v_mul_f32 v131, v131, v93
v_mfma_f32_16x16x32_bf16 v[172:175], a[172:175], a[36:39], v[172:175]
v_cvt_pk_bf16_f32 v44, v128, v129
v_cvt_pk_bf16_f32 v45, v130, v131
v_mfma_f32_16x16x32_bf16 v[132:135], a[176:179], a[56:59], v[132:135]
v_mul_f32 v168, v168, v93
v_mul_f32 v169, v169, v93
v_mfma_f32_16x16x32_bf16 v[172:175], a[180:183], a[56:59], v[172:175]
v_mul_f32 v170, v170, v93
v_mul_f32 v171, v171, v93
v_mfma_f32_16x16x32_bf16 v[132:135], a[184:187], a[76:79], v[132:135]
v_cvt_pk_bf16_f32 v46, v168, v169
v_cvt_pk_bf16_f32 v47, v170, v171
v_mfma_f32_16x16x32_bf16 v[172:175], a[188:191], a[76:79], v[172:175]
s_add_u32 s39, s42, 884736
buffer_store_dwordx4 v[44:47], v89, s[28:31], s39 offen sc1
s_nop 1
v_mul_f32 v132, v132, v94
v_mul_f32 v133, v133, v94
v_mul_f32 v134, v134, v94
v_mul_f32 v135, v135, v94
v_cvt_pk_bf16_f32 v24, v132, v133
v_cvt_pk_bf16_f32 v25, v134, v135
v_mul_f32 v172, v172, v94
v_mul_f32 v173, v173, v94
v_mul_f32 v174, v174, v94
v_mul_f32 v175, v175, v94
v_cvt_pk_bf16_f32 v26, v172, v173
v_cvt_pk_bf16_f32 v27, v174, v175
s_add_u32 s39, s42, 1114112
buffer_store_dwordx4 v[24:27], v89, s[28:31], s39 offen sc1
s_cmp_eq_u32 s88, 0xffff
s_cselect_b32 s101, 1, 0
s_waitcnt vmcnt(11)
v_cmp_ge_u64 s[60:61], s[86:87], v[84:85]
v_cmp_le_u64 vcc, s[80:81], v[84:85]
s_nop 1
s_and_b32 s92, vcc_lo, s60
v_cmp_le_u64 vcc, s[82:83], v[84:85]
s_nop 1
s_and_b32 s93, vcc_lo, s60
v_cmp_le_u64 vcc, s[84:85], v[84:85]
s_nop 1
s_and_b32 s100, vcc_lo, s60
v_cmp_le_u64 vcc, s[94:95], v[84:85]
s_nop 1
s_and_b32 s43, vcc_lo, s60
s_and_b32 s3, s92, 65535
s_andn2_b32 s3, s3, s88
s_or_b32 s88, s88, s3
s_bitcmp1_b32 s3, 0
s_cselect_b32 s22, s58, 0
buffer_load_dwordx4 a[84:87], v89, s[20:23], s64 offen offset:0 sc1
s_bitcmp1_b32 s3, 1
s_cselect_b32 s22, s58, 0
buffer_load_dwordx4 a[88:91], v89, s[20:23], s64 offen offset:1024 sc1
s_bitcmp1_b32 s3, 2
s_cselect_b32 s22, s58, 0
buffer_load_dwordx4 a[92:95], v89, s[20:23], s64 offen offset:2048 sc1
s_bitcmp1_b32 s3, 3
s_cselect_b32 s22, s58, 0
buffer_load_dwordx4 a[96:99], v89, s[20:23], s64 offen offset:3072 sc1
s_bitcmp1_b32 s3, 4
s_cselect_b32 s22, s58, 0
buffer_load_dwordx4 a[100:103], v21, s[20:23], s64 offen offset:0 sc1
s_bitcmp1_b32 s3, 5
s_cselect_b32 s22, s58, 0
buffer_load_dwordx4 a[104:107], v21, s[20:23], s64 offen offset:1024 sc1
s_bitcmp1_b32 s3, 6
s_cselect_b32 s22, s58, 0
buffer_load_dwordx4 a[108:111], v21, s[20:23], s64 offen offset:2048 sc1
s_bitcmp1_b32 s3, 7
s_cselect_b32 s22, s58, 0
buffer_load_dwordx4 a[112:115], v21, s[20:23], s64 offen offset:3072 sc1
s_bitcmp1_b32 s3, 8
s_cselect_b32 s22, s58, 0
buffer_load_dwordx4 a[116:119], v22, s[20:23], s64 offen offset:0 sc1
s_bitcmp1_b32 s3, 9
s_cselect_b32 s22, s58, 0
buffer_load_dwordx4 a[120:123], v22, s[20:23], s64 offen offset:1024 sc1
s_bitcmp1_b32 s3, 10
s_cselect_b32 s22, s58, 0
buffer_load_dwordx4 a[124:127], v22, s[20:23], s64 offen offset:2048 sc1
s_bitcmp1_b32 s3, 11
s_cselect_b32 s22, s58, 0
buffer_load_dwordx4 a[128:131], v22, s[20:23], s64 offen offset:3072 sc1
s_bitcmp1_b32 s3, 12
s_cselect_b32 s22, s58, 0
buffer_load_dwordx4 a[132:135], v23, s[20:23], s64 offen offset:0 sc1
s_bitcmp1_b32 s3, 13
s_cselect_b32 s22, s58, 0
buffer_load_dwordx4 a[136:139], v23, s[20:23], s64 offen offset:1024 sc1
s_bitcmp1_b32 s3, 14
s_cselect_b32 s22, s58, 0
buffer_load_dwordx4 a[140:143], v23, s[20:23], s64 offen offset:2048 sc1
s_bitcmp1_b32 s3, 15
s_cselect_b32 s22, s58, 0
buffer_load_dwordx4 a[144:147], v23, s[20:23], s64 offen offset:3072 sc1
v_add_u32 v16, 1, v16
s_waitcnt vmcnt(21)
buffer_store_dwordx2 v[16:17], v18, s[12:15], s70 offen sc1
v_and_b32 v20, 15, v0
v_mul_u32_u24 v20, 1792, v20
v_bfe_u32 v86, v0, 4, 1
v_lshl_add_u32 v20, v86, 5, v20
v_bfe_u32 v86, v0, 5, 1
v_lshl_add_u32 v20, v86, 4, v20
v_bfe_u32 v86, v0, 2, 2
v_bfe_u32 v87, v0, 4, 2
v_cmp_eq_u32 s[60:61], v86, v87
v_and_b32 v86, 1, v0
v_lshlrev_b32 v86, 4, v86
v_mov_b32 v87, 16256
v_lshlrev_b32 v86, v86, v87
v_cndmask_b32 v86, 0, v86, s[60:61]
v_and_b32 v87, 2, v0
v_cmp_ne_u32 s[60:61], 0, v87
v_mov_b32 v87, 0
s_nop 0
v_cndmask_b32 v87, 0, v86, s[60:61]
v_xor_b32 v86, v86, v87
v_accvgpr_write_b32 a252, v86
v_accvgpr_write_b32 a253, v87
v_accvgpr_write_b32 a254, v86
v_accvgpr_write_b32 a255, v87
v_accvgpr_write_b32 a80, 0
v_accvgpr_write_b32 a81, 0
v_accvgpr_write_b32 a82, 0
v_accvgpr_write_b32 a83, 0
v_accvgpr_write_b32 a148, 0
v_accvgpr_write_b32 a149, 0
v_accvgpr_write_b32 a150, 0
v_accvgpr_write_b32 a151, 0
v_accvgpr_write_b32 a14, 0
v_accvgpr_write_b32 a15, 0
v_accvgpr_write_b32 a216, 0
v_accvgpr_write_b32 a217, 0
v_add_u32 v16, 1, v16
s_waitcnt vmcnt(17)
buffer_store_dwordx2 v[16:17], v18, s[12:15], s70 offen sc1
s_mov_b32 s36, 0
s_mov_b32 s35, -1
L_issue:
s_mov_b32 s44, 0
s_mov_b32 s45, 0xffff
s_andn2_b32 s92, s92, s88
s_or_b32 s88, s88, s92
s_bitcmp1_b32 s75, 0
s_cselect_b32 s3, s43, 0
s_or_b32 s3, s3, s88
s_and_b32 s45, s45, s3
s_cmp_eq_u32 s3, 0xffff
s_cselect_b32 s3, s3, 0
s_andn2_b32 s3, s3, s88
s_cselect_b32 s41, 1, 0
s_or_b32 s44, s44, s41
s_or_b32 s92, s92, s3
s_cbranch_scc0 L_k0
s_and_b32 s3, s92, 15
s_cbranch_scc0 L_g0_0
s_bitcmp1_b32 s92, 0
s_cbranch_scc0 L_sk0_0
buffer_load_dwordx4 a[84:87], v89, s[56:59], s64 offen offset:0 sc1
L_sk0_0:
s_bitcmp1_b32 s92, 1
s_cbranch_scc0 L_sk0_1
buffer_load_dwordx4 a[88:91], v89, s[56:59], s64 offen offset:1024 sc1
L_sk0_1:
s_bitcmp1_b32 s92, 2
s_cbranch_scc0 L_sk0_2
buffer_load_dwordx4 a[92:95], v89, s[56:59], s64 offen offset:2048 sc1
L_sk0_2:
s_bitcmp1_b32 s92, 3
s_cbranch_scc0 L_sk0_3
buffer_load_dwordx4 a[96:99], v89, s[56:59], s64 offen offset:3072 sc1
L_sk0_3:
L_g0_0:
s_and_b32 s3, s92, 240
s_cbranch_scc0 L_g0_1
s_bitcmp1_b32 s92, 4
s_cbranch_scc0 L_sk0_4
buffer_load_dwordx4 a[100:103], v21, s[56:59], s64 offen offset:0 sc1
L_sk0_4:
s_bitcmp1_b32 s92, 5
s_cbranch_scc0 L_sk0_5
buffer_load_dwordx4 a[104:107], v21, s[56:59], s64 offen offset:1024 sc1
L_sk0_5:
s_bitcmp1_b32 s92, 6
s_cbranch_scc0 L_sk0_6
buffer_load_dwordx4 a[108:111], v21, s[56:59], s64 offen offset:2048 sc1
L_sk0_6:
s_bitcmp1_b32 s92, 7
s_cbranch_scc0 L_sk0_7
buffer_load_dwordx4 a[112:115], v21, s[56:59], s64 offen offset:3072 sc1
L_sk0_7:
L_g0_1:
s_and_b32 s3, s92, 3840
s_cbranch_scc0 L_g0_2
s_bitcmp1_b32 s92, 8
s_cbranch_scc0 L_sk0_8
buffer_load_dwordx4 a[116:119], v22, s[56:59], s64 offen offset:0 sc1
L_sk0_8:
s_bitcmp1_b32 s92, 9
s_cbranch_scc0 L_sk0_9
buffer_load_dwordx4 a[120:123], v22, s[56:59], s64 offen offset:1024 sc1
L_sk0_9:
s_bitcmp1_b32 s92, 10
s_cbranch_scc0 L_sk0_10
buffer_load_dwordx4 a[124:127], v22, s[56:59], s64 offen offset:2048 sc1
L_sk0_10:
s_bitcmp1_b32 s92, 11
s_cbranch_scc0 L_sk0_11
buffer_load_dwordx4 a[128:131], v22, s[56:59], s64 offen offset:3072 sc1
L_sk0_11:
L_g0_2:
s_and_b32 s3, s92, 61440
s_cbranch_scc0 L_g0_3
s_bitcmp1_b32 s92, 12
s_cbranch_scc0 L_sk0_12
buffer_load_dwordx4 a[132:135], v23, s[56:59], s64 offen offset:0 sc1
L_sk0_12:
s_bitcmp1_b32 s92, 13
s_cbranch_scc0 L_sk0_13
buffer_load_dwordx4 a[136:139], v23, s[56:59], s64 offen offset:1024 sc1
L_sk0_13:
s_bitcmp1_b32 s92, 14
s_cbranch_scc0 L_sk0_14
buffer_load_dwordx4 a[140:143], v23, s[56:59], s64 offen offset:2048 sc1
L_sk0_14:
s_bitcmp1_b32 s92, 15
s_cbranch_scc0 L_sk0_15
buffer_load_dwordx4 a[144:147], v23, s[56:59], s64 offen offset:3072 sc1
L_sk0_15:
L_g0_3:
L_k0:
s_andn2_b32 s93, s93, s89
s_or_b32 s89, s89, s93
s_bitcmp1_b32 s75, 1
s_cselect_b32 s3, s43, 0
s_or_b32 s3, s3, s89
s_and_b32 s45, s45, s3
s_cmp_eq_u32 s3, 0xffff
s_cselect_b32 s3, s3, 0
s_andn2_b32 s3, s3, s89
s_cselect_b32 s41, 2, 0
s_or_b32 s44, s44, s41
s_or_b32 s93, s93, s3
s_cbranch_scc0 L_k1
s_and_b32 s3, s93, 15
s_cbranch_scc0 L_g1_0
s_bitcmp1_b32 s93, 0
s_cbranch_scc0 L_sk1_0
buffer_load_dwordx4 a[152:155], v89, s[56:59], s65 offen offset:0 sc1
L_sk1_0:
s_bitcmp1_b32 s93, 1
s_cbranch_scc0 L_sk1_1
buffer_load_dwordx4 a[156:159], v89, s[56:59], s65 offen offset:1024 sc1
L_sk1_1:
s_bitcmp1_b32 s93, 2
s_cbranch_scc0 L_sk1_2
buffer_load_dwordx4 a[160:163], v89, s[56:59], s65 offen offset:2048 sc1
L_sk1_2:
s_bitcmp1_b32 s93, 3
s_cbranch_scc0 L_sk1_3
buffer_load_dwordx4 a[164:167], v89, s[56:59], s65 offen offset:3072 sc1
L_sk1_3:
L_g1_0:
s_and_b32 s3, s93, 240
s_cbranch_scc0 L_g1_1
s_bitcmp1_b32 s93, 4
s_cbranch_scc0 L_sk1_4
buffer_load_dwordx4 a[168:171], v21, s[56:59], s65 offen offset:0 sc1
L_sk1_4:
s_bitcmp1_b32 s93, 5
s_cbranch_scc0 L_sk1_5
buffer_load_dwordx4 a[172:175], v21, s[56:59], s65 offen offset:1024 sc1
L_sk1_5:
s_bitcmp1_b32 s93, 6
s_cbranch_scc0 L_sk1_6
buffer_load_dwordx4 a[176:179], v21, s[56:59], s65 offen offset:2048 sc1
L_sk1_6:
s_bitcmp1_b32 s93, 7
s_cbranch_scc0 L_sk1_7
buffer_load_dwordx4 a[180:183], v21, s[56:59], s65 offen offset:3072 sc1
L_sk1_7:
L_g1_1:
s_and_b32 s3, s93, 3840
s_cbranch_scc0 L_g1_2
s_bitcmp1_b32 s93, 8
s_cbranch_scc0 L_sk1_8
buffer_load_dwordx4 a[184:187], v22, s[56:59], s65 offen offset:0 sc1
L_sk1_8:
s_bitcmp1_b32 s93, 9
s_cbranch_scc0 L_sk1_9
buffer_load_dwordx4 a[188:191], v22, s[56:59], s65 offen offset:1024 sc1
L_sk1_9:
s_bitcmp1_b32 s93, 10
s_cbranch_scc0 L_sk1_10
buffer_load_dwordx4 a[192:195], v22, s[56:59], s65 offen offset:2048 sc1
L_sk1_10:
s_bitcmp1_b32 s93, 11
s_cbranch_scc0 L_sk1_11
buffer_load_dwordx4 a[196:199], v22, s[56:59], s65 offen offset:3072 sc1
L_sk1_11:
L_g1_2:
s_and_b32 s3, s93, 61440
s_cbranch_scc0 L_g1_3
s_bitcmp1_b32 s93, 12
s_cbranch_scc0 L_sk1_12
buffer_load_dwordx4 a[200:203], v23, s[56:59], s65 offen offset:0 sc1
L_sk1_12:
s_bitcmp1_b32 s93, 13
s_cbranch_scc0 L_sk1_13
buffer_load_dwordx4 a[204:207], v23, s[56:59], s65 offen offset:1024 sc1
L_sk1_13:
s_bitcmp1_b32 s93, 14
s_cbranch_scc0 L_sk1_14
buffer_load_dwordx4 a[208:211], v23, s[56:59], s65 offen offset:2048 sc1
L_sk1_14:
s_bitcmp1_b32 s93, 15
s_cbranch_scc0 L_sk1_15
buffer_load_dwordx4 a[212:215], v23, s[56:59], s65 offen offset:3072 sc1
L_sk1_15:
L_g1_3:
L_k1:
s_andn2_b32 s100, s100, s90
s_or_b32 s90, s90, s100
s_bitcmp1_b32 s75, 2
s_cselect_b32 s3, s43, 0
s_or_b32 s3, s3, s90
s_and_b32 s45, s45, s3
s_cmp_eq_u32 s3, 0xffff
s_cselect_b32 s3, s3, 0
s_andn2_b32 s3, s3, s90
s_cselect_b32 s41, 4, 0
s_or_b32 s44, s44, s41
s_or_b32 s100, s100, s3
s_cbranch_scc0 L_k2
s_and_b32 s3, s100, 15
s_cbranch_scc0 L_g2_0
s_bitcmp1_b32 s100, 0
s_cbranch_scc0 L_sk2_0
buffer_load_dwordx4 a[16:19], v89, s[56:59], s66 offen offset:0 sc1
L_sk2_0:
s_bitcmp1_b32 s100, 1
s_cbranch_scc0 L_sk2_1
buffer_load_dwordx4 a[20:23], v89, s[56:59], s66 offen offset:1024 sc1
L_sk2_1:
s_bitcmp1_b32 s100, 2
s_cbranch_scc0 L_sk2_2
buffer_load_dwordx4 a[24:27], v89, s[56:59], s66 offen offset:2048 sc1
L_sk2_2:
s_bitcmp1_b32 s100, 3
s_cbranch_scc0 L_sk2_3
buffer_load_dwordx4 a[28:31], v89, s[56:59], s66 offen offset:3072 sc1
L_sk2_3:
L_g2_0:
s_and_b32 s3, s100, 240
s_cbranch_scc0 L_g2_1
s_bitcmp1_b32 s100, 4
s_cbranch_scc0 L_sk2_4
buffer_load_dwordx4 a[32:35], v21, s[56:59], s66 offen offset:0 sc1
L_sk2_4:
s_bitcmp1_b32 s100, 5
s_cbranch_scc0 L_sk2_5
buffer_load_dwordx4 a[36:39], v21, s[56:59], s66 offen offset:1024 sc1
L_sk2_5:
s_bitcmp1_b32 s100, 6
s_cbranch_scc0 L_sk2_6
buffer_load_dwordx4 a[40:43], v21, s[56:59], s66 offen offset:2048 sc1
L_sk2_6:
s_bitcmp1_b32 s100, 7
s_cbranch_scc0 L_sk2_7
buffer_load_dwordx4 a[44:47], v21, s[56:59], s66 offen offset:3072 sc1
L_sk2_7:
L_g2_1:
s_and_b32 s3, s100, 3840
s_cbranch_scc0 L_g2_2
s_bitcmp1_b32 s100, 8
s_cbranch_scc0 L_sk2_8
buffer_load_dwordx4 a[48:51], v22, s[56:59], s66 offen offset:0 sc1
L_sk2_8:
s_bitcmp1_b32 s100, 9
s_cbranch_scc0 L_sk2_9
buffer_load_dwordx4 a[52:55], v22, s[56:59], s66 offen offset:1024 sc1
L_sk2_9:
s_bitcmp1_b32 s100, 10
s_cbranch_scc0 L_sk2_10
buffer_load_dwordx4 a[56:59], v22, s[56:59], s66 offen offset:2048 sc1
L_sk2_10:
s_bitcmp1_b32 s100, 11
s_cbranch_scc0 L_sk2_11
buffer_load_dwordx4 a[60:63], v22, s[56:59], s66 offen offset:3072 sc1
L_sk2_11:
L_g2_2:
s_and_b32 s3, s100, 61440
s_cbranch_scc0 L_g2_3
s_bitcmp1_b32 s100, 12
s_cbranch_scc0 L_sk2_12
buffer_load_dwordx4 a[64:67], v23, s[56:59], s66 offen offset:0 sc1
L_sk2_12:
s_bitcmp1_b32 s100, 13
s_cbranch_scc0 L_sk2_13
buffer_load_dwordx4 a[68:71], v23, s[56:59], s66 offen offset:1024 sc1
L_sk2_13:
s_bitcmp1_b32 s100, 14
s_cbranch_scc0 L_sk2_14
buffer_load_dwordx4 a[72:75], v23, s[56:59], s66 offen offset:2048 sc1
L_sk2_14:
s_bitcmp1_b32 s100, 15
s_cbranch_scc0 L_sk2_15
buffer_load_dwordx4 a[76:79], v23, s[56:59], s66 offen offset:3072 sc1
L_sk2_15:
L_g2_3:
L_k2:
s_and_b32 s41, s88, s89
s_and_b32 s41, s41, s90
s_cmp_eq_u32 s41, 0xffff
s_cbranch_scc1 L_allf
v_mov_b32 v84, 0
v_mov_b32 v85, 0
s_andn2_b32 exec_lo, 0xffff, s41
buffer_atomic_or_x2 v[84:85], v19, s[12:15], 0 offen sc0 sc1
s_mov_b32 exec_lo, -1
L_allf:
s_cmp_eq_u32 s45, 0xffff
s_cselect_b32 s45, s36, 0
s_min_u32 s45, s45, 1
s_cmp_eq_u32 s45, 0
s_cbranch_scc1 L_nomk
s_mov_b32 s38, 4096
buffer_load_dwordx2 v[86:87], v19, s[12:15], s38 offen sc1
L_nomk:
s_mov_b32 s46, 0
s_andn2_b32 s3, s101, s91
s_cbranch_scc0 L_nos
L_sums:
s_or_b32 s91, s91, s3
s_bitcmp1_b32 s3, 0
s_cbranch_scc0 L_s0
v_mfma_f32_16x16x32_bf16 v[96:99], a[252:255], a[82:85], 0
v_mfma_f32_16x16x32_bf16 v[100:103], a[252:255], a[86:89], 0
v_mfma_f32_16x16x32_bf16 v[96:99], a[252:255], a[90:93], v[96:99]
v_mfma_f32_16x16x32_bf16 v[100:103], a[252:255], a[94:97], v[100:103]
v_mfma_f32_16x16x32_bf16 v[96:99], a[252:255], a[98:101], v[96:99]
v_mfma_f32_16x16x32_bf16 v[100:103], a[252:255], a[102:105], v[100:103]
v_mfma_f32_16x16x32_bf16 v[96:99], a[252:255], a[106:109], v[96:99]
v_mfma_f32_16x16x32_bf16 v[100:103], a[252:255], a[110:113], v[100:103]
v_mfma_f32_16x16x32_bf16 v[96:99], a[252:255], a[114:117], v[96:99]
v_mfma_f32_16x16x32_bf16 v[100:103], a[252:255], a[118:121], v[100:103]
v_mfma_f32_16x16x32_bf16 v[96:99], a[252:255], a[122:125], v[96:99]
v_mfma_f32_16x16x32_bf16 v[100:103], a[252:255], a[126:129], v[100:103]
v_mfma_f32_16x16x32_bf16 v[96:99], a[252:255], a[130:133], v[96:99]
v_mfma_f32_16x16x32_bf16 v[100:103], a[252:255], a[134:137], v[100:103]
v_mfma_f32_16x16x32_bf16 v[96:99], a[252:255], a[138:141], v[96:99]
v_mfma_f32_16x16x32_bf16 v[100:103], a[252:255], a[142:145], v[100:103]
v_mfma_f32_16x16x32_bf16 v[96:99], a[252:255], a[146:149], v[96:99]
L_s0:
s_bitcmp1_b32 s3, 1
s_cbranch_scc0 L_s1
v_mfma_f32_16x16x32_bf16 v[104:107], a[252:255], a[150:153], 0
v_mfma_f32_16x16x32_bf16 v[108:111], a[252:255], a[154:157], 0
v_mfma_f32_16x16x32_bf16 v[104:107], a[252:255], a[158:161], v[104:107]
v_mfma_f32_16x16x32_bf16 v[108:111], a[252:255], a[162:165], v[108:111]
v_mfma_f32_16x16x32_bf16 v[104:107], a[252:255], a[166:169], v[104:107]
v_mfma_f32_16x16x32_bf16 v[108:111], a[252:255], a[170:173], v[108:111]
v_mfma_f32_16x16x32_bf16 v[104:107], a[252:255], a[174:177], v[104:107]
v_mfma_f32_16x16x32_bf16 v[108:111], a[252:255], a[178:181], v[108:111]
v_mfma_f32_16x16x32_bf16 v[104:107], a[252:255], a[182:185], v[104:107]
v_mfma_f32_16x16x32_bf16 v[108:111], a[252:255], a[186:189], v[108:111]
v_mfma_f32_16x16x32_bf16 v[104:107], a[252:255], a[190:193], v[104:107]
v_mfma_f32_16x16x32_bf16 v[108:111], a[252:255], a[194:197], v[108:111]
v_mfma_f32_16x16x32_bf16 v[104:107], a[252:255], a[198:201], v[104:107]
v_mfma_f32_16x16x32_bf16 v[108:111], a[252:255], a[202:205], v[108:111]
v_mfma_f32_16x16x32_bf16 v[104:107], a[252:255], a[206:209], v[104:107]
v_mfma_f32_16x16x32_bf16 v[108:111], a[252:255], a[210:213], v[108:111]
v_mfma_f32_16x16x32_bf16 v[104:107], a[252:255], a[214:217], v[104:107]
L_s1:
s_bitcmp1_b32 s3, 2
s_cbranch_scc0 L_s2
v_mfma_f32_16x16x32_bf16 v[112:115], a[252:255], a[14:17], 0
v_mfma_f32_16x16x32_bf16 v[116:119], a[252:255], a[18:21], 0
v_mfma_f32_16x16x32_bf16 v[112:115], a[252:255], a[22:25], v[112:115]
v_mfma_f32_16x16x32_bf16 v[116:119], a[252:255], a[26:29], v[116:119]
v_mfma_f32_16x16x32_bf16 v[112:115], a[252:255], a[30:33], v[112:115]
v_mfma_f32_16x16x32_bf16 v[116:119], a[252:255], a[34:37], v[116:119]
v_mfma_f32_16x16x32_bf16 v[112:115], a[252:255], a[38:41], v[112:115]
v_mfma_f32_16x16x32_bf16 v[116:119], a[252:255], a[42:45], v[116:119]
v_mfma_f32_16x16x32_bf16 v[112:115], a[252:255], a[46:49], v[112:115]
v_mfma_f32_16x16x32_bf16 v[116:119], a[252:255], a[50:53], v[116:119]
v_mfma_f32_16x16x32_bf16 v[112:115], a[252:255], a[54:57], v[112:115]
v_mfma_f32_16x16x32_bf16 v[116:119], a[252:255], a[58:61], v[116:119]
v_mfma_f32_16x16x32_bf16 v[112:115], a[252:255], a[62:65], v[112:115]
v_mfma_f32_16x16x32_bf16 v[116:119], a[252:255], a[66:69], v[116:119]
v_mfma_f32_16x16x32_bf16 v[112:115], a[252:255], a[70:73], v[112:115]
v_mfma_f32_16x16x32_bf16 v[116:119], a[252:255], a[74:77], v[116:119]
v_mfma_f32_16x16x32_bf16 v[112:115], a[252:255], a[78:81], v[112:115]
L_s2:
s_nop 7
s_bitcmp1_b32 s3, 0
s_cbranch_scc0 L_f0
v_cmp_u_f32 vcc, v96, v100
v_cvt_pk_bf16_f32 v96, v96, v97
v_cvt_pk_bf16_f32 v97, v98, v99
v_cvt_pk_bf16_f32 v98, v100, v101
v_cvt_pk_bf16_f32 v99, v102, v103
s_cbranch_vccz L_ok0
s_bitcmp1_b32 s44, 0
s_cbranch_scc0 L_ok0
s_bitset0_b32 s91, 0
s_bitset0_b32 s3, 0
s_branch L_f0
L_ok0:
s_mov_b32 s88, 0xffff
v_permlane16_swap_b32 v96, v98
v_permlane16_swap_b32 v97, v99
s_nop 1
buffer_store_dwordx4 v[96:99], v20, s[16:19], s67 offen
L_f0:
s_bitcmp1_b32 s3, 1
s_cbranch_scc0 L_f1
v_cmp_u_f32 vcc, v104, v108
v_cvt_pk_bf16_f32 v104, v104, v105
v_cvt_pk_bf16_f32 v105, v106, v107
v_cvt_pk_bf16_f32 v106, v108, v109
v_cvt_pk_bf16_f32 v107, v110, v111
s_cbranch_vccz L_ok1
s_bitcmp1_b32 s44, 1
s_cbranch_scc0 L_ok1
s_bitset0_b32 s91, 1
s_bitset0_b32 s3, 1
s_branch L_f1
L_ok1:
s_mov_b32 s89, 0xffff
v_permlane16_swap_b32 v104, v106
v_permlane16_swap_b32 v105, v107
s_nop 1
buffer_store_dwordx4 v[104:107], v20, s[16:19], s68 offen
L_f1:
s_bitcmp1_b32 s3, 2
s_cbranch_scc0 L_f2
v_cmp_u_f32 vcc, v112, v116
v_cvt_pk_bf16_f32 v112, v112, v113
v_cvt_pk_bf16_f32 v113, v114, v115
v_cvt_pk_bf16_f32 v114, v116, v117
v_cvt_pk_bf16_f32 v115, v118, v119
s_cbranch_vccz L_ok2
s_bitcmp1_b32 s44, 2
s_cbranch_scc0 L_ok2
s_bitset0_b32 s91, 2
s_bitset0_b32 s3, 2
s_branch L_f2
L_ok2:
s_mov_b32 s90, 0xffff
v_permlane16_swap_b32 v112, v114
v_permlane16_swap_b32 v113, v115
s_nop 1
buffer_store_dwordx4 v[112:115], v20, s[16:19], s71 offen
L_f2:
s_cmp_lg_u32 s46, 0
s_cbranch_scc1 L_after
L_nos:
s_mov_b32 s101, 0
s_cmp_eq_u32 s88, 0xffff
s_cselect_b32 s3, 1, 0
s_or_b32 s101, s101, s3
s_cmp_eq_u32 s89, 0xffff
s_cselect_b32 s3, 2, 0
s_or_b32 s101, s101, s3
s_cmp_eq_u32 s90, 0xffff
s_cselect_b32 s3, 4, 0
s_or_b32 s101, s101, s3
s_add_u32 s36, s36, 1
s_mov_b32 s46, 1
s_or_b32 s3, s101, s44
s_cmp_eq_u32 s101, 7
s_cselect_b32 s41, 1, s44
s_cmp_eq_u32 s41, 0
s_waitcnt vmcnt(0)
s_cbranch_scc1 L_more
s_cmp_lg_u32 s45, 0
s_cbranch_scc1 L_hasmk
s_mov_b32 s38, 4096
buffer_load_dwordx2 v[86:87], v19, s[12:15], s38 offen sc1
L_hasmk:
s_andn2_b32 s3, s3, s91
s_cbranch_scc1 L_sums
L_after:
s_cmp_eq_u32 s91, 7
s_cbranch_scc1 L_chk
L_more:
v_cmp_ge_u64 s[60:61], s[86:87], v[84:85]
v_cmp_le_u64 vcc, s[80:81], v[84:85]
s_nop 1
s_and_b32 s92, vcc_lo, s60
v_cmp_le_u64 vcc, s[82:83], v[84:85]
s_nop 1
s_and_b32 s93, vcc_lo, s60
v_cmp_le_u64 vcc, s[84:85], v[84:85]
s_nop 1
s_and_b32 s100, vcc_lo, s60
v_cmp_le_u64 vcc, s[94:95], v[84:85]
s_nop 1
s_and_b32 s43, vcc_lo, s60
s_cmp_lt_u32 s36, 2048
s_cbranch_scc1 L_issue
s_cmp_gt_u32 s36, 2048
s_cbranch_scc1 L_last
s_lshl_b32 s38, s37, 3
s_add_u32 s38, s38, 4096
buffer_store_dwordx2 v[16:17], v18, s[12:15], s38 offen sc1
s_waitcnt vmcnt(0)
s_branch L_issue
L_last:
s_mov_b32 s41, 0xffff
s_or_b32 s3, s92, s88
s_and_b32 s41, s41, s3
s_or_b32 s3, s93, s89
s_and_b32 s41, s41, s3
s_or_b32 s3, s100, s90
s_and_b32 s41, s41, s3
s_cmp_eq_u32 s41, 0xffff
s_cbranch_scc1 L_issue
s_branch L_fin
L_chk:
s_cmp_lg_u32 s35, -1
s_cbranch_scc1 L_chk2
s_cmp_lg_u32 s45, 0
s_cbranch_scc1 L_w2
s_cmp_eq_u32 s3, 0
s_cbranch_scc0 L_w1
s_waitcnt vmcnt(0)
L_w1:
s_waitcnt vmcnt(1)
L_w2:
v_cmp_eq_u64 vcc, v[86:87], v[16:17]
s_nop 1
s_and_b32 s35, vcc_lo, 0xffff
s_bitset0_b32 s35, s37
s_cmp_eq_u32 s35, 0
s_cbranch_scc1 L_fin
v_mov_b32 v84, 0
v_mov_b32 v85, 0
buffer_atomic_or_x2 v[84:85], v19, s[12:15], 0 offen sc0 sc1
s_waitcnt vmcnt(0)
v_cmp_ge_u64 s[60:61], s[86:87], v[84:85]
v_cmp_le_u64 vcc, s[86:87], v[84:85]
s_nop 1
s_and_b32 s100, vcc_lo, s60
s_cmp_lg_u32 s100, 0xffff
s_cbranch_scc1 L_fin
L_chk2:
s_cmp_eq_u32 s35, 0
s_cbranch_scc1 L_fin
s_ff1_i32_b32 s34, s35
s_bitset0_b32 s35, s34
s_and_b32 s101, s34, 7
s_lshl_b32 s101, s101, 3
s_mov_b32 s91, 0
s_mov_b32 s75, 0
s_mov_b32 s92, 185339150
s_mov_b32 s93, 117967114
s_bitcmp1_b32 s34, 3
s_cmov_b32 s92, 50595078
s_cmov_b32 s93, 1073742082
s_lshr_b64 s[92:93], s[92:93], s101
s_and_b32 s41, s92, 127
s_cmp_lt_u32 s41, 35
s_cselect_b32 s88, 0, 0xffff
s_cselect_b32 s100, 0, 1
s_cselect_b32 s41, s41, 0
s_or_b32 s91, s91, s100
s_cmp_ge_u32 s41, 35
s_cselect_b32 s100, 1, 0
s_or_b32 s75, s75, s100
s_mul_i32 s3, s41, 52
s_lshr_b32 s3, s3, 8
s_mul_i32 s67, s3, 5
s_sub_u32 s41, s41, s67
s_sub_u32 s80, s3, 6
s_mul_i32 s64, s41, 7
s_add_u32 s64, s64, s3
s_mul_i32 s64, s64, 32768
s_mul_i32 s67, s41, 28672
s_lshl_b32 s3, s3, 7
s_add_u32 s67, s67, s3
s_mov_b32 s92, 320083222
s_mov_b32 s93, 252711186
s_bitcmp1_b32 s34, 3
s_cmov_b32 s92, 1077952576
s_cmov_b32 s93, 1077952576
s_lshr_b64 s[92:93], s[92:93], s101
s_and_b32 s41, s92, 127
s_cmp_lt_u32 s41, 35
s_cselect_b32 s89, 0, 0xffff
s_cselect_b32 s100, 0, 2
s_cselect_b32 s41, s41, 0
s_or_b32 s91, s91, s100
s_cmp_ge_u32 s41, 35
s_cselect_b32 s100, 2, 0
s_or_b32 s75, s75, s100
s_mul_i32 s3, s41, 52
s_lshr_b32 s3, s3, 8
s_mul_i32 s68, s3, 5
s_sub_u32 s41, s41, s68
s_sub_u32 s82, s3, 6
s_mul_i32 s65, s41, 7
s_add_u32 s65, s65, s3
s_mul_i32 s65, s65, 32768
s_mul_i32 s68, s41, 28672
s_lshl_b32 s3, s3, 7
s_add_u32 s68, s68, s3
s_mov_b32 s92, 522199330
s_mov_b32 s93, 454827294
s_bitcmp1_b32 s34, 3
s_cmov_b32 s92, 387455258
s_cmov_b32 s93, 1077952576
s_lshr_b64 s[92:93], s[92:93], s101
s_and_b32 s41, s92, 127
s_cmp_lt_u32 s41, 35
s_cselect_b32 s90, 0, 0xffff
s_cselect_b32 s100, 0, 4
s_cselect_b32 s41, s41, 0
s_or_b32 s91, s91, s100
s_cmp_ge_u32 s41, 35
s_cselect_b32 s100, 4, 0
s_or_b32 s75, s75, s100
s_mul_i32 s3, s41, 52
s_lshr_b32 s3, s3, 8
s_mul_i32 s71, s3, 5
s_sub_u32 s41, s41, s71
s_sub_u32 s84, s3, 6
s_mul_i32 s66, s41, 7
s_add_u32 s66, s66, s3
s_mul_i32 s66, s66, 32768
s_mul_i32 s71, s41, 28672
s_lshl_b32 s3, s3, 7
s_add_u32 s71, s71, s3
s_add_u32 s80, s80, s86
s_mov_b32 s81, s87
s_add_u32 s64, s64, s42
s_add_u32 s82, s82, s86
s_mov_b32 s83, s87
s_add_u32 s65, s65, s42
s_add_u32 s84, s84, s86
s_mov_b32 s85, s87
s_add_u32 s66, s66, s42
s_mov_b32 s92, 0xffff
s_mov_b32 s93, 0xffff
s_mov_b32 s100, 0xffff
s_mov_b32 s101, 0
s_waitcnt vmcnt(0)
s_branch L_issue
L_fin:
s_endpgm
L_R_t0:
s_mov_b32 s46, 0
s_call_b64 s[44:45], L_subR
s_branch L_Rr_t0
L_D_t0:
s_mov_b32 s46, 1
s_call_b64 s[44:45], L_subD
s_branch L_Dr_t0
L_R_p3:
s_mov_b32 s46, 1
s_call_b64 s[44:45], L_subR
s_branch L_Rr_p3
L_D_p3:
s_mov_b32 s46, 0
s_call_b64 s[44:45], L_subD
s_branch L_Dr_p3
L_R_p0:
s_mov_b32 s46, 0
s_call_b64 s[44:45], L_subR
s_branch L_Rr_p0
L_D_p0:
s_mov_b32 s46, 1
s_call_b64 s[44:45], L_subD
s_branch L_Dr_p0
L_R_p1:
s_mov_b32 s46, 1
s_call_b64 s[44:45], L_subR
s_branch L_Rr_p1
L_D_p1:
s_mov_b32 s46, 0
s_call_b64 s[44:45], L_subD
s_branch L_Dr_p1
L_R_p2:
s_mov_b32 s46, 0
s_call_b64 s[44:45], L_subR
s_branch L_Rr_p2
L_D_p2:
s_mov_b32 s46, 1
s_call_b64 s[44:45], L_subD
s_branch L_Dr_p2
L_R_t27:
s_mov_b32 s46, 1
s_call_b64 s[44:45], L_subR
s_branch L_Rr_t27
L_D_t27:
s_mov_b32 s46, 0
s_call_b64 s[44:45], L_subD
s_branch L_Dr_t27
L_R_t28:
s_mov_b32 s46, 0
s_call_b64 s[44:45], L_subR
s_branch L_Rr_t28
L_D_t28:
s_mov_b32 s46, 1
s_call_b64 s[44:45], L_subD
s_branch L_Dr_t28
L_R_t29:
s_mov_b32 s46, 1
s_call_b64 s[44:45], L_subR
s_branch L_Rr_t29
L_D_t29:
s_mov_b32 s46, 0
s_call_b64 s[44:45], L_subD
s_branch L_Dr_t29
L_R_t30:
s_mov_b32 s46, 0
s_call_b64 s[44:45], L_subR
s_branch L_Rr_t30
L_D_t30:
s_mov_b32 s46, 1
s_call_b64 s[44:45], L_subD
s_branch L_Dr_t30
L_X_t31:
s_mov_b32 s46, 1
s_waitcnt lgkmcnt(0)
s_nop 15
v_mov_b32 v24, v48
v_mov_b32 v25, v49
v_mov_b32 v26, v50
v_mov_b32 v27, v51
v_accvgpr_write_b32 a224, v52
v_accvgpr_write_b32 a225, v53
v_accvgpr_write_b32 a226, v54
v_accvgpr_write_b32 a227, v55
v_accvgpr_write_b32 a228, v56
v_accvgpr_write_b32 a229, v57
v_accvgpr_write_b32 a230, v58
v_accvgpr_write_b32 a231, v59
v_accvgpr_write_b32 a232, v60
v_accvgpr_write_b32 a233, v61
v_accvgpr_write_b32 a234, v62
v_accvgpr_write_b32 a235, v63
v_accvgpr_write_b32 a236, v64
v_accvgpr_write_b32 a237, v65
v_accvgpr_write_b32 a238, v66
v_accvgpr_write_b32 a239, v67
s_call_b64 s[44:45], L_subR
v_mov_b32 v48, v24
v_mov_b32 v49, v25
v_mov_b32 v50, v26
v_mov_b32 v51, v27
v_accvgpr_read_b32 v52, a224
v_accvgpr_read_b32 v53, a225
v_accvgpr_read_b32 v54, a226
v_accvgpr_read_b32 v55, a227
v_accvgpr_read_b32 v56, a228
v_accvgpr_read_b32 v57, a229
v_accvgpr_read_b32 v58, a230
v_accvgpr_read_b32 v59, a231
v_accvgpr_read_b32 v60, a232
v_accvgpr_read_b32 v61, a233
v_accvgpr_read_b32 v62, a234
v_accvgpr_read_b32 v63, a235
v_accvgpr_read_b32 v64, a236
v_accvgpr_read_b32 v65, a237
v_accvgpr_read_b32 v66, a238
v_accvgpr_read_b32 v67, a239
s_nop 3
s_branch L_Xr_t31
L_subD:
s_nop 15
s_mul_i32 s39, s46, 10240
v_add_u32 v40, s39, v14
s_mul_i32 s39, s46, 5120
s_mul_i32 s52, s32, 1280
s_add_u32 s39, s39, s52
s_add_u32 s39, s39, 86016
v_and_b32 v41, 63, v0
v_lshlrev_b32 v41, 2, v41
v_add_u32 v41, s39, v41
v_max3_f32 v42, v48, v49, v50
v_max_f32 v42, v42, v51
v_mov_b32 v43, v42
s_nop 1
v_permlane32_swap_b32 v42, v43
v_max_f32 v42, v42, v43
v_mov_b32 v43, v42
s_nop 1
v_permlane16_swap_b32 v42, v43
v_max_f32 v42, v42, v43
v_add_f32 v42, 1107296256, v42
v_ceil_f32 v42, v42
v_max_f32 v42, 0, v42
ds_write_b32 v41, v42 offset:0
v_sub_f32 v48, v48, v42
v_sub_f32 v49, v49, v42
v_sub_f32 v50, v50, v42
v_sub_f32 v51, v51, v42
v_exp_f32 v48, v48
v_exp_f32 v49, v49
v_exp_f32 v50, v50
v_exp_f32 v51, v51
v_cvt_pk_bf16_f32 v28, v48, v49
v_cvt_pk_bf16_f32 v29, v50, v51
v_sub_f32 v44, 0, v42
v_exp_f32 v44, v44
v_or_b32 v46, 2147483648, v28
v_mov_b32 v47, v29
ds_write_b64 v40, v[46:47] offset:0
v_max3_f32 v42, v52, v53, v54
v_max_f32 v42, v42, v55
v_mov_b32 v43, v42
s_nop 1
v_permlane32_swap_b32 v42, v43
v_max_f32 v42, v42, v43
v_mov_b32 v43, v42
s_nop 1
v_permlane16_swap_b32 v42, v43
v_max_f32 v42, v42, v43
v_add_f32 v42, 1107296256, v42
v_ceil_f32 v42, v42
v_max_f32 v42, 0, v42
ds_write_b32 v41, v42 offset:256
v_sub_f32 v52, v52, v42
v_sub_f32 v53, v53, v42
v_sub_f32 v54, v54, v42
v_sub_f32 v55, v55, v42
v_exp_f32 v52, v52
v_exp_f32 v53, v53
v_exp_f32 v54, v54
v_exp_f32 v55, v55
v_cvt_pk_bf16_f32 v30, v52, v53
v_cvt_pk_bf16_f32 v31, v54, v55
v_sub_f32 v45, 0, v42
v_exp_f32 v45, v45
s_nop 0
v_cndmask_b32 v44, v44, v45, s[48:49]
v_accvgpr_read_b32 v43, a240
v_mul_f32 v43, v43, v44
v_accvgpr_write_b32 a240, v43
ds_write_b64 v40, v[30:31] offset:1024
v_max3_f32 v42, v56, v57, v58
v_max_f32 v42, v42, v59
v_mov_b32 v43, v42
s_nop 1
v_permlane32_swap_b32 v42, v43
v_max_f32 v42, v42, v43
v_mov_b32 v43, v42
s_nop 1
v_permlane16_swap_b32 v42, v43
v_max_f32 v42, v42, v43
v_add_f32 v42, 1107296256, v42
v_ceil_f32 v42, v42
v_max_f32 v42, 0, v42
ds_write_b32 v41, v42 offset:512
v_sub_f32 v56, v56, v42
v_sub_f32 v57, v57, v42
v_sub_f32 v58, v58, v42
v_sub_f32 v59, v59, v42
v_exp_f32 v56, v56
v_exp_f32 v57, v57
v_exp_f32 v58, v58
v_exp_f32 v59, v59
v_cvt_pk_bf16_f32 v32, v56, v57
v_cvt_pk_bf16_f32 v33, v58, v59
v_sub_f32 v44, 0, v42
v_exp_f32 v44, v44
ds_write_b64 v40, v[32:33] offset:2048
v_max3_f32 v42, v60, v61, v62
v_max_f32 v42, v42, v63
v_mov_b32 v43, v42
s_nop 1
v_permlane32_swap_b32 v42, v43
v_max_f32 v42, v42, v43
v_mov_b32 v43, v42
s_nop 1
v_permlane16_swap_b32 v42, v43
v_max_f32 v42, v42, v43
v_add_f32 v42, 1107296256, v42
v_ceil_f32 v42, v42
v_max_f32 v42, 0, v42
ds_write_b32 v41, v42 offset:768
v_sub_f32 v60, v60, v42
v_sub_f32 v61, v61, v42
v_sub_f32 v62, v62, v42
v_sub_f32 v63, v63, v42
v_exp_f32 v60, v60
v_exp_f32 v61, v61
v_exp_f32 v62, v62
v_exp_f32 v63, v63
v_cvt_pk_bf16_f32 v34, v60, v61
v_cvt_pk_bf16_f32 v35, v62, v63
v_sub_f32 v45, 0, v42
v_exp_f32 v45, v45
s_nop 0
v_cndmask_b32 v44, v44, v45, s[48:49]
v_accvgpr_read_b32 v43, a244
v_mul_f32 v43, v43, v44
v_accvgpr_write_b32 a244, v43
ds_write_b64 v40, v[34:35] offset:3072
v_max3_f32 v42, v64, v65, v66
v_max_f32 v42, v42, v67
v_mov_b32 v43, v42
s_nop 1
v_permlane32_swap_b32 v42, v43
v_max_f32 v42, v42, v43
v_mov_b32 v43, v42
s_nop 1
v_permlane16_swap_b32 v42, v43
v_max_f32 v42, v42, v43
v_add_f32 v42, 1107296256, v42
v_ceil_f32 v42, v42
v_max_f32 v42, 0, v42
ds_write_b32 v41, v42 offset:1024
v_sub_f32 v64, v64, v42
v_sub_f32 v65, v65, v42
v_sub_f32 v66, v66, v42
v_sub_f32 v67, v67, v42
v_exp_f32 v64, v64
v_exp_f32 v65, v65
v_exp_f32 v66, v66
v_exp_f32 v67, v67
v_cvt_pk_bf16_f32 v36, v64, v65
v_cvt_pk_bf16_f32 v37, v66, v67
v_sub_f32 v44, 0, v42
v_exp_f32 v44, v44
v_accvgpr_read_b32 v43, a248
v_mul_f32 v43, v43, v44
v_accvgpr_write_b32 a248, v43
ds_write_b64 v40, v[36:37] offset:4096
s_nop 3
s_setpc_b64 s[44:45]
L_subR:
s_waitcnt lgkmcnt(0)
s_nop 15
s_mul_i32 s39, s46, 5120
s_lshr_b32 s52, s32, 1
s_mul_i32 s52, s52, 2560
s_add_u32 s39, s39, s52
s_add_u32 s39, s39, 86016
v_and_b32 v40, 63, v0
v_lshlrev_b32 v40, 2, v40
v_add_u32 v40, s39, v40
v_cmp_gt_i32 s[52:53], 0, v24
v_cmp_gt_i32 s[54:55], 0, v26
v_and_b32 v24, 2147483647, v24
v_and_b32 v26, 2147483647, v26
ds_read_b32 v41, v40 offset:0
ds_read_b32 v42, v40 offset:1280
s_waitcnt lgkmcnt(0)
v_cndmask_b32 v41, 0, v41, s[52:53]
v_cndmask_b32 v42, 0, v42, s[54:55]
v_max_f32 v43, v41, v42
v_sub_f32 v41, v41, v43
v_sub_f32 v42, v42, v43
v_exp_f32 v41, v41
v_exp_f32 v42, v42
v_sub_f32 v44, 0, v43
v_exp_f32 v44, v44
v_lshlrev_b32 v45, 16, v24
v_and_b32 v46, 4294901760, v24
v_mul_f32 v45, v45, v41
v_mul_f32 v46, v46, v41
v_cvt_pk_bf16_f32 v24, v45, v46
v_lshlrev_b32 v45, 16, v25
v_and_b32 v46, 4294901760, v25
v_mul_f32 v45, v45, v41
v_mul_f32 v46, v46, v41
v_cvt_pk_bf16_f32 v25, v45, v46
v_lshlrev_b32 v45, 16, v26
v_and_b32 v46, 4294901760, v26
v_mul_f32 v45, v45, v42
v_mul_f32 v46, v46, v42
v_cvt_pk_bf16_f32 v26, v45, v46
v_lshlrev_b32 v45, 16, v27
v_and_b32 v46, 4294901760, v27
v_mul_f32 v45, v45, v42
v_mul_f32 v46, v46, v42
v_cvt_pk_bf16_f32 v27, v45, v46
v_mul_f32 v96, v96, v44
v_mul_f32 v97, v97, v44
v_mul_f32 v98, v98, v44
v_mul_f32 v99, v99, v44
v_mul_f32 v116, v116, v44
v_mul_f32 v117, v117, v44
v_mul_f32 v118, v118, v44
v_mul_f32 v119, v119, v44
v_mul_f32 v136, v136, v44
v_mul_f32 v137, v137, v44
v_mul_f32 v138, v138, v44
v_mul_f32 v139, v139, v44
v_mul_f32 v156, v156, v44
v_mul_f32 v157, v157, v44
v_mul_f32 v158, v158, v44
v_mul_f32 v159, v159, v44
v_mul_f32 v176, v176, v44
v_mul_f32 v177, v177, v44
v_mul_f32 v178, v178, v44
v_mul_f32 v179, v179, v44
v_mul_f32 v196, v196, v44
v_mul_f32 v197, v197, v44
v_mul_f32 v198, v198, v44
v_mul_f32 v199, v199, v44
v_mul_f32 v216, v216, v44
v_mul_f32 v217, v217, v44
v_mul_f32 v218, v218, v44
v_mul_f32 v219, v219, v44
v_mul_f32 v236, v236, v44
v_mul_f32 v237, v237, v44
v_mul_f32 v238, v238, v44
v_mul_f32 v239, v239, v44
v_sub_f32 v68, v68, v43
v_sub_f32 v69, v69, v43
v_sub_f32 v70, v70, v43
v_sub_f32 v71, v71, v43
v_sub_f32 v48, v48, v43
v_sub_f32 v49, v49, v43
v_sub_f32 v50, v50, v43
v_sub_f32 v51, v51, v43
v_cndmask_b32 v28, v41, v42, s[50:51]
ds_read_b32 v41, v40 offset:256
ds_read_b32 v42, v40 offset:1536
s_waitcnt lgkmcnt(0)
v_cndmask_b32 v41, 0, v41, s[52:53]
v_cndmask_b32 v42, 0, v42, s[54:55]
v_max_f32 v43, v41, v42
v_sub_f32 v41, v41, v43
v_sub_f32 v42, v42, v43
v_exp_f32 v41, v41
v_exp_f32 v42, v42
v_sub_f32 v44, 0, v43
v_exp_f32 v44, v44
v_accvgpr_read_b32 v47, a224
v_lshlrev_b32 v45, 16, v47
v_and_b32 v46, 4294901760, v47
v_mul_f32 v45, v45, v41
v_mul_f32 v46, v46, v41
v_cvt_pk_bf16_f32 v47, v45, v46
v_accvgpr_write_b32 a224, v47
v_accvgpr_read_b32 v47, a225
v_lshlrev_b32 v45, 16, v47
v_and_b32 v46, 4294901760, v47
v_mul_f32 v45, v45, v41
v_mul_f32 v46, v46, v41
v_cvt_pk_bf16_f32 v47, v45, v46
v_accvgpr_write_b32 a225, v47
v_accvgpr_read_b32 v47, a226
v_lshlrev_b32 v45, 16, v47
v_and_b32 v46, 4294901760, v47
v_mul_f32 v45, v45, v42
v_mul_f32 v46, v46, v42
v_cvt_pk_bf16_f32 v47, v45, v46
v_accvgpr_write_b32 a226, v47
v_accvgpr_read_b32 v47, a227
v_lshlrev_b32 v45, 16, v47
v_and_b32 v46, 4294901760, v47
v_mul_f32 v45, v45, v42
v_mul_f32 v46, v46, v42
v_cvt_pk_bf16_f32 v47, v45, v46
v_accvgpr_write_b32 a227, v47
v_mul_f32 v100, v100, v44
v_mul_f32 v101, v101, v44
v_mul_f32 v102, v102, v44
v_mul_f32 v103, v103, v44
v_mul_f32 v120, v120, v44
v_mul_f32 v121, v121, v44
v_mul_f32 v122, v122, v44
v_mul_f32 v123, v123, v44
v_mul_f32 v140, v140, v44
v_mul_f32 v141, v141, v44
v_mul_f32 v142, v142, v44
v_mul_f32 v143, v143, v44
v_mul_f32 v160, v160, v44
v_mul_f32 v161, v161, v44
v_mul_f32 v162, v162, v44
v_mul_f32 v163, v163, v44
v_mul_f32 v180, v180, v44
v_mul_f32 v181, v181, v44
v_mul_f32 v182, v182, v44
v_mul_f32 v183, v183, v44
v_mul_f32 v200, v200, v44
v_mul_f32 v201, v201, v44
v_mul_f32 v202, v202, v44
v_mul_f32 v203, v203, v44
v_mul_f32 v220, v220, v44
v_mul_f32 v221, v221, v44
v_mul_f32 v222, v222, v44
v_mul_f32 v223, v223, v44
v_mul_f32 v240, v240, v44
v_mul_f32 v241, v241, v44
v_mul_f32 v242, v242, v44
v_mul_f32 v243, v243, v44
v_sub_f32 v72, v72, v43
v_sub_f32 v73, v73, v43
v_sub_f32 v74, v74, v43
v_sub_f32 v75, v75, v43
v_sub_f32 v52, v52, v43
v_sub_f32 v53, v53, v43
v_sub_f32 v54, v54, v43
v_sub_f32 v55, v55, v43
v_cndmask_b32 v29, v41, v42, s[50:51]
v_cndmask_b32 v28, v28, v29, s[48:49]
v_accvgpr_read_b32 v45, a240
v_mul_f32 v45, v45, v28
v_accvgpr_write_b32 a240, v45
ds_read_b32 v41, v40 offset:512
ds_read_b32 v42, v40 offset:1792
s_waitcnt lgkmcnt(0)
v_cndmask_b32 v41, 0, v41, s[52:53]
v_cndmask_b32 v42, 0, v42, s[54:55]
v_max_f32 v43, v41, v42
v_sub_f32 v41, v41, v43
v_sub_f32 v42, v42, v43
v_exp_f32 v41, v41
v_exp_f32 v42, v42
v_sub_f32 v44, 0, v43
v_exp_f32 v44, v44
v_accvgpr_read_b32 v47, a228
v_lshlrev_b32 v45, 16, v47
v_and_b32 v46, 4294901760, v47
v_mul_f32 v45, v45, v41
v_mul_f32 v46, v46, v41
v_cvt_pk_bf16_f32 v47, v45, v46
v_accvgpr_write_b32 a228, v47
v_accvgpr_read_b32 v47, a229
v_lshlrev_b32 v45, 16, v47
v_and_b32 v46, 4294901760, v47
v_mul_f32 v45, v45, v41
v_mul_f32 v46, v46, v41
v_cvt_pk_bf16_f32 v47, v45, v46
v_accvgpr_write_b32 a229, v47
v_accvgpr_read_b32 v47, a230
v_lshlrev_b32 v45, 16, v47
v_and_b32 v46, 4294901760, v47
v_mul_f32 v45, v45, v42
v_mul_f32 v46, v46, v42
v_cvt_pk_bf16_f32 v47, v45, v46
v_accvgpr_write_b32 a230, v47
v_accvgpr_read_b32 v47, a231
v_lshlrev_b32 v45, 16, v47
v_and_b32 v46, 4294901760, v47
v_mul_f32 v45, v45, v42
v_mul_f32 v46, v46, v42
v_cvt_pk_bf16_f32 v47, v45, v46
v_accvgpr_write_b32 a231, v47
v_mul_f32 v104, v104, v44
v_mul_f32 v105, v105, v44
v_mul_f32 v106, v106, v44
v_mul_f32 v107, v107, v44
v_mul_f32 v124, v124, v44
v_mul_f32 v125, v125, v44
v_mul_f32 v126, v126, v44
v_mul_f32 v127, v127, v44
v_mul_f32 v144, v144, v44
v_mul_f32 v145, v145, v44
v_mul_f32 v146, v146, v44
v_mul_f32 v147, v147, v44
v_mul_f32 v164, v164, v44
v_mul_f32 v165, v165, v44
v_mul_f32 v166, v166, v44
v_mul_f32 v167, v167, v44
v_mul_f32 v184, v184, v44
v_mul_f32 v185, v185, v44
v_mul_f32 v186, v186, v44
v_mul_f32 v187, v187, v44
v_mul_f32 v204, v204, v44
v_mul_f32 v205, v205, v44
v_mul_f32 v206, v206, v44
v_mul_f32 v207, v207, v44
v_mul_f32 v224, v224, v44
v_mul_f32 v225, v225, v44
v_mul_f32 v226, v226, v44
v_mul_f32 v227, v227, v44
v_mul_f32 v244, v244, v44
v_mul_f32 v245, v245, v44
v_mul_f32 v246, v246, v44
v_mul_f32 v247, v247, v44
v_sub_f32 v76, v76, v43
v_sub_f32 v77, v77, v43
v_sub_f32 v78, v78, v43
v_sub_f32 v79, v79, v43
v_cndmask_b32 v28, v41, v42, s[50:51]
ds_read_b32 v41, v40 offset:768
ds_read_b32 v42, v40 offset:2048
s_waitcnt lgkmcnt(0)
v_cndmask_b32 v41, 0, v41, s[52:53]
v_cndmask_b32 v42, 0, v42, s[54:55]
v_max_f32 v43, v41, v42
v_sub_f32 v41, v41, v43
v_sub_f32 v42, v42, v43
v_exp_f32 v41, v41
v_exp_f32 v42, v42
v_sub_f32 v44, 0, v43
v_exp_f32 v44, v44
v_accvgpr_read_b32 v47, a232
v_lshlrev_b32 v45, 16, v47
v_and_b32 v46, 4294901760, v47
v_mul_f32 v45, v45, v41
v_mul_f32 v46, v46, v41
v_cvt_pk_bf16_f32 v47, v45, v46
v_accvgpr_write_b32 a232, v47
v_accvgpr_read_b32 v47, a233
v_lshlrev_b32 v45, 16, v47
v_and_b32 v46, 4294901760, v47
v_mul_f32 v45, v45, v41
v_mul_f32 v46, v46, v41
v_cvt_pk_bf16_f32 v47, v45, v46
v_accvgpr_write_b32 a233, v47
v_accvgpr_read_b32 v47, a234
v_lshlrev_b32 v45, 16, v47
v_and_b32 v46, 4294901760, v47
v_mul_f32 v45, v45, v42
v_mul_f32 v46, v46, v42
v_cvt_pk_bf16_f32 v47, v45, v46
v_accvgpr_write_b32 a234, v47
v_accvgpr_read_b32 v47, a235
v_lshlrev_b32 v45, 16, v47
v_and_b32 v46, 4294901760, v47
v_mul_f32 v45, v45, v42
v_mul_f32 v46, v46, v42
v_cvt_pk_bf16_f32 v47, v45, v46
v_accvgpr_write_b32 a235, v47
v_mul_f32 v108, v108, v44
v_mul_f32 v109, v109, v44
v_mul_f32 v110, v110, v44
v_mul_f32 v111, v111, v44
v_mul_f32 v128, v128, v44
v_mul_f32 v129, v129, v44
v_mul_f32 v130, v130, v44
v_mul_f32 v131, v131, v44
v_mul_f32 v148, v148, v44
v_mul_f32 v149, v149, v44
v_mul_f32 v150, v150, v44
v_mul_f32 v151, v151, v44
v_mul_f32 v168, v168, v44
v_mul_f32 v169, v169, v44
v_mul_f32 v170, v170, v44
v_mul_f32 v171, v171, v44
v_mul_f32 v188, v188, v44
v_mul_f32 v189, v189, v44
v_mul_f32 v190, v190, v44
v_mul_f32 v191, v191, v44
v_mul_f32 v208, v208, v44
v_mul_f32 v209, v209, v44
v_mul_f32 v210, v210, v44
v_mul_f32 v211, v211, v44
v_mul_f32 v228, v228, v44
v_mul_f32 v229, v229, v44
v_mul_f32 v230, v230, v44
v_mul_f32 v231, v231, v44
v_mul_f32 v248, v248, v44
v_mul_f32 v249, v249, v44
v_mul_f32 v250, v250, v44
v_mul_f32 v251, v251, v44
v_sub_f32 v80, v80, v43
v_sub_f32 v81, v81, v43
v_sub_f32 v82, v82, v43
v_sub_f32 v83, v83, v43
v_cndmask_b32 v29, v41, v42, s[50:51]
v_cndmask_b32 v28, v28, v29, s[48:49]
v_accvgpr_read_b32 v45, a244
v_mul_f32 v45, v45, v28
v_accvgpr_write_b32 a244, v45
ds_read_b32 v41, v40 offset:1024
ds_read_b32 v42, v40 offset:2304
s_waitcnt lgkmcnt(0)
v_cndmask_b32 v41, 0, v41, s[52:53]
v_cndmask_b32 v42, 0, v42, s[54:55]
v_max_f32 v43, v41, v42
v_sub_f32 v41, v41, v43
v_sub_f32 v42, v42, v43
v_exp_f32 v41, v41
v_exp_f32 v42, v42
v_sub_f32 v44, 0, v43
v_exp_f32 v44, v44
v_accvgpr_read_b32 v47, a236
v_lshlrev_b32 v45, 16, v47
v_and_b32 v46, 4294901760, v47
v_mul_f32 v45, v45, v41
v_mul_f32 v46, v46, v41
v_cvt_pk_bf16_f32 v47, v45, v46
v_accvgpr_write_b32 a236, v47
v_accvgpr_read_b32 v47, a237
v_lshlrev_b32 v45, 16, v47
v_and_b32 v46, 4294901760, v47
v_mul_f32 v45, v45, v41
v_mul_f32 v46, v46, v41
v_cvt_pk_bf16_f32 v47, v45, v46
v_accvgpr_write_b32 a237, v47
v_accvgpr_read_b32 v47, a238
v_lshlrev_b32 v45, 16, v47
v_and_b32 v46, 4294901760, v47
v_mul_f32 v45, v45, v42
v_mul_f32 v46, v46, v42
v_cvt_pk_bf16_f32 v47, v45, v46
v_accvgpr_write_b32 a238, v47
v_accvgpr_read_b32 v47, a239
v_lshlrev_b32 v45, 16, v47
v_and_b32 v46, 4294901760, v47
v_mul_f32 v45, v45, v42
v_mul_f32 v46, v46, v42
v_cvt_pk_bf16_f32 v47, v45, v46
v_accvgpr_write_b32 a239, v47
v_mul_f32 v112, v112, v44
v_mul_f32 v113, v113, v44
v_mul_f32 v114, v114, v44
v_mul_f32 v115, v115, v44
v_mul_f32 v132, v132, v44
v_mul_f32 v133, v133, v44
v_mul_f32 v134, v134, v44
v_mul_f32 v135, v135, v44
v_mul_f32 v152, v152, v44
v_mul_f32 v153, v153, v44
v_mul_f32 v154, v154, v44
v_mul_f32 v155, v155, v44
v_mul_f32 v172, v172, v44
v_mul_f32 v173, v173, v44
v_mul_f32 v174, v174, v44
v_mul_f32 v175, v175, v44
v_mul_f32 v192, v192, v44
v_mul_f32 v193, v193, v44
v_mul_f32 v194, v194, v44
v_mul_f32 v195, v195, v44
v_mul_f32 v212, v212, v44
v_mul_f32 v213, v213, v44
v_mul_f32 v214, v214, v44
v_mul_f32 v215, v215, v44
v_mul_f32 v232, v232, v44
v_mul_f32 v233, v233, v44
v_mul_f32 v234, v234, v44
v_mul_f32 v235, v235, v44
v_mul_f32 v252, v252, v44
v_mul_f32 v253, v253, v44
v_mul_f32 v254, v254, v44
v_mul_f32 v255, v255, v44
v_sub_f32 v84, v84, v43
v_sub_f32 v85, v85, v43
v_sub_f32 v86, v86, v43
v_sub_f32 v87, v87, v43
v_cndmask_b32 v28, v41, v42, s[50:51]
v_accvgpr_read_b32 v45, a248
v_mul_f32 v45, v45, v28
v_accvgpr_write_b32 a248, v45
s_nop 3
s_setpc_b64 s[44:45]
L_exit:
s_endpgm
.section .rodata,"a"
.p2align 6
.amdhsa_kernel concat_heads__mha_block_cached__mha_block_cached__near_ridge_kernel
  .amdhsa_next_free_vgpr 512
  .amdhsa_next_free_sgpr 102
  .amdhsa_accum_offset 256
  .amdhsa_group_segment_fixed_size 0
  .amdhsa_kernarg_size 104
  .amdhsa_user_sgpr_count 2
  .amdhsa_user_sgpr_kernarg_segment_ptr 1
  .amdhsa_system_sgpr_workgroup_id_x 1
.end_amdhsa_kernel
```
